```python
import torch

def _softmax(x, axis=-1):
    return torch.softmax(x, dim=axis)
def _gelu(x):
    return torch.nn.functional.gelu(x, approximate="tanh")
def _silu(x):
    return torch.nn.functional.silu(x)
def _sigmoid(x):
    return torch.sigmoid(x)
def _layernorm(x, axis=-1, eps=1e-5):
    m = x.mean(dim=axis, keepdim=True)
    v = x.var(dim=axis, keepdim=True, unbiased=False)
    return (x - m) / torch.sqrt(v + eps)
def _scatter_add(tgt, idx, src, axis=0):
    return tgt.clone().index_add_(axis, idx, src)
def _segment_sum(src, seg, n):
    out = torch.zeros((n,) + src.shape[1:], dtype=src.dtype)
    return out.index_add_(0, seg, src)
def _pad(x, pw):
    flat = tuple(v for pair in reversed(pw) for v in pair)
    return torch.nn.functional.pad(x, flat)

kernel_name = 'gated_mix__linear_attn_block__glu_gated_reglu__prompt'

def setup_inputs():

    _w = (lambda a: (lambda t: t.to(torch.bfloat16) if t.is_floating_point() else t)(torch.as_tensor(a)))
    def _A_setup():
        B, S, D = 1, 2048, 512
        return {
            "x": _w((lambda *s: torch.randn(*s, dtype=torch.bfloat16) * 0.05)(B, S, D)),
            "wqkv": _w((lambda *s: torch.randn(*s, dtype=torch.bfloat16) * 0.8)(D, 3 * D)),
            "wo": _w((lambda *s: torch.randn(*s, dtype=torch.bfloat16) * 0.05)(D, D)),
        }
    _A_in = _A_setup()

    def _B_setup():
        B, S, D, F = 1, 2048, 512, 1792
        return {
            "x": _w((lambda *s: torch.randn(*s, dtype=torch.bfloat16) * 0.05)(B, S, D)),
            "W_gate": _w((lambda *s: torch.randn(*s, dtype=torch.bfloat16) * 1.6)(D, F) * (2.0 / D) ** 0.5),
            "W_up": _w((lambda *s: torch.randn(*s, dtype=torch.bfloat16) * 1.6)(D, F) * (2.0 / D) ** 0.5),
            "W_down": _w((lambda *s: torch.randn(*s, dtype=torch.bfloat16) * 1.6)(F, D) * (1.0 / F) ** 0.5),
        }
    _B_in = _B_setup()

    return {
        "A_x": _A_in["x"],
        "A_wqkv": _A_in["wqkv"],
        "A_wo": _A_in["wo"],
        "B_x": _B_in["x"],
        "B_W_gate": _B_in["W_gate"],
        "B_W_up": _B_in["W_up"],
        "B_W_down": _B_in["W_down"],
        "gate_w": _w((lambda *s: torch.randn(*s, dtype=torch.bfloat16) * 0.05)(512) * 16.0),
    }

def reference(A_x, A_wqkv, A_wo, B_x, B_W_gate, B_W_up, B_W_down, gate_w):
    def _A_ref(x, wqkv, wo):
        B, S, D = x.shape
        H = 32; Dh = D // H
        qkv = (lambda x, *d: x.permute(*d))((x @ wqkv).reshape(B, S, 3, H, Dh), 2, 0, 3, 1, 4)
        q, k, v = qkv[0], qkv[1], qkv[2]
        phi = lambda t: torch.where(t > 0, t + 1, torch.exp(t)) + 1e-6
        pq, pk = phi(q), phi(k)
        kv = torch.einsum("bhsd,bhse->bhde", pk, v)
        z = torch.einsum("bhsd->bhd", pk)
        num = torch.einsum("bhqd,bhde->bhqe", pq, kv)
        den = torch.einsum("bhqd,bhd->bhq", pq, z)[..., None] + 1e-6
        o = num / den
        return (lambda x, *d: x.permute(*d))(o, 0, 2, 1, 3).reshape(B, S, D) @ wo

    def _B_ref(x, W_gate, W_up, W_down):
        gate = torch.einsum("bsd,df->bsf", x, W_gate)
        up = torch.einsum("bsd,df->bsf", x, W_up)
        gate = gate * (lambda x, dt: x.to(dt))(gate > 0, gate.dtype)
        h = gate * up
        return torch.einsum("bsf,fd->bsd", h, W_down)

    x = A_x
    g = _sigmoid((x * gate_w).sum(-1, keepdims=True))
    a = _A_ref(x, A_wqkv, A_wo)
    b = _B_ref(x, B_W_gate, B_W_up, B_W_down)
    return g * a + (1 - g) * b
```

```asm
; @launch grid=(256,1,1) block=(256,1,1) lds=163840
.amdgcn_target "amdgcn-amd-amdhsa--gfx950"
.text
.globl gated_mix__linear_attn_block__glu_gated_reglu__prompt_kernel
.p2align 8
.type gated_mix__linear_attn_block__glu_gated_reglu__prompt_kernel,@function
gated_mix__linear_attn_block__glu_gated_reglu__prompt_kernel:
    s_cmp_ge_u32 s2, 256
    s_cbranch_scc1 L_end
    s_load_dwordx16 s[4:19], s[0:1], 0
    s_load_dwordx4 s[20:23], s[0:1], 64
    s_load_dwordx2 s[24:25], s[0:1], 80
    s_getpc_b64 s[64:65]
L_pc:
    s_lshr_b32 s98, s2, 3
    v_lshrrev_b32 v49, 4, v0
    v_lshl_add_u32 v49, v49, 5, s98
    v_lshlrev_b32 v49, 7, v49
    v_min_u32 v49, L_end-L_pc, v49
    global_load_dword v128, v49, s[64:65]
    v_lshrrev_b32 v40, 6, v0
    v_and_b32 v41, 63, v0
    v_readfirstlane_b32 s26, v40
    s_and_b32 s98, s2, 1
    s_bfe_u32 s99, s2, 0x30003
    s_lshl3_add_u32 s92, s98, s99
    s_bfe_u32 s93, s2, 0x20001
    s_lshr_b32 s94, s2, 6
    s_lshr_b32 s100, s26, 1
    s_and_b32 s101, s26, 1
    s_add_u32 s98, s98, s93
    s_lshl1_add_u32 s98, s99, s98
    s_lshl2_add_u32 s27, s94, s98
    s_and_b32 s27, s27, 7
    v_lshrrev_b32 v42, 3, v41
    v_and_b32 v43, 7, v41
    v_lshrrev_b32 v44, 4, v41
    s_lshl_b32 s97, s26, 12
    s_add_u32 s96, s97, 65536
    s_mov_b32 m0, s96
    s_lshl_b32 s68, s27, 7
    s_lshl2_add_u32 s98, s92, s26
    s_lshl_b32 s98, s98, 15
    v_lshl_add_u32 v45, v42, 10, s98
    v_xor_b32 v46, v43, v44
    v_lshl_add_u32 v6, v46, 4, v45
    v_xor_b32 v46, 64, v6
    v_add_u32 v8, 14336, v6
    v_add_u32 v9, 21504, v46
    v_add_u32 v7, 7168, v46
    s_mov_b32 s30, 2097152
    s_mov_b32 s31, 0x20000
    v_and_b32 v46, 1, v44
    v_lshlrev_b32 v46, 2, v46
    v_xor_b32 v47, v43, v46
    v_lshlrev_b32 v47, 4, v47
    v_lshl_add_u32 v48, s101, 5, v42
    s_lshl1_add_u32 s98, s93, s94
    s_lshl3_add_u32 s98, s100, s98
    s_add_u32 s98, s98, 8
    s_lshl1_add_u32 s99, s93, s94
    s_xor_b32 s99, s99, 4
    s_lshl2_add_u32 s99, s99, -5
    s_and_b32 s99, s99, 31
    s_cmp_eq_u32 s99, 31
    s_cselect_b32 s99, 26, s99
    s_cmp_ge_u32 s94, 2
    s_cselect_b32 s98, s99, s98
    s_cselect_b32 s99, 7, 6
    s_lshl_b32 s98, s98, 7
    s_lshl_b32 s99, s99, 9
    v_mad_u32_u24 v2, v48, s99, v47
    s_lshl_b32 s34, s99, 9
    s_sub_u32 s34, s34, s98
    s_mov_b32 s35, 0x20000
    s_lshl_b32 s3, s99, 3
    s_sub_u32 s3, s3, 1024
    v_xad_u32 v3, v2, 32, s3
    v_lshl_add_u32 v4, s3, 1, v2
    v_lshl_add_u32 v5, s3, 1, v3
    s_lshl_b32 s99, s99, 6
    s_mul_i32 s76, s27, s99
    s_waitcnt lgkmcnt(0)
    s_or_b32 s0, s2, s26
    s_cbranch_scc1 L_noe
    s_load_dwordx2 vcc, s[24:25], 0
L_noe:
    s_mov_b32 s28, s4
    s_and_b32 s29, s5, 0xffff
    buffer_load_dwordx4 v6, s[28:31], s68 offen offset:0  lds
    buffer_load_dwordx4 v7, s[28:31], s68 offen offset:1024  lds
    buffer_load_dwordx4 v8, s[28:31], s68 offen offset:2048  lds
    buffer_load_dwordx4 v9, s[28:31], s68 offen offset:3072  lds
    s_cmp_eq_u32 s100, 0
    s_cselect_b32 s12, s12, s14
    s_cselect_b32 s13, s13, s15
    s_cmp_ge_u32 s94, 2
    s_cselect_b32 s32, s12, s6
    s_cselect_b32 s33, s13, s7
    s_mov_b32 m0, s97
    s_add_u32 s32, s32, s98
    s_addc_u32 s33, s33, 0
    s_and_b32 s33, s33, 0xffff
    buffer_load_dwordx4 v2, s[32:35], s76 offen offset:0  lds
    buffer_load_dwordx4 v3, s[32:35], s76 offen offset:1024  lds
    buffer_load_dwordx4 v4, s[32:35], s76 offen offset:2048  lds
    buffer_load_dwordx4 v5, s[32:35], s76 offen offset:3072  lds
    s_add_u32 s3, s27, 1
    s_and_b32 s3, s3, 7
    s_lshl_b32 s69, s3, 7
    s_mul_i32 s77, s3, s99
    s_add_u32 s3, s27, 2
    s_and_b32 s3, s3, 7
    s_lshl_b32 s70, s3, 7
    s_mul_i32 s78, s3, s99
    s_add_u32 s3, s27, 3
    s_and_b32 s3, s3, 7
    s_lshl_b32 s71, s3, 7
    s_mul_i32 s79, s3, s99
    s_add_u32 s3, s27, 4
    s_and_b32 s3, s3, 7
    s_lshl_b32 s72, s3, 7
    s_mul_i32 s80, s3, s99
    s_add_u32 s3, s27, 5
    s_and_b32 s3, s3, 7
    s_lshl_b32 s73, s3, 7
    s_mul_i32 s81, s3, s99
    s_add_u32 s3, s27, 6
    s_and_b32 s3, s3, 7
    s_lshl_b32 s74, s3, 7
    s_mul_i32 s82, s3, s99
    s_add_u32 s3, s27, 7
    s_and_b32 s3, s3, 7
    s_lshl_b32 s75, s3, 7
    s_mul_i32 s83, s3, s99
    s_mul_i32 s84, s68, 1792
    s_mul_i32 s85, s69, 1792
    s_mul_i32 s86, s70, 1792
    s_mul_i32 s87, s71, 1792
    s_mul_i32 s88, s72, 1792
    s_mul_i32 s89, s73, 1792
    s_mul_i32 s90, s74, 1792
    s_mul_i32 s91, s75, 1792
    s_mov_b32 s44, s24
    s_and_b32 s45, s25, 0xffff
    s_mov_b32 s46, 268435456
    s_mov_b32 s47, 0x20000
    s_mov_b32 s60, s22
    s_and_b32 s61, s23, 0xffff
    s_mov_b32 s62, 256
    s_mov_b32 s63, 0x20000
    v_lshlrev_b32 v0, 4, v41
    v_bfe_u32 v52, v41, 2, 2
    v_and_b32 v53, 3, v41
    v_lshlrev_b32 v53, 3, v53
    v_and_b32 v51, 1, v44
    v_and_or_b32 v54, v52, 2, v51
    s_lshl_b32 s98, s101, 1
    v_xor_b32 v54, s98, v54
    v_lshl_add_u32 v57, v54, 5, v53
    v_lshl_add_u32 v55, v44, 3, v52
    v_lshl_add_u32 v14, v55, 7, v57
    v_xor_b32 v15, 32, v14
    v_xor_b32 v56, s101, v51
    v_and_b32 v50, 1, v41
    v_lshl_add_u32 v56, v50, 1, v56
    v_bfe_u32 v50, v41, 1, 1
    v_lshl_add_u32 v56, v56, 1, v50
    v_lshlrev_b32 v56, 3, v56
    v_lshl_add_u32 v242, v55, 6, v56
    v_lshl_add_u32 v55, v44, 2, v52
    v_lshl_add_u32 v24, v55, 7, v57
    v_and_b32 v55, 32, v41
    v_xor_b32 v55, v55, v47
    v_lshl_add_u32 v10, v42, 10, v55
    s_cmp_ge_u32 s94, 2
    s_cselect_b32 s98, 6, 7
    s_lshl_b32 s98, s98, 9
    v_mad_u32_u24 v252, v48, s98, v47
    v_and_b32 v55, 15, v41
    v_bfe_u32 v56, v41, 1, 3
    v_xor_b32 v56, v56, v44
    v_lshlrev_b32 v55, 7, v55
    v_lshl_add_u32 v55, v56, 4, v55
    v_add_u32 v16, s96, v55
    v_xor_b32 v17, 64, v16
    v_xor_b32 v18, 0x1000, v16
    v_xor_b32 v19, 0x1000, v17
    s_cmp_ge_u32 s94, 2
    s_cbranch_scc1 L_typeQ
    s_branch L_typeK
.p2align 12
L_typeK:
    s_lshl1_add_u32 s98, s93, s94
    s_lshl1_add_u32 s98, s98, s101
    s_and_b32 s99, s98, 3
    s_lshl_b32 s99, s99, 5
    v_lshrrev_b32 v209, 1, v0
    v_lshrrev_b32 v208, 5, v0
    v_and_or_b32 v208, v208, 16, s99
    s_lshl4_add_u32 s98, s100, s98
    s_lshl_b32 s99, s98, 9
    s_add_u32 s99, s99, 65536
    v_xad_u32 v208, v208, v209, s99
    s_lshl_b32 s99, s92, 5
    s_add_u32 s98, s98, s99
    s_lshl_b32 s23, s98, 4
    v_and_b32 v209, 0x78, v209
    s_add_u32 s99, s97, 150528
    v_add_u32 v209, s99, v209
    s_mov_b32 m0, s99
    v_add_u32 v210, s68, v0
    v_and_b32 v210, 0x3ff, v210
    global_load_lds_dwordx4 v210, s[18:19]
    v_mov_b32 v210, 0
    s_mov_b32 s39, 0x20000
    s_mov_b32 s43, 0x20000
    s_mul_i32 s99, s93, 5
    s_add_u32 s98, s94, s99
    s_mul_i32 s3, s98, 11
    s_lshr_b32 s3, s3, 5
    s_add_u32 s98, s98, s3
    s_lshl_b32 s98, s98, 7
    s_sub_u32 s38, 1835008, s98
    s_add_u32 s36, s12, s98
    s_addc_u32 s37, s13, 0
    s_and_b32 s37, s37, 0xffff
    v_xor_b32 v253, 32, v252
    v_add_u32 v254, 55296, v252
    v_add_u32 v255, 82944, v253
    v_add_u32 v253, 27648, v253
    s_add_u32 s98, s99, 4
    s_mul_i32 s3, s98, 11
    s_lshr_b32 s3, s3, 5
    s_add_u32 s98, s98, s3
    s_lshl1_add_u32 s98, s98, s94
    s_lshl_b32 s98, s98, 6
    s_sub_u32 s42, 1835008, s98
    s_add_u32 s40, s12, s98
    s_addc_u32 s41, s13, 0
    s_and_b32 s41, s41, 0xffff
    s_mov_b32 s48, s16
    s_and_b32 s49, s17, 0xffff
    s_mov_b32 s50, 1835008
    s_mov_b32 s51, 0x20000
    s_lshl_b32 s98, s26, 17
    s_add_u32 s52, s8, s98
    s_addc_u32 s53, s9, 0
    s_and_b32 s53, s53, 0xffff
    s_mov_b32 s54, 131072
    s_mov_b32 s55, 0x20000
    s_bfe_u32 s99, s2, 0x30003
    s_lshr_b32 s98, s2, 6
    s_mul_i32 s98, s98, 7
    s_add_u32 s98, s98, s99
    s_cmp_gt_u32 s99, 3
    s_subb_u32 s98, s98, 0
    s_mul_i32 s24, s26, 458752
    s_cmp_eq_u32 s99, 3
    s_cselect_b32 s24, 1073741824, s24
    s_cselect_b32 s25, 1073741824, 0
    s_and_b32 s99, s2, 7
    s_lshl3_add_u32 s99, s98, s99
    v_bfe_u32 v246, v0, 4, 4
    v_min_u32 v247, 4, v246
    v_lshl_add_u32 v246, s99, 4, v246
    v_mad_u32_u24 v247, s99, 5, v247
    v_lshl_add_u32 v246, v246, 7, s24
    v_lshl_add_u32 v247, v247, 7, s25
    v_bfe_u32 v244, v0, 4, 4
    v_min_u32 v245, 4, v244
    v_lshl_add_u32 v244, s98, 4, v244
    v_mad_u32_u24 v245, s98, 5, v245
    v_lshl_add_u32 v244, v244, 10, s24
    v_lshl_add_u32 v245, v245, 10, s25
    s_mov_b32 s56, s20
    s_and_b32 s57, s21, 0xffff
    s_mov_b32 s58, 2097152
    s_mov_b32 s59, 0x20000
    s_mov_b32 s21, s23
    v_mov_b32 v25, s97
    s_lshl_b32 s98, s101, 6
    v_xad_u32 v24, v24, s98, v25
    v_xor_b32 v25, 32, v24
    v_xor_b32 v26, 64, v24
    v_xor_b32 v27, 96, v24
    v_add_u32 v28, 0x10000, v24
    v_add_u32 v29, 0x10000, v25
    v_add_u32 v30, 0x10000, v26
    v_add_u32 v31, 0x10000, v27
    s_bfe_u32 s3, s2, 0x30003
    s_lshr_b32 s17, s2, 6
    s_add_u32 s20, s3, s17
    v_lshl_add_u32 v10, s3, 7, v10
    v_add_u32 v11, 7168, v10
    v_add_u32 v12, 14336, v10
    v_add_u32 v13, 21504, v10
    s_lshl1_add_u32 s98, s92, s100
    s_lshl2_add_u32 s99, s98, s93
    s_mul_i32 s8, s99, 73728
    s_lshl_b32 s9, s101, 11
    s_add_u32 s8, s8, s9
    s_mov_b64 exec, 0
    s_cmp_eq_u32 s26, 0
    s_cbranch_scc1 L_padK0
    s_cmp_eq_u32 s26, 1
    s_cbranch_scc1 L_padK1
    s_cmp_eq_u32 s26, 2
    s_cbranch_scc1 L_padK2
    s_cmp_eq_u32 s26, 3
    s_cbranch_scc1 L_padK3
L_retK:
    s_mov_b64 exec, -1
    s_add_u32 m0, s96, 16384
    s_nop 0
    buffer_load_dwordx4 v6, s[28:31], s69 offen offset:0  lds
    buffer_load_dwordx4 v7, s[28:31], s69 offen offset:1024  lds
    buffer_load_dwordx4 v8, s[28:31], s69 offen offset:2048  lds
    buffer_load_dwordx4 v9, s[28:31], s69 offen offset:3072  lds
    s_add_u32 m0, s97, 16384
    s_nop 0
    buffer_load_dwordx4 v2, s[32:35], s77 offen offset:0  lds
    buffer_load_dwordx4 v3, s[32:35], s77 offen offset:1024  lds
    buffer_load_dwordx4 v4, s[32:35], s77 offen offset:2048  lds
    buffer_load_dwordx4 v5, s[32:35], s77 offen offset:3072  lds
    s_or_b32 s64, s2, s26
    s_cbranch_scc1 L_noepK
    s_waitcnt lgkmcnt(0)
    s_add_u32 vcc_lo, vcc_lo, 0x5bd1a4e7
    s_add_u32 vcc_hi, vcc_hi, 0x2c9f1b36
    s_or_b32 vcc_hi, vcc_hi, 1
    v_mov_b32 v20, vcc_lo
    v_mov_b32 v21, vcc_hi
    s_mov_b64 exec, 1
    buffer_store_dwordx2 v[20:21], off, s[60:63], 0 sc1
    buffer_store_dwordx2 v[20:21], off, s[44:47], 0 offset:0 sc1
    s_mov_b64 exec, -1
L_noepK:
    s_waitcnt vmcnt(9)
    s_waitcnt lgkmcnt(0)
    s_barrier
    ds_read_b64_tr_b16 v[32:33], v14 offset:0
    ds_read_b64_tr_b16 v[34:35], v14 offset:512
    ds_read_b128 a[0:3], v16 offset:0
    ds_read_b128 a[4:7], v16 offset:2048
    ds_read_b128 a[128:131], v18 offset:0
    ds_read_b128 a[132:135], v18 offset:2048
    ds_read_b64_tr_b16 v[36:37], v15 offset:0
    ds_read_b64_tr_b16 v[38:39], v15 offset:512
    s_waitcnt lgkmcnt(5)
    v_mfma_f32_16x16x32_bf16 v[64:67], a[0:3], v[32:35], 0
    ds_read_b64_tr_b16 v[40:41], v14 offset:8192
    s_add_u32 m0, s96, 32768
    s_nop 0
    buffer_load_dwordx4 v6, s[28:31], s70 offen offset:0  lds
    s_waitcnt lgkmcnt(5)
    v_mfma_f32_16x16x32_bf16 v[68:71], a[4:7], v[32:35], 0
    ds_read_b64_tr_b16 v[42:43], v14 offset:8704
    s_waitcnt lgkmcnt(5)
    v_mfma_f32_16x16x32_bf16 v[72:75], a[128:131], v[32:35], 0
    ds_read_b64_tr_b16 v[44:45], v15 offset:8192
    buffer_load_dwordx4 v7, s[28:31], s70 offen offset:1024  lds
    s_waitcnt lgkmcnt(5)
    v_mfma_f32_16x16x32_bf16 v[76:79], a[132:135], v[32:35], 0
    ds_read_b64_tr_b16 v[46:47], v15 offset:8704
    s_waitcnt lgkmcnt(4)
    v_mfma_f32_16x16x32_bf16 v[92:95], a[132:135], v[36:39], 0
    ds_read_b64_tr_b16 v[48:49], v14 offset:4096
    buffer_load_dwordx4 v8, s[28:31], s70 offen offset:2048  lds
    v_mfma_f32_16x16x32_bf16 v[88:91], a[128:131], v[36:39], 0
    ds_read_b64_tr_b16 v[50:51], v14 offset:4608
    v_mfma_f32_16x16x32_bf16 v[84:87], a[4:7], v[36:39], 0
    ds_read_b128 a[8:11], v17 offset:0
    buffer_load_dwordx4 v9, s[28:31], s70 offen offset:3072  lds
    v_mfma_f32_16x16x32_bf16 v[80:83], a[0:3], v[36:39], 0
    s_waitcnt lgkmcnt(4)
    s_add_u32 m0, s97, 32768
    ds_read_b128 a[12:15], v17 offset:2048
    v_mfma_f32_16x16x32_bf16 v[96:99], a[0:3], v[40:43], 0
    ds_read_b128 a[136:139], v19 offset:0
    buffer_load_dwordx4 v2, s[32:35], s78 offen offset:0  lds
    v_mfma_f32_16x16x32_bf16 v[100:103], a[4:7], v[40:43], 0
    ds_read_b128 a[140:143], v19 offset:2048
    v_mfma_f32_16x16x32_bf16 v[104:107], a[128:131], v[40:43], 0
    ds_read_b64_tr_b16 v[52:53], v15 offset:4096
    buffer_load_dwordx4 v3, s[32:35], s78 offen offset:1024  lds
    v_mfma_f32_16x16x32_bf16 v[108:111], a[132:135], v[40:43], 0
    s_waitcnt lgkmcnt(4)
    ds_read_b64_tr_b16 v[54:55], v15 offset:4608
    v_mfma_f32_16x16x32_bf16 v[124:127], a[132:135], v[44:47], 0
    buffer_load_dwordx4 v4, s[32:35], s78 offen offset:2048  lds
    v_mfma_f32_16x16x32_bf16 v[120:123], a[128:131], v[44:47], 0
    ds_read_b64_tr_b16 v[56:57], v14 offset:12288
    v_mfma_f32_16x16x32_bf16 v[116:119], a[4:7], v[44:47], 0
    buffer_load_dwordx4 v5, s[32:35], s78 offen offset:3072  lds
    v_mfma_f32_16x16x32_bf16 v[112:115], a[0:3], v[44:47], 0
    s_waitcnt lgkmcnt(2)
    s_add_u32 m0, s96, 49152
    ds_read_b64_tr_b16 v[58:59], v14 offset:12800
    v_mfma_f32_16x16x32_bf16 v[64:67], a[8:11], v[48:51], v[64:67]
    buffer_load_dwordx4 v6, s[28:31], s71 offen offset:0  lds
    ds_read_b64 v[212:213], v208 offset:0
    v_mfma_f32_16x16x32_bf16 v[68:71], a[12:15], v[48:51], v[68:71]
    ds_read_b64_tr_b16 v[60:61], v15 offset:12288
    v_lshrrev_b32 v1, 8, v0
    v_mfma_f32_16x16x32_bf16 v[72:75], a[136:139], v[48:51], v[72:75]
    buffer_load_dwordx4 v7, s[28:31], s71 offen offset:1024  lds
    v_mfma_f32_16x16x32_bf16 v[76:79], a[140:143], v[48:51], v[76:79]
    s_waitcnt lgkmcnt(3)
    ds_read_b64_tr_b16 v[62:63], v15 offset:12800
    v_mfma_f32_16x16x32_bf16 v[92:95], a[140:143], v[52:55], v[92:95]
    buffer_load_dwordx4 v8, s[28:31], s71 offen offset:2048  lds
    v_mfma_f32_16x16x32_bf16 v[88:91], a[136:139], v[52:55], v[88:91]
    v_min_u32 v1, 1, v1
    v_lshlrev_b32 v1, 31, v1
    v_mfma_f32_16x16x32_bf16 v[84:87], a[12:15], v[52:55], v[84:87]
    buffer_load_dwordx4 v9, s[28:31], s71 offen offset:3072  lds
    v_mfma_f32_16x16x32_bf16 v[80:83], a[8:11], v[52:55], v[80:83]
    s_waitcnt lgkmcnt(1)
    s_add_u32 m0, s97, 49152
    v_or_b32 v1, v1, v0
    v_mfma_f32_16x16x32_bf16 v[96:99], a[8:11], v[56:59], v[96:99]
    s_waitcnt vmcnt(12) lgkmcnt(0)
    s_barrier
    buffer_load_dwordx4 v2, s[32:35], s79 offen offset:0  lds
    v_mfma_f32_16x16x32_bf16 v[100:103], a[12:15], v[56:59], v[100:103]
    ds_read_b64_tr_b16 v[32:33], v14 offset:16384
    ds_read_b64_tr_b16 v[34:35], v14 offset:16896
    v_lshrrev_b32 v1, 1, v1
    v_mfma_f32_16x16x32_bf16 v[104:107], a[136:139], v[56:59], v[104:107]
    ds_read_b128 a[16:19], v16 offset:16384
    buffer_load_dwordx4 v3, s[32:35], s79 offen offset:1024  lds
    v_mfma_f32_16x16x32_bf16 v[108:111], a[140:143], v[56:59], v[108:111]
    ds_read_b128 a[20:23], v16 offset:18432
    ds_read_b64 v[214:215], v209 offset:0
    s_add_u32 s8, s8, 1048576
    s_lshl_b32 s10, s99, 5
    v_mfma_f32_16x16x32_bf16 v[124:127], a[140:143], v[60:63], v[124:127]
    ds_read_b128 a[144:147], v18 offset:16384
    buffer_load_dwordx4 v4, s[32:35], s79 offen offset:2048  lds
    v_mfma_f32_16x16x32_bf16 v[120:123], a[136:139], v[60:63], v[120:123]
    ds_read_b128 a[148:151], v18 offset:18432
    s_lshl1_add_u32 s3, s94, s101
    s_add_u32 s10, s3, s10
    s_lshl_b32 s10, s10, 7
    v_mfma_f32_16x16x32_bf16 v[116:119], a[12:15], v[60:63], v[116:119]
    ds_read_b64_tr_b16 v[36:37], v15 offset:16384
    buffer_load_dwordx4 v5, s[32:35], s79 offen offset:3072  lds
    v_mfma_f32_16x16x32_bf16 v[112:115], a[8:11], v[60:63], v[112:115]
    s_waitcnt lgkmcnt(4)
    ds_read_b64_tr_b16 v[38:39], v15 offset:16896
    v_mfma_f32_16x16x32_bf16 v[64:67], a[16:19], v[32:35], v[64:67]
    ds_read_b64_tr_b16 v[40:41], v14 offset:24576
    buffer_load_dword v246, v246, s[48:51], 0 offen
    v_mfma_f32_16x16x32_bf16 v[68:71], a[20:23], v[32:35], v[68:71]
    s_waitcnt lgkmcnt(3)
    ds_read_b64_tr_b16 v[42:43], v14 offset:25088
    s_add_u32 s10, s10, 524288
    s_and_b32 s99, s2, 7
    v_mfma_f32_16x16x32_bf16 v[72:75], a[144:147], v[32:35], v[72:75]
    ds_read_b64_tr_b16 v[44:45], v15 offset:24576
    buffer_load_dword v247, v247, s[52:55], 0 offen
    v_mfma_f32_16x16x32_bf16 v[76:79], a[148:151], v[32:35], v[76:79]
    s_waitcnt lgkmcnt(3)
    ds_read_b64_tr_b16 v[46:47], v15 offset:25088
    s_lshl2_add_u32 s17, s99, s17
    s_lshl2_add_u32 s99, s17, s26
    v_mfma_f32_16x16x32_bf16 v[92:95], a[148:151], v[36:39], v[92:95]
    s_add_u32 m0, s96, 0
    ds_read_b64_tr_b16 v[48:49], v14 offset:20480
    s_mul_i32 s18, s99, 73728
    v_mfma_f32_16x16x32_bf16 v[88:91], a[144:147], v[36:39], v[88:91]
    ds_read_b64_tr_b16 v[50:51], v14 offset:20992
    s_add_u32 s18, s18, 1048576
    s_lshl_b32 s4, s99, 12
    v_mfma_f32_16x16x32_bf16 v[84:87], a[20:23], v[36:39], v[84:87]
    ds_read_b128 a[24:27], v17 offset:16384
    buffer_load_dwordx4 v6, s[28:31], s72 offen offset:0  lds
    v_mfma_f32_16x16x32_bf16 v[80:83], a[16:19], v[36:39], v[80:83]
    s_waitcnt lgkmcnt(4)
    ds_read_b128 a[28:31], v17 offset:18432
    s_add_u32 s4, s4, 524288
    v_mfma_f32_16x16x32_bf16 v[96:99], a[16:19], v[40:43], v[96:99]
    ds_read_b128 a[152:155], v19 offset:16384
    s_add_u32 s99, s94, 12
    s_lshl_b32 s99, s99, 12
    v_mfma_f32_16x16x32_bf16 v[100:103], a[20:23], v[40:43], v[100:103]
    ds_read_b128 a[156:159], v19 offset:18432
    s_add_u32 s15, s8, s99
    v_mfma_f32_16x16x32_bf16 v[104:107], a[144:147], v[40:43], v[104:107]
    ds_read_b64_tr_b16 v[52:53], v15 offset:20480
    buffer_load_dwordx4 v7, s[28:31], s72 offen offset:1024  lds
    v_mfma_f32_16x16x32_bf16 v[108:111], a[148:151], v[40:43], v[108:111]
    s_waitcnt lgkmcnt(4)
    ds_read_b64_tr_b16 v[54:55], v15 offset:20992
    s_add_u32 s99, s3, 4
    v_mfma_f32_16x16x32_bf16 v[124:127], a[148:151], v[44:47], v[124:127]
    ds_read_b64_tr_b16 v[56:57], v14 offset:28672
    v_dot2c_f32_bf16 v210, v212, v214
    s_lshl_b32 s99, s99, 12
    v_mfma_f32_16x16x32_bf16 v[120:123], a[144:147], v[44:47], v[120:123]
    ds_read_b64_tr_b16 v[58:59], v14 offset:29184
    s_add_u32 s8, s8, s99
    s_xor_b32 s9, s8, 2048
    v_mfma_f32_16x16x32_bf16 v[116:119], a[20:23], v[44:47], v[116:119]
    ds_read_b64_tr_b16 v[60:61], v15 offset:28672
    buffer_load_dwordx4 v8, s[28:31], s72 offen offset:2048  lds
    v_mfma_f32_16x16x32_bf16 v[112:115], a[16:19], v[44:47], v[112:115]
    ds_read_b64_tr_b16 v[62:63], v15 offset:29184
    v_dot2c_f32_bf16 v210, v213, v215
    v_mfma_f32_16x16x32_bf16 v[64:67], a[24:27], v[48:51], v[64:67]
    s_waitcnt lgkmcnt(4)
    ds_read_b64 v[212:213], v208 offset:16384
    s_lshl2_add_u32 s99, s93, s3
    v_mfma_f32_16x16x32_bf16 v[68:71], a[28:31], v[48:51], v[68:71]
    ds_read_b64 v[214:215], v209 offset:128
    s_lshl3_add_u32 s11, s99, s92
    s_lshl_b32 s11, s11, 7
    v_mfma_f32_16x16x32_bf16 v[72:75], a[152:155], v[48:51], v[72:75]
    buffer_load_dwordx4 v9, s[28:31], s72 offen offset:3072  lds
    v_mfma_f32_16x16x32_bf16 v[76:79], a[156:159], v[48:51], v[76:79]
    s_add_u32 m0, s97, 0
    s_add_u32 s11, s11, 65536
    s_cmp_eq_u32 s26, 0
    s_cselect_b32 s11, s11, 1073741824
    v_mfma_f32_16x16x32_bf16 v[92:95], a[156:159], v[52:55], v[92:95]
    s_lshl4_add_u32 s99, s99, s92
    s_lshl_b32 s13, s99, 10
    s_add_u32 s13, s13, 262144
    v_mfma_f32_16x16x32_bf16 v[88:91], a[152:155], v[52:55], v[88:91]
    s_lshl_b32 s14, s99, 7
    v_mfma_f32_16x16x32_bf16 v[84:87], a[28:31], v[52:55], v[84:87]
    buffer_load_dwordx4 v2, s[32:35], s80 offen offset:0  lds
    v_mfma_f32_16x16x32_bf16 v[80:83], a[24:27], v[52:55], v[80:83]
    s_waitcnt lgkmcnt(2)
    s_add_u32 s14, s14, 131072
    v_lshrrev_b32 v249, 6, v0
    v_mfma_f32_16x16x32_bf16 v[96:99], a[24:27], v[56:59], v[96:99]
    s_waitcnt vmcnt(15) lgkmcnt(0)
    s_barrier
    v_lshrrev_b32 v250, 5, v0
    v_mfma_f32_16x16x32_bf16 v[100:103], a[28:31], v[56:59], v[100:103]
    ds_read_b64_tr_b16 v[32:33], v14 offset:32768
    ds_read_b64_tr_b16 v[34:35], v14 offset:33280
    v_mfma_f32_16x16x32_bf16 v[104:107], a[152:155], v[56:59], v[104:107]
    ds_read_b128 a[32:35], v16 offset:32768
    buffer_load_dwordx4 v3, s[32:35], s80 offen offset:1024  lds
    v_mfma_f32_16x16x32_bf16 v[108:111], a[156:159], v[56:59], v[108:111]
    ds_read_b128 a[36:39], v16 offset:34816
    v_and_b32 v250, 16, v250
    v_mfma_f32_16x16x32_bf16 v[124:127], a[156:159], v[60:63], v[124:127]
    ds_read_b128 a[160:163], v18 offset:32768
    v_and_b32 v251, 0x30, v0
    v_mfma_f32_16x16x32_bf16 v[120:123], a[152:155], v[60:63], v[120:123]
    ds_read_b128 a[164:167], v18 offset:34816
    v_xor_b32 v250, v250, v251
    v_mfma_f32_16x16x32_bf16 v[116:119], a[28:31], v[60:63], v[116:119]
    ds_read_b64_tr_b16 v[36:37], v15 offset:32768
    buffer_load_dwordx4 v4, s[32:35], s80 offen offset:2048  lds
    v_mfma_f32_16x16x32_bf16 v[112:115], a[24:27], v[60:63], v[112:115]
    s_waitcnt lgkmcnt(4)
    ds_read_b64_tr_b16 v[38:39], v15 offset:33280
    v_mfma_f32_16x16x32_bf16 v[64:67], a[32:35], v[32:35], v[64:67]
    s_waitcnt lgkmcnt(4)
    ds_read_b64_tr_b16 v[40:41], v14 offset:40960
    v_mfma_f32_16x16x32_bf16 v[68:71], a[36:39], v[32:35], v[68:71]
    s_waitcnt lgkmcnt(3)
    ds_read_b64_tr_b16 v[42:43], v14 offset:41472
    v_mul_u32_u24 v249, 3584, v249
    v_mfma_f32_16x16x32_bf16 v[72:75], a[160:163], v[32:35], v[72:75]
    ds_read_b64_tr_b16 v[44:45], v15 offset:40960
    buffer_load_dwordx4 v5, s[32:35], s80 offen offset:3072  lds
    v_mfma_f32_16x16x32_bf16 v[76:79], a[164:167], v[32:35], v[76:79]
    s_waitcnt lgkmcnt(3)
    ds_read_b64_tr_b16 v[46:47], v15 offset:41472
    v_add_u32 v248, v249, v250
    v_add_u32 v249, 56320, v248
    v_mfma_f32_16x16x32_bf16 v[92:95], a[164:167], v[36:39], v[92:95]
    s_add_u32 m0, s96, 16384
    ds_read_b64_tr_b16 v[48:49], v14 offset:36864
    v_add_u32 v250, 112640, v248
    v_mfma_f32_16x16x32_bf16 v[88:91], a[160:163], v[36:39], v[88:91]
    ds_read_b64_tr_b16 v[50:51], v14 offset:37376
    v_add_u32 v251, 168960, v248
    v_and_b32 v243, 0xf0, v0
    v_mfma_f32_16x16x32_bf16 v[84:87], a[36:39], v[36:39], v[84:87]
    ds_read_b128 a[40:43], v17 offset:32768
    buffer_load_dwordx4 v6, s[28:31], s73 offen offset:0  lds
    v_mfma_f32_16x16x32_bf16 v[80:83], a[32:35], v[36:39], v[80:83]
    s_waitcnt lgkmcnt(4)
    ds_read_b128 a[44:47], v17 offset:34816
    v_bfe_u32 v241, v0, 8, 1
    v_mfma_f32_16x16x32_bf16 v[96:99], a[32:35], v[40:43], v[96:99]
    ds_read_b128 a[168:171], v19 offset:32768
    v_lshl_add_u32 v243, v241, 10, v243
    v_lshrrev_b32 v241, 9, v0
    v_mfma_f32_16x16x32_bf16 v[100:103], a[36:39], v[40:43], v[100:103]
    ds_read_b128 a[172:175], v19 offset:34816
    v_lshl_add_u32 v241, s101, 1, v241
    v_mfma_f32_16x16x32_bf16 v[104:107], a[160:163], v[40:43], v[104:107]
    ds_read_b64_tr_b16 v[52:53], v15 offset:36864
    buffer_load_dwordx4 v7, s[28:31], s73 offen offset:1024  lds
    v_mfma_f32_16x16x32_bf16 v[108:111], a[164:167], v[40:43], v[108:111]
    s_waitcnt lgkmcnt(4)
    ds_read_b64_tr_b16 v[54:55], v15 offset:37376
    v_lshl_add_u32 v243, v241, 8, v243
    v_mfma_f32_16x16x32_bf16 v[124:127], a[164:167], v[44:47], v[124:127]
    ds_read_b64_tr_b16 v[56:57], v14 offset:45056
    v_dot2c_f32_bf16 v210, v212, v214
    v_mfma_f32_16x16x32_bf16 v[120:123], a[160:163], v[44:47], v[120:123]
    ds_read_b64_tr_b16 v[58:59], v14 offset:45568
    s_cmp_eq_u32 s101, 0
    s_cselect_b32 s92, s84, s85
    s_cselect_b32 s93, s86, s87
    s_cselect_b32 s94, s88, s89
    s_cselect_b32 s95, s90, s91
    v_mfma_f32_16x16x32_bf16 v[116:119], a[36:39], v[44:47], v[116:119]
    ds_read_b64_tr_b16 v[60:61], v15 offset:45056
    buffer_load_dwordx4 v8, s[28:31], s73 offen offset:2048  lds
    v_mfma_f32_16x16x32_bf16 v[112:115], a[32:35], v[44:47], v[112:115]
    ds_read_b64_tr_b16 v[62:63], v15 offset:45568
    v_dot2c_f32_bf16 v210, v213, v215
    v_mfma_f32_16x16x32_bf16 v[64:67], a[40:43], v[48:51], v[64:67]
    s_waitcnt lgkmcnt(4)
    ds_read_b64 v[212:213], v208 offset:32768
    v_mfma_f32_16x16x32_bf16 v[68:71], a[44:47], v[48:51], v[68:71]
    ds_read_b64 v[214:215], v209 offset:256
    s_add_u32 s98, s20, 0
    v_mfma_f32_16x16x32_bf16 v[72:75], a[168:171], v[48:51], v[72:75]
    buffer_load_dwordx4 v9, s[28:31], s73 offen offset:3072  lds
    v_mfma_f32_16x16x32_bf16 v[76:79], a[172:175], v[48:51], v[76:79]
    s_add_u32 m0, s97, 16384
    s_and_b32 s98, s98, 3
    s_lshl_b32 s0, s98, 12
    s_add_u32 s98, s20, 1
    v_mfma_f32_16x16x32_bf16 v[92:95], a[172:175], v[52:55], v[92:95]
    s_and_b32 s98, s98, 3
    s_lshl_b32 s5, s98, 12
    s_add_u32 s98, s20, 2
    v_mfma_f32_16x16x32_bf16 v[88:91], a[168:171], v[52:55], v[88:91]
    s_and_b32 s98, s98, 3
    v_mfma_f32_16x16x32_bf16 v[84:87], a[44:47], v[52:55], v[84:87]
    buffer_load_dwordx4 v2, s[32:35], s81 offen offset:0  lds
    v_mfma_f32_16x16x32_bf16 v[80:83], a[40:43], v[52:55], v[80:83]
    s_waitcnt lgkmcnt(2)
    s_lshl_b32 s12, s98, 12
    s_add_u32 s98, s20, 3
    v_mfma_f32_16x16x32_bf16 v[96:99], a[40:43], v[56:59], v[96:99]
    s_waitcnt vmcnt(15) lgkmcnt(0)
    s_barrier
    s_and_b32 s98, s98, 3
    v_mfma_f32_16x16x32_bf16 v[100:103], a[44:47], v[56:59], v[100:103]
    ds_read_b64_tr_b16 v[32:33], v14 offset:49152
    ds_read_b64_tr_b16 v[34:35], v14 offset:49664
    v_mfma_f32_16x16x32_bf16 v[104:107], a[168:171], v[56:59], v[104:107]
    ds_read_b128 a[48:51], v16 offset:49152
    buffer_load_dwordx4 v3, s[32:35], s81 offen offset:1024  lds
    v_mfma_f32_16x16x32_bf16 v[108:111], a[172:175], v[56:59], v[108:111]
    ds_read_b128 a[52:55], v16 offset:51200
    s_lshl_b32 s16, s98, 12
    v_mfma_f32_16x16x32_bf16 v[124:127], a[172:175], v[60:63], v[124:127]
    ds_read_b128 a[176:179], v18 offset:49152
    s_and_b32 s22, s0, 4096
    v_mfma_f32_16x16x32_bf16 v[120:123], a[168:171], v[60:63], v[120:123]
    ds_read_b128 a[180:183], v18 offset:51200
    s_and_b32 s27, s5, 4096
    v_mfma_f32_16x16x32_bf16 v[116:119], a[44:47], v[60:63], v[116:119]
    ds_read_b64_tr_b16 v[36:37], v15 offset:49152
    buffer_load_dwordx4 v4, s[32:35], s81 offen offset:2048  lds
    v_mfma_f32_16x16x32_bf16 v[112:115], a[40:43], v[60:63], v[112:115]
    s_waitcnt lgkmcnt(4)
    ds_read_b64_tr_b16 v[38:39], v15 offset:49664
    v_mfma_f32_16x16x32_bf16 v[64:67], a[48:51], v[32:35], v[64:67]
    s_waitcnt lgkmcnt(4)
    ds_read_b64_tr_b16 v[40:41], v14 offset:57344
    v_mfma_f32_16x16x32_bf16 v[68:71], a[52:55], v[32:35], v[68:71]
    s_waitcnt lgkmcnt(3)
    ds_read_b64_tr_b16 v[42:43], v14 offset:57856
    v_lshrrev_b32 v135, 4, v0
    v_mfma_f32_16x16x32_bf16 v[72:75], a[176:179], v[32:35], v[72:75]
    ds_read_b64_tr_b16 v[44:45], v15 offset:57344
    buffer_load_dwordx4 v5, s[32:35], s81 offen offset:3072  lds
    v_mfma_f32_16x16x32_bf16 v[76:79], a[180:183], v[32:35], v[76:79]
    s_waitcnt lgkmcnt(3)
    ds_read_b64_tr_b16 v[46:47], v15 offset:57856
    v_add_u32 v132, s20, v135
    s_mov_b32 s24, 0x3000
    v_mfma_f32_16x16x32_bf16 v[92:95], a[180:183], v[36:39], v[92:95]
    s_add_u32 m0, s96, 32768
    ds_read_b64_tr_b16 v[48:49], v14 offset:53248
    s_mov_b32 s25, 0
    v_mfma_f32_16x16x32_bf16 v[88:91], a[176:179], v[36:39], v[88:91]
    ds_read_b64_tr_b16 v[50:51], v14 offset:53760
    v_cndmask_b32 v133, 3, 1, s[24:25]
    v_bfi_b32 v132, v133, v132, v135
    v_mfma_f32_16x16x32_bf16 v[84:87], a[52:55], v[36:39], v[84:87]
    ds_read_b128 a[56:59], v17 offset:49152
    buffer_load_dwordx4 v6, s[28:31], s74 offen offset:0  lds
    v_mfma_f32_16x16x32_bf16 v[80:83], a[48:51], v[36:39], v[80:83]
    s_waitcnt lgkmcnt(4)
    ds_read_b128 a[60:63], v17 offset:51200
    v_lshrrev_b32 v133, 1, v132
    v_mfma_f32_16x16x32_bf16 v[96:99], a[48:51], v[40:43], v[96:99]
    ds_read_b128 a[184:187], v19 offset:49152
    v_lshl_add_u32 v134, s26, 1, v133
    v_lshl_add_u32 v134, v134, 2, 3
    v_mfma_f32_16x16x32_bf16 v[100:103], a[52:55], v[40:43], v[100:103]
    ds_read_b128 a[188:191], v19 offset:51200
    v_xor_b32 v134, 16, v134
    v_mfma_f32_16x16x32_bf16 v[104:107], a[176:179], v[40:43], v[104:107]
    ds_read_b64_tr_b16 v[52:53], v15 offset:53248
    buffer_load_dwordx4 v7, s[28:31], s74 offen offset:1024  lds
    v_mfma_f32_16x16x32_bf16 v[108:111], a[180:183], v[40:43], v[108:111]
    s_waitcnt lgkmcnt(4)
    ds_read_b64_tr_b16 v[54:55], v15 offset:53760
    v_mfma_f32_16x16x32_bf16 v[124:127], a[180:183], v[44:47], v[124:127]
    ds_read_b64_tr_b16 v[56:57], v14 offset:61440
    v_dot2c_f32_bf16 v210, v212, v214
    v_cmp_eq_u32 s[24:25], 31, v134
    v_mfma_f32_16x16x32_bf16 v[120:123], a[176:179], v[44:47], v[120:123]
    ds_read_b64_tr_b16 v[58:59], v14 offset:61952
    s_mul_i32 s98, s26, 5
    s_sub_u32 s98, s98, 2
    v_mfma_f32_16x16x32_bf16 v[116:119], a[52:55], v[44:47], v[116:119]
    ds_read_b64_tr_b16 v[60:61], v15 offset:61440
    buffer_load_dwordx4 v8, s[28:31], s74 offen offset:2048  lds
    v_mfma_f32_16x16x32_bf16 v[112:115], a[48:51], v[44:47], v[112:115]
    ds_read_b64_tr_b16 v[62:63], v15 offset:61952
    v_dot2c_f32_bf16 v210, v213, v215
    v_cndmask_b32 v134, v134, 26, s[24:25]
    v_mfma_f32_16x16x32_bf16 v[64:67], a[56:59], v[48:51], v[64:67]
    s_waitcnt lgkmcnt(4)
    ds_read_b64 v[212:213], v208 offset:49152
    v_add_u32 v133, s98, v133
    v_mfma_f32_16x16x32_bf16 v[68:71], a[60:63], v[48:51], v[68:71]
    ds_read_b64 v[214:215], v209 offset:384
    v_mul_u32_u24 v23, 11, v133
    v_lshrrev_b32 v23, 5, v23
    v_mfma_f32_16x16x32_bf16 v[72:75], a[184:187], v[48:51], v[72:75]
    buffer_load_dwordx4 v9, s[28:31], s74 offen offset:3072  lds
    v_mfma_f32_16x16x32_bf16 v[76:79], a[188:191], v[48:51], v[76:79]
    s_add_u32 m0, s97, 32768
    v_add_u32 v133, v133, v23
    s_mov_b32 s24, 15
    s_mov_b32 s25, 0
    v_mfma_f32_16x16x32_bf16 v[92:95], a[188:191], v[52:55], v[92:95]
    v_cndmask_b32 v133, v133, v134, s[24:25]
    v_and_b32 v132, 1, v132
    v_mfma_f32_16x16x32_bf16 v[88:91], a[184:187], v[52:55], v[88:91]
    v_lshl_add_u32 v132, v133, 1, v132
    v_lshlrev_b32 v23, 15, v132
    v_mfma_f32_16x16x32_bf16 v[84:87], a[60:63], v[52:55], v[84:87]
    buffer_load_dwordx4 v2, s[32:35], s82 offen offset:0  lds
    v_mfma_f32_16x16x32_bf16 v[80:83], a[56:59], v[52:55], v[80:83]
    s_waitcnt lgkmcnt(2)
    v_add_u32 v228, s97, v0
    v_add_u32 v228, 147456, v228
    v_mfma_f32_16x16x32_bf16 v[96:99], a[56:59], v[56:59], v[96:99]
    s_waitcnt vmcnt(13) lgkmcnt(0)
    s_barrier
    v_xor_b32 v229, 0x2000, v228
    v_mfma_f32_16x16x32_bf16 v[100:103], a[60:63], v[56:59], v[100:103]
    ds_read_b64_tr_b16 v[32:33], v14 offset:0
    ds_read_b64_tr_b16 v[34:35], v14 offset:512
    v_mfma_f32_16x16x32_bf16 v[104:107], a[184:187], v[56:59], v[104:107]
    ds_read_b128 a[64:67], v16 offset:0
    buffer_load_dwordx4 v3, s[32:35], s82 offen offset:1024  lds
    v_mfma_f32_16x16x32_bf16 v[108:111], a[188:191], v[56:59], v[108:111]
    ds_read_b128 a[68:71], v16 offset:2048
    v_lshrrev_b32 v230, 9, v0
    v_mfma_f32_16x16x32_bf16 v[124:127], a[188:191], v[60:63], v[124:127]
    ds_read_b128 a[192:195], v18 offset:0
    v_xor_b32 v230, s100, v230
    v_mfma_f32_16x16x32_bf16 v[120:123], a[184:187], v[60:63], v[120:123]
    ds_read_b128 a[196:199], v18 offset:2048
    v_lshl_add_u32 v230, v230, 30, v0
    v_mfma_f32_16x16x32_bf16 v[116:119], a[60:63], v[60:63], v[116:119]
    ds_read_b64_tr_b16 v[36:37], v15 offset:0
    buffer_load_dwordx4 v4, s[32:35], s82 offen offset:2048  lds
    v_mfma_f32_16x16x32_bf16 v[112:115], a[56:59], v[60:63], v[112:115]
    s_waitcnt lgkmcnt(4)
    ds_read_b64_tr_b16 v[38:39], v15 offset:512
    v_mfma_f32_16x16x32_bf16 v[64:67], a[64:67], v[32:35], v[64:67]
    s_waitcnt lgkmcnt(4)
    ds_read_b64_tr_b16 v[40:41], v14 offset:8192
    v_mfma_f32_16x16x32_bf16 v[68:71], a[68:71], v[32:35], v[68:71]
    s_waitcnt lgkmcnt(3)
    ds_read_b64_tr_b16 v[42:43], v14 offset:8704
    v_lshrrev_b32 v231, 1, v0
    v_mfma_f32_16x16x32_bf16 v[72:75], a[192:195], v[32:35], v[72:75]
    ds_read_b64_tr_b16 v[44:45], v15 offset:8192
    buffer_load_dwordx4 v5, s[32:35], s82 offen offset:3072  lds
    v_mfma_f32_16x16x32_bf16 v[76:79], a[196:199], v[32:35], v[76:79]
    s_waitcnt lgkmcnt(3)
    ds_read_b64_tr_b16 v[46:47], v15 offset:8704
    v_and_b32 v231, 0x78, v231
    v_mov_b32 v220, 0x3f803f80
    v_mfma_f32_16x16x32_bf16 v[92:95], a[196:199], v[36:39], v[92:95]
    s_add_u32 m0, s96, 49152
    ds_read_b64_tr_b16 v[48:49], v14 offset:4096
    v_mov_b32 v221, 0x3f803f80
    v_mfma_f32_16x16x32_bf16 v[88:91], a[192:195], v[36:39], v[88:91]
    ds_read_b64_tr_b16 v[50:51], v14 offset:4608
    v_mov_b32 v222, 0x3f803f80
    v_mov_b32 v223, 0x3f803f80
    v_mfma_f32_16x16x32_bf16 v[84:87], a[68:71], v[36:39], v[84:87]
    ds_read_b128 a[72:75], v17 offset:0
    buffer_load_dwordx4 v6, s[28:31], s75 offen offset:0  lds
    v_mfma_f32_16x16x32_bf16 v[80:83], a[64:67], v[36:39], v[80:83]
    s_waitcnt lgkmcnt(4)
    ds_read_b128 a[76:79], v17 offset:2048
L_padK0:
    s_cbranch_execz L_padK4
    v_mfma_f32_16x16x32_bf16 v[96:99], a[64:67], v[40:43], v[96:99]
    ds_read_b128 a[200:203], v19 offset:0
    v_mfma_f32_16x16x32_bf16 v[100:103], a[68:71], v[40:43], v[100:103]
    ds_read_b128 a[204:207], v19 offset:2048
    v_mfma_f32_16x16x32_bf16 v[104:107], a[192:195], v[40:43], v[104:107]
    ds_read_b64_tr_b16 v[52:53], v15 offset:4096
    buffer_load_dwordx4 v7, s[28:31], s75 offen offset:1024  lds
    v_mfma_f32_16x16x32_bf16 v[108:111], a[196:199], v[40:43], v[108:111]
    s_waitcnt lgkmcnt(4)
    ds_read_b64_tr_b16 v[54:55], v15 offset:4608
    v_mfma_f32_16x16x32_bf16 v[124:127], a[196:199], v[44:47], v[124:127]
    ds_read_b64_tr_b16 v[56:57], v14 offset:12288
    v_dot2c_f32_bf16 v210, v212, v214
    v_mfma_f32_16x16x32_bf16 v[120:123], a[192:195], v[44:47], v[120:123]
    ds_read_b64_tr_b16 v[58:59], v14 offset:12800
    v_mfma_f32_16x16x32_bf16 v[116:119], a[68:71], v[44:47], v[116:119]
    ds_read_b64_tr_b16 v[60:61], v15 offset:12288
    buffer_load_dwordx4 v8, s[28:31], s75 offen offset:2048  lds
    v_mfma_f32_16x16x32_bf16 v[112:115], a[64:67], v[44:47], v[112:115]
    ds_read_b64_tr_b16 v[62:63], v15 offset:12800
    v_dot2c_f32_bf16 v210, v213, v215
    v_mfma_f32_16x16x32_bf16 v[64:67], a[72:75], v[48:51], v[64:67]
    s_waitcnt lgkmcnt(4)
    ds_read_b64 v[212:213], v208 offset:0
    v_mfma_f32_16x16x32_bf16 v[68:71], a[76:79], v[48:51], v[68:71]
    ds_read_b64 v[214:215], v209 offset:512
    v_mfma_f32_16x16x32_bf16 v[72:75], a[200:203], v[48:51], v[72:75]
    buffer_load_dwordx4 v9, s[28:31], s75 offen offset:3072  lds
    v_mfma_f32_16x16x32_bf16 v[76:79], a[204:207], v[48:51], v[76:79]
    s_add_u32 m0, s97, 49152
    v_mfma_f32_16x16x32_bf16 v[92:95], a[204:207], v[52:55], v[92:95]
    v_mfma_f32_16x16x32_bf16 v[88:91], a[200:203], v[52:55], v[88:91]
    v_mfma_f32_16x16x32_bf16 v[84:87], a[76:79], v[52:55], v[84:87]
    buffer_load_dwordx4 v2, s[32:35], s83 offen offset:0  lds
    v_mfma_f32_16x16x32_bf16 v[80:83], a[72:75], v[52:55], v[80:83]
    s_waitcnt lgkmcnt(2)
    v_mfma_f32_16x16x32_bf16 v[96:99], a[72:75], v[56:59], v[96:99]
    s_waitcnt vmcnt(13) lgkmcnt(0)
    s_barrier
    v_mfma_f32_16x16x32_bf16 v[100:103], a[76:79], v[56:59], v[100:103]
    ds_read_b64_tr_b16 v[32:33], v14 offset:16384
    ds_read_b64_tr_b16 v[34:35], v14 offset:16896
    v_mfma_f32_16x16x32_bf16 v[104:107], a[200:203], v[56:59], v[104:107]
    ds_read_b128 a[80:83], v16 offset:16384
    buffer_load_dwordx4 v3, s[32:35], s83 offen offset:1024  lds
    v_mfma_f32_16x16x32_bf16 v[108:111], a[204:207], v[56:59], v[108:111]
    ds_read_b128 a[84:87], v16 offset:18432
    v_mfma_f32_16x16x32_bf16 v[124:127], a[204:207], v[60:63], v[124:127]
    ds_read_b128 a[208:211], v18 offset:16384
    v_mfma_f32_16x16x32_bf16 v[120:123], a[200:203], v[60:63], v[120:123]
    ds_read_b128 a[212:215], v18 offset:18432
    v_mfma_f32_16x16x32_bf16 v[116:119], a[76:79], v[60:63], v[116:119]
    ds_read_b64_tr_b16 v[36:37], v15 offset:16384
    buffer_load_dwordx4 v4, s[32:35], s83 offen offset:2048  lds
    v_mfma_f32_16x16x32_bf16 v[112:115], a[72:75], v[60:63], v[112:115]
    s_waitcnt lgkmcnt(4)
    ds_read_b64_tr_b16 v[38:39], v15 offset:16896
    v_mfma_f32_16x16x32_bf16 v[64:67], a[80:83], v[32:35], v[64:67]
    s_waitcnt lgkmcnt(4)
    ds_read_b64_tr_b16 v[40:41], v14 offset:24576
    v_mfma_f32_16x16x32_bf16 v[68:71], a[84:87], v[32:35], v[68:71]
    s_waitcnt lgkmcnt(3)
    ds_read_b64_tr_b16 v[42:43], v14 offset:25088
    v_mfma_f32_16x16x32_bf16 v[72:75], a[208:211], v[32:35], v[72:75]
    ds_read_b64_tr_b16 v[44:45], v15 offset:24576
    buffer_load_dwordx4 v5, s[32:35], s83 offen offset:3072  lds
    v_mfma_f32_16x16x32_bf16 v[76:79], a[212:215], v[32:35], v[76:79]
    s_waitcnt lgkmcnt(3)
    ds_read_b64_tr_b16 v[46:47], v15 offset:25088
    v_mfma_f32_16x16x32_bf16 v[92:95], a[212:215], v[36:39], v[92:95]
    s_add_u32 m0, s97, 0
    ds_read_b64_tr_b16 v[48:49], v14 offset:20480
    v_mfma_f32_16x16x32_bf16 v[88:91], a[208:211], v[36:39], v[88:91]
    ds_read_b64_tr_b16 v[50:51], v14 offset:20992
    v_mfma_f32_16x16x32_bf16 v[84:87], a[84:87], v[36:39], v[84:87]
    ds_read_b128 a[88:91], v17 offset:16384
    buffer_load_dwordx4 v252, s[36:39], s84 offen offset:0  lds
    v_mfma_f32_16x16x32_bf16 v[80:83], a[80:83], v[36:39], v[80:83]
    s_waitcnt lgkmcnt(4)
    ds_read_b128 a[92:95], v17 offset:18432
    v_mfma_f32_16x16x32_bf16 v[96:99], a[80:83], v[40:43], v[96:99]
    ds_read_b128 a[216:219], v19 offset:16384
    buffer_load_dwordx2 v[20:21], off, s[60:63], 0 sc1
    v_mfma_f32_16x16x32_bf16 v[100:103], a[84:87], v[40:43], v[100:103]
    ds_read_b128 a[220:223], v19 offset:18432
    v_mfma_f32_16x16x32_bf16 v[104:107], a[208:211], v[40:43], v[104:107]
    ds_read_b64_tr_b16 v[52:53], v15 offset:20480
    buffer_load_dwordx4 v253, s[36:39], s84 offen offset:1024  lds
    v_mfma_f32_16x16x32_bf16 v[108:111], a[212:215], v[40:43], v[108:111]
    s_waitcnt lgkmcnt(4)
    ds_read_b64_tr_b16 v[54:55], v15 offset:20992
    v_mfma_f32_16x16x32_bf16 v[124:127], a[212:215], v[44:47], v[124:127]
    ds_read_b64_tr_b16 v[56:57], v14 offset:28672
    v_dot2c_f32_bf16 v210, v212, v214
    v_mfma_f32_16x16x32_bf16 v[120:123], a[208:211], v[44:47], v[120:123]
    ds_read_b64_tr_b16 v[58:59], v14 offset:29184
    v_readlane_b32 s68, v23, 0
    v_mfma_f32_16x16x32_bf16 v[116:119], a[84:87], v[44:47], v[116:119]
    ds_read_b64_tr_b16 v[60:61], v15 offset:28672
    buffer_load_dwordx4 v254, s[36:39], s84 offen offset:2048  lds
    v_mfma_f32_16x16x32_bf16 v[112:115], a[80:83], v[44:47], v[112:115]
    ds_read_b64_tr_b16 v[62:63], v15 offset:29184
    v_dot2c_f32_bf16 v210, v213, v215
    v_mfma_f32_16x16x32_bf16 v[64:67], a[88:91], v[48:51], v[64:67]
    s_waitcnt lgkmcnt(4)
    ds_read_b64 v[212:213], v208 offset:16384
    v_mfma_f32_16x16x32_bf16 v[68:71], a[92:95], v[48:51], v[68:71]
    ds_read_b64 v[214:215], v209 offset:640
    v_readlane_b32 s69, v23, 1
    v_mfma_f32_16x16x32_bf16 v[72:75], a[216:219], v[48:51], v[72:75]
    buffer_load_dwordx4 v255, s[36:39], s84 offen offset:3072  lds
    v_mfma_f32_16x16x32_bf16 v[76:79], a[220:223], v[48:51], v[76:79]
    v_readlane_b32 s70, v23, 2
    v_readlane_b32 s71, v23, 3
    v_mfma_f32_16x16x32_bf16 v[92:95], a[220:223], v[52:55], v[92:95]
    buffer_load_dword v244, v244, s[48:51], 0 offen offset:384
    v_mfma_f32_16x16x32_bf16 v[88:91], a[216:219], v[52:55], v[88:91]
    v_readlane_b32 s72, v23, 4
    v_readlane_b32 s73, v23, 5
    v_mfma_f32_16x16x32_bf16 v[84:87], a[92:95], v[52:55], v[84:87]
    buffer_load_dword v245, v245, s[52:55], 0 offen offset:384
    v_mfma_f32_16x16x32_bf16 v[80:83], a[88:91], v[52:55], v[80:83]
    s_waitcnt lgkmcnt(2)
    v_readlane_b32 s74, v23, 6
    v_mfma_f32_16x16x32_bf16 v[96:99], a[88:91], v[56:59], v[96:99]
    s_waitcnt vmcnt(15) lgkmcnt(0)
    s_barrier
    v_readlane_b32 s75, v23, 7
    v_mfma_f32_16x16x32_bf16 v[100:103], a[92:95], v[56:59], v[100:103]
    ds_read_b64_tr_b16 v[32:33], v14 offset:32768
    ds_read_b64_tr_b16 v[34:35], v14 offset:33280
    v_mfma_f32_16x16x32_bf16 v[104:107], a[216:219], v[56:59], v[104:107]
    ds_read_b128 a[96:99], v16 offset:32768
    v_readlane_b32 s76, v23, 8
    v_mfma_f32_16x16x32_bf16 v[108:111], a[220:223], v[56:59], v[108:111]
    ds_read_b128 a[100:103], v16 offset:34816
    v_mfma_f32_16x16x32_bf16 v[124:127], a[220:223], v[60:63], v[124:127]
    ds_read_b128 a[224:227], v18 offset:32768
    v_readlane_b32 s77, v23, 9
    v_mfma_f32_16x16x32_bf16 v[120:123], a[216:219], v[60:63], v[120:123]
    ds_read_b128 a[228:231], v18 offset:34816
    v_mfma_f32_16x16x32_bf16 v[116:119], a[92:95], v[60:63], v[116:119]
    ds_read_b64_tr_b16 v[36:37], v15 offset:32768
    v_readlane_b32 s78, v23, 10
    v_mfma_f32_16x16x32_bf16 v[112:115], a[88:91], v[60:63], v[112:115]
    s_waitcnt lgkmcnt(4)
    ds_read_b64_tr_b16 v[38:39], v15 offset:33280
    v_mfma_f32_16x16x32_bf16 v[64:67], a[96:99], v[32:35], v[64:67]
    s_waitcnt lgkmcnt(4)
    ds_read_b64_tr_b16 v[40:41], v14 offset:40960
    v_mfma_f32_16x16x32_bf16 v[68:71], a[100:103], v[32:35], v[68:71]
    s_waitcnt lgkmcnt(4)
    ds_read_b64_tr_b16 v[42:43], v14 offset:41472
    v_mfma_f32_16x16x32_bf16 v[72:75], a[224:227], v[32:35], v[72:75]
    s_waitcnt lgkmcnt(4)
    ds_read_b64_tr_b16 v[44:45], v15 offset:40960
    v_mfma_f32_16x16x32_bf16 v[76:79], a[228:231], v[32:35], v[76:79]
    s_waitcnt lgkmcnt(3)
    ds_read_b64_tr_b16 v[46:47], v15 offset:41472
    v_mfma_f32_16x16x32_bf16 v[92:95], a[228:231], v[36:39], v[92:95]
    ds_read_b64_tr_b16 v[48:49], v14 offset:36864
    v_readlane_b32 s79, v23, 11
    v_mfma_f32_16x16x32_bf16 v[88:91], a[224:227], v[36:39], v[88:91]
    ds_read_b64_tr_b16 v[50:51], v14 offset:37376
    v_readlane_b32 s80, v23, 12
    v_mfma_f32_16x16x32_bf16 v[84:87], a[100:103], v[36:39], v[84:87]
    ds_read_b128 a[104:107], v17 offset:32768
    v_readlane_b32 s81, v23, 13
    v_mfma_f32_16x16x32_bf16 v[80:83], a[96:99], v[36:39], v[80:83]
    s_waitcnt lgkmcnt(4)
    ds_read_b128 a[108:111], v17 offset:34816
    v_mfma_f32_16x16x32_bf16 v[96:99], a[96:99], v[40:43], v[96:99]
    ds_read_b128 a[232:235], v19 offset:32768
    v_mfma_f32_16x16x32_bf16 v[100:103], a[100:103], v[40:43], v[100:103]
    ds_read_b128 a[236:239], v19 offset:34816
    v_mfma_f32_16x16x32_bf16 v[104:107], a[224:227], v[40:43], v[104:107]
    ds_read_b64_tr_b16 v[52:53], v15 offset:36864
    v_dot2c_f32_bf16 v210, v212, v214
    v_mfma_f32_16x16x32_bf16 v[108:111], a[228:231], v[40:43], v[108:111]
    s_waitcnt lgkmcnt(4)
    ds_read_b64_tr_b16 v[54:55], v15 offset:37376
    v_mfma_f32_16x16x32_bf16 v[124:127], a[228:231], v[44:47], v[124:127]
    ds_read_b64_tr_b16 v[56:57], v14 offset:45056
    v_dot2c_f32_bf16 v210, v213, v215
    v_mfma_f32_16x16x32_bf16 v[120:123], a[224:227], v[44:47], v[120:123]
    ds_read_b64_tr_b16 v[58:59], v14 offset:45568
    v_mfma_f32_16x16x32_bf16 v[116:119], a[100:103], v[44:47], v[116:119]
    ds_read_b64_tr_b16 v[60:61], v15 offset:45056
    v_mfma_f32_16x16x32_bf16 v[112:115], a[96:99], v[44:47], v[112:115]
    ds_read_b64_tr_b16 v[62:63], v15 offset:45568
    v_mfma_f32_16x16x32_bf16 v[64:67], a[104:107], v[48:51], v[64:67]
    s_waitcnt lgkmcnt(4)
    ds_read_b64 v[212:213], v208 offset:32768
    v_mfma_f32_16x16x32_bf16 v[68:71], a[108:111], v[48:51], v[68:71]
    s_add_u32 m0, s97, 16384
    ds_read_b64 v[214:215], v209 offset:768
    v_mfma_f32_16x16x32_bf16 v[72:75], a[232:235], v[48:51], v[72:75]
    v_mfma_f32_16x16x32_bf16 v[76:79], a[236:239], v[48:51], v[76:79]
    v_mfma_f32_16x16x32_bf16 v[92:95], a[236:239], v[52:55], v[92:95]
    v_mfma_f32_16x16x32_bf16 v[88:91], a[232:235], v[52:55], v[88:91]
    v_mfma_f32_16x16x32_bf16 v[84:87], a[108:111], v[52:55], v[84:87]
    buffer_load_dwordx4 v252, s[36:39], s85 offen offset:0  lds
    v_mfma_f32_16x16x32_bf16 v[80:83], a[104:107], v[52:55], v[80:83]
    s_waitcnt lgkmcnt(2)
    v_mfma_f32_16x16x32_bf16 v[96:99], a[104:107], v[56:59], v[96:99]
    s_waitcnt vmcnt(8) lgkmcnt(0)
    s_barrier
    v_mfma_f32_16x16x32_bf16 v[100:103], a[108:111], v[56:59], v[100:103]
    ds_read_b64_tr_b16 v[32:33], v14 offset:49152
    ds_read_b64_tr_b16 v[34:35], v14 offset:49664
    v_mfma_f32_16x16x32_bf16 v[104:107], a[232:235], v[56:59], v[104:107]
    ds_read_b128 a[112:115], v16 offset:49152
    buffer_load_dwordx4 v253, s[36:39], s85 offen offset:1024  lds
    v_mfma_f32_16x16x32_bf16 v[108:111], a[236:239], v[56:59], v[108:111]
    ds_read_b128 a[116:119], v16 offset:51200
    v_mfma_f32_16x16x32_bf16 v[124:127], a[236:239], v[60:63], v[124:127]
    ds_read_b128 a[240:243], v18 offset:49152
    v_mfma_f32_16x16x32_bf16 v[120:123], a[232:235], v[60:63], v[120:123]
    ds_read_b128 a[244:247], v18 offset:51200
    v_mfma_f32_16x16x32_bf16 v[116:119], a[108:111], v[60:63], v[116:119]
    ds_read_b64_tr_b16 v[36:37], v15 offset:49152
    buffer_load_dwordx4 v254, s[36:39], s85 offen offset:2048  lds
    v_mfma_f32_16x16x32_bf16 v[112:115], a[104:107], v[60:63], v[112:115]
    s_waitcnt lgkmcnt(4)
    ds_read_b64_tr_b16 v[38:39], v15 offset:49664
    v_mfma_f32_16x16x32_bf16 v[64:67], a[112:115], v[32:35], v[64:67]
    s_waitcnt lgkmcnt(4)
    ds_read_b64_tr_b16 v[40:41], v14 offset:57344
    v_mfma_f32_16x16x32_bf16 v[68:71], a[116:119], v[32:35], v[68:71]
    s_waitcnt lgkmcnt(3)
    ds_read_b64_tr_b16 v[42:43], v14 offset:57856
    v_mfma_f32_16x16x32_bf16 v[72:75], a[240:243], v[32:35], v[72:75]
    ds_read_b64_tr_b16 v[44:45], v15 offset:57344
    buffer_load_dwordx4 v255, s[36:39], s85 offen offset:3072  lds
    v_mfma_f32_16x16x32_bf16 v[76:79], a[244:247], v[32:35], v[76:79]
    s_waitcnt lgkmcnt(3)
    ds_read_b64_tr_b16 v[46:47], v15 offset:57856
    v_mfma_f32_16x16x32_bf16 v[92:95], a[244:247], v[36:39], v[92:95]
    s_add_u32 m0, s97, 32768
    ds_read_b64_tr_b16 v[48:49], v14 offset:53248
    v_mfma_f32_16x16x32_bf16 v[88:91], a[240:243], v[36:39], v[88:91]
    ds_read_b64_tr_b16 v[50:51], v14 offset:53760
    v_mfma_f32_16x16x32_bf16 v[84:87], a[116:119], v[36:39], v[84:87]
    ds_read_b128 a[120:123], v17 offset:49152
    buffer_load_dwordx4 v252, s[36:39], s86 offen offset:0  lds
    v_mfma_f32_16x16x32_bf16 v[80:83], a[112:115], v[36:39], v[80:83]
    s_waitcnt lgkmcnt(4)
    ds_read_b128 a[124:127], v17 offset:51200
    v_mfma_f32_16x16x32_bf16 v[96:99], a[112:115], v[40:43], v[96:99]
    ds_read_b128 a[248:251], v19 offset:49152
    v_mfma_f32_16x16x32_bf16 v[100:103], a[116:119], v[40:43], v[100:103]
    ds_read_b128 a[252:255], v19 offset:51200
    v_mfma_f32_16x16x32_bf16 v[104:107], a[240:243], v[40:43], v[104:107]
    ds_read_b64_tr_b16 v[52:53], v15 offset:53248
    buffer_load_dwordx4 v253, s[36:39], s86 offen offset:1024  lds
    v_mfma_f32_16x16x32_bf16 v[108:111], a[244:247], v[40:43], v[108:111]
    s_waitcnt lgkmcnt(4)
    ds_read_b64_tr_b16 v[54:55], v15 offset:53760
    v_mfma_f32_16x16x32_bf16 v[124:127], a[244:247], v[44:47], v[124:127]
    ds_read_b64_tr_b16 v[56:57], v14 offset:61440
    v_dot2c_f32_bf16 v210, v212, v214
    v_mfma_f32_16x16x32_bf16 v[120:123], a[240:243], v[44:47], v[120:123]
    ds_read_b64_tr_b16 v[58:59], v14 offset:61952
    v_mfma_f32_16x16x32_bf16 v[116:119], a[116:119], v[44:47], v[116:119]
    ds_read_b64_tr_b16 v[60:61], v15 offset:61440
    buffer_load_dwordx4 v254, s[36:39], s86 offen offset:2048  lds
    v_mfma_f32_16x16x32_bf16 v[112:115], a[112:115], v[44:47], v[112:115]
    ds_read_b64_tr_b16 v[62:63], v15 offset:61952
    v_dot2c_f32_bf16 v210, v213, v215
    v_mfma_f32_16x16x32_bf16 v[64:67], a[120:123], v[48:51], v[64:67]
    s_waitcnt lgkmcnt(4)
    ds_read_b64 v[212:213], v208 offset:49152
    v_mfma_f32_16x16x32_bf16 v[68:71], a[124:127], v[48:51], v[68:71]
    ds_read_b64 v[214:215], v209 offset:896
    v_mfma_f32_16x16x32_bf16 v[72:75], a[248:251], v[48:51], v[72:75]
    buffer_load_dwordx4 v255, s[36:39], s86 offen offset:3072  lds
    v_mfma_f32_16x16x32_bf16 v[76:79], a[252:255], v[48:51], v[76:79]
    v_mfma_f32_16x16x32_bf16 v[92:95], a[252:255], v[52:55], v[92:95]
    v_mfma_f32_16x16x32_bf16 v[88:91], a[248:251], v[52:55], v[88:91]
    s_add_u32 m0, s97, 49152
    v_mfma_f32_16x16x32_bf16 v[84:87], a[124:127], v[52:55], v[84:87]
    v_mfma_f32_16x16x32_bf16 v[80:83], a[120:123], v[52:55], v[80:83]
    s_waitcnt lgkmcnt(2)
    v_mfma_f32_16x16x32_bf16 v[96:99], a[120:123], v[56:59], v[96:99]
    s_waitcnt vmcnt(10) lgkmcnt(0)
    s_barrier
    v_mfma_f32_16x16x32_bf16 v[100:103], a[124:127], v[56:59], v[100:103]
    ds_read_b64_tr_b16 v[32:33], v14 offset:0
    v_mfma_f32_16x16x32_bf16 v[104:107], a[248:251], v[56:59], v[104:107]
    buffer_load_dwordx4 v252, s[36:39], s87 offen offset:0  lds
    v_mfma_f32_16x16x32_bf16 v[108:111], a[252:255], v[56:59], v[108:111]
    ds_read_b64_tr_b16 v[34:35], v14 offset:512
    v_mfma_f32_16x16x32_bf16 v[124:127], a[252:255], v[60:63], v[124:127]
    ds_read_b64_tr_b16 v[36:37], v15 offset:0
    v_mfma_f32_16x16x32_bf16 v[120:123], a[248:251], v[60:63], v[120:123]
    ds_read_b64_tr_b16 v[38:39], v15 offset:512
    v_mfma_f32_16x16x32_bf16 v[116:119], a[124:127], v[60:63], v[116:119]
    buffer_load_dwordx4 v253, s[36:39], s87 offen offset:1024  lds
    v_mfma_f32_16x16x32_bf16 v[112:115], a[120:123], v[60:63], v[112:115]
    s_waitcnt lgkmcnt(2)
    ds_read_b64_tr_b16 v[40:41], v14 offset:8192
    v_mfma_f32_16x16x32_bf16 v[128:131], v[32:35], a[0:3], 0
    ds_read_b64_tr_b16 v[42:43], v14 offset:8704
    v_mfma_f32_16x16x32_bf16 v[136:139], v[32:35], a[4:7], 0
    ds_read_b64_tr_b16 v[44:45], v15 offset:8192
    v_mfma_f32_16x16x32_bf16 v[144:147], v[32:35], a[128:131], 0
    buffer_load_dwordx4 v254, s[36:39], s87 offen offset:2048  lds
    v_mfma_f32_16x16x32_bf16 v[152:155], v[32:35], a[132:135], 0
    s_waitcnt lgkmcnt(3)
    ds_read_b64_tr_b16 v[46:47], v15 offset:8704
    v_mfma_f32_16x16x32_bf16 v[156:159], v[36:39], a[132:135], 0
    ds_read_b64_tr_b16 v[48:49], v14 offset:4096
    v_mfma_f32_16x16x32_bf16 v[148:151], v[36:39], a[128:131], 0
    ds_read_b64_tr_b16 v[50:51], v14 offset:4608
    v_mfma_f32_16x16x32_bf16 v[140:143], v[36:39], a[4:7], 0
    buffer_load_dwordx4 v255, s[36:39], s87 offen offset:3072  lds
    v_mfma_f32_16x16x32_bf16 v[132:135], v[36:39], a[0:3], 0
    s_waitcnt lgkmcnt(3)
    ds_read_b64_tr_b16 v[52:53], v15 offset:4096
    v_mfma_f32_16x16x32_bf16 v[160:163], v[40:43], a[0:3], 0
    s_add_u32 m0, s97, 81920
    ds_read_b64_tr_b16 v[54:55], v15 offset:4608
    v_mfma_f32_16x16x32_bf16 v[168:171], v[40:43], a[4:7], 0
    ds_read_b64_tr_b16 v[56:57], v14 offset:12288
    v_mfma_f32_16x16x32_bf16 v[176:179], v[40:43], a[128:131], 0
    buffer_load_dwordx4 v10, s[48:51], s68 offen offset:0 sc1 lds
    v_mfma_f32_16x16x32_bf16 v[184:187], v[40:43], a[132:135], 0
    s_waitcnt lgkmcnt(3)
    ds_read_b64_tr_b16 v[58:59], v14 offset:12800
    v_mfma_f32_16x16x32_bf16 v[188:191], v[44:47], a[132:135], 0
    ds_read_b64_tr_b16 v[60:61], v15 offset:12288
    v_dot2c_f32_bf16 v210, v212, v214
    v_mfma_f32_16x16x32_bf16 v[180:183], v[44:47], a[128:131], 0
    ds_read_b64_tr_b16 v[62:63], v15 offset:12800
    v_mfma_f32_16x16x32_bf16 v[172:175], v[44:47], a[4:7], 0
    buffer_load_dwordx4 v11, s[48:51], s68 offen offset:1024 sc1 lds
    v_mfma_f32_16x16x32_bf16 v[164:167], v[44:47], a[0:3], 0
    v_dot2c_f32_bf16 v210, v213, v215
    v_mfma_f32_16x16x32_bf16 v[128:131], v[48:51], a[8:11], v[128:131]
    v_readfirstlane_b32 s6, v20
    v_readfirstlane_b32 s7, v21
    s_nop 0
    s_cmp_lg_u32 s7, 0
    s_cbranch_scc0 L_slow_tagK
L_back_tagK:
    v_lshlrev_b32 v6, 3, v0
    v_and_b32 v6, 0x180, v6
    v_mfma_f32_16x16x32_bf16 v[136:139], v[48:51], a[12:15], v[136:139]
    v_add_f32_dpp v210, v210, v210 row_shr:1 row_mask:0xf bank_mask:0xf bound_ctrl:0
    v_mul_f32 v224, 0x3fb8aa3b, v64
    v_mfma_f32_16x16x32_bf16 v[144:147], v[48:51], a[136:139], v[144:147]
    buffer_load_dwordx4 v12, s[48:51], s68 offen offset:2048 sc1 lds
    v_mfma_f32_16x16x32_bf16 v[152:155], v[48:51], a[140:143], v[152:155]
    s_waitcnt lgkmcnt(0)
    v_add_f32_dpp v210, v210, v210 row_shr:2 row_mask:0xf bank_mask:0xf bound_ctrl:0
    v_mul_f32 v225, 0x3fb8aa3b, v65
    v_max_f32 v64, 0x358637bd, v64
    v_mfma_f32_16x16x32_bf16 v[156:159], v[52:55], a[140:143], v[156:159]
    v_exp_f32 v224, v224 clamp
    v_max_f32 v65, 0x358637bd, v65
    v_mfma_f32_16x16x32_bf16 v[148:151], v[52:55], a[136:139], v[148:151]
    v_exp_f32 v225, v225 clamp
    v_mfma_f32_16x16x32_bf16 v[140:143], v[52:55], a[12:15], v[140:143]
    buffer_load_dwordx4 v13, s[48:51], s68 offen offset:3072 sc1 lds
    v_mfma_f32_16x16x32_bf16 v[132:135], v[52:55], a[8:11], v[132:135]
    s_add_u32 m0, s97, 0
    v_add_f32 v64, v64, v224
    v_add_f32 v65, v65, v225
    v_cvt_pk_bf16_f32 v64, v64, v65
    v_mul_f32 v226, 0x3fb8aa3b, v66
    v_mfma_f32_16x16x32_bf16 v[160:163], v[56:59], a[8:11], v[160:163]
    s_waitcnt vmcnt(12)
    s_barrier
    v_add_f32_dpp v210, v210, v210 row_shr:4 row_mask:0xf bank_mask:0xf bound_ctrl:0
    v_mfma_f32_16x16x32_bf16 v[168:171], v[56:59], a[12:15], v[168:171]
    ds_read_b64_tr_b16 v[32:33], v14 offset:16384
    v_mul_f32 v227, 0x3fb8aa3b, v67
    v_exp_f32 v226, v226 clamp
    v_mfma_f32_16x16x32_bf16 v[176:179], v[56:59], a[136:139], v[176:179]
    buffer_load_dwordx4 v252, s[36:39], s88 offen offset:0  lds
    v_mfma_f32_16x16x32_bf16 v[184:187], v[56:59], a[140:143], v[184:187]
    ds_read_b64_tr_b16 v[34:35], v14 offset:16896
    v_add_f32_dpp v210, v210, v210 row_shr:8 row_mask:0xf bank_mask:0xf bound_ctrl:0
    v_exp_f32 v227, v227 clamp
    v_max_f32 v66, 0x358637bd, v66
    v_mfma_f32_16x16x32_bf16 v[188:191], v[60:63], a[140:143], v[188:191]
    ds_read_b64_tr_b16 v[36:37], v15 offset:16384
    v_mul_f32 v210, 0xbfb8aa3b, v210
    v_max_f32 v67, 0x358637bd, v67
    v_add_f32 v66, v66, v226
    v_mfma_f32_16x16x32_bf16 v[180:183], v[60:63], a[136:139], v[180:183]
    ds_read_b64_tr_b16 v[38:39], v15 offset:16896
    v_exp_f32 v210, v210
    v_add_f32 v67, v67, v227
    v_cvt_pk_bf16_f32 v65, v66, v67
    v_mfma_f32_16x16x32_bf16 v[172:175], v[60:63], a[12:15], v[172:175]
    buffer_load_dwordx4 v253, s[36:39], s88 offen offset:1024  lds
    v_mfma_f32_16x16x32_bf16 v[164:167], v[60:63], a[8:11], v[164:167]
    s_waitcnt lgkmcnt(2)
    ds_read_b64_tr_b16 v[40:41], v14 offset:24576
    v_mul_f32 v224, 0x3fb8aa3b, v68
    v_mul_f32 v225, 0x3fb8aa3b, v69
    v_exp_f32 v224, v224 clamp
    v_mfma_f32_16x16x32_bf16 v[128:131], v[32:35], a[16:19], v[128:131]
    ds_read_b64_tr_b16 v[42:43], v14 offset:25088
    v_add_u32 v216, 16, v0
    v_exp_f32 v225, v225 clamp
    v_mfma_f32_16x16x32_bf16 v[136:139], v[32:35], a[20:23], v[136:139]
    ds_read_b64_tr_b16 v[44:45], v15 offset:24576
    v_add_f32 v210, 1.0, v210
    v_max_f32 v68, 0x358637bd, v68
    v_max_f32 v69, 0x358637bd, v69
    v_mfma_f32_16x16x32_bf16 v[144:147], v[32:35], a[144:147], v[144:147]
    buffer_load_dwordx4 v254, s[36:39], s88 offen offset:2048  lds
    v_mfma_f32_16x16x32_bf16 v[152:155], v[32:35], a[148:151], v[152:155]
    s_waitcnt lgkmcnt(3)
    ds_read_b64_tr_b16 v[46:47], v15 offset:25088
    v_add_f32 v68, v68, v224
    v_add_f32 v69, v69, v225
    v_cvt_pk_bf16_f32 v66, v68, v69
    v_mul_f32 v226, 0x3fb8aa3b, v70
    v_mfma_f32_16x16x32_bf16 v[156:159], v[36:39], a[148:151], v[156:159]
    ds_read_b64_tr_b16 v[48:49], v14 offset:20480
    v_and_b32 v216, 0xf0, v216
    v_mul_f32 v227, 0x3fb8aa3b, v71
    v_max_f32 v70, 0x358637bd, v70
    v_mfma_f32_16x16x32_bf16 v[148:151], v[36:39], a[144:147], v[148:151]
    ds_read_b64_tr_b16 v[50:51], v14 offset:20992
    v_rcp_f32 v210, v210
    v_exp_f32 v226, v226 clamp
    v_mfma_f32_16x16x32_bf16 v[140:143], v[36:39], a[20:23], v[140:143]
    buffer_load_dwordx4 v255, s[36:39], s88 offen offset:3072  lds
    v_mfma_f32_16x16x32_bf16 v[132:135], v[36:39], a[16:19], v[132:135]
    s_waitcnt lgkmcnt(3)
    ds_read_b64_tr_b16 v[52:53], v15 offset:20480
    v_exp_f32 v227, v227 clamp
    v_max_f32 v71, 0x358637bd, v71
    v_add_f32 v70, v70, v226
    v_mfma_f32_16x16x32_bf16 v[160:163], v[40:43], a[16:19], v[160:163]
    s_add_u32 m0, s97, 98304
    ds_read_b64_tr_b16 v[54:55], v15 offset:20992
    v_add_f32 v71, v71, v227
    v_cvt_pk_bf16_f32 v67, v70, v71
    v_mfma_f32_16x16x32_bf16 v[168:171], v[40:43], a[20:23], v[168:171]
    ds_read_b64_tr_b16 v[56:57], v14 offset:28672
    v_min_u32 v216, 1, v216
    v_cvt_pk_bf16_f32 v96, v96, v97
    v_cvt_pk_bf16_f32 v97, v98, v99
    v_mfma_f32_16x16x32_bf16 v[176:179], v[40:43], a[144:147], v[176:179]
    buffer_load_dwordx4 v10, s[48:51], s72 offen offset:0 sc1 lds
    v_mfma_f32_16x16x32_bf16 v[184:187], v[40:43], a[148:151], v[184:187]
    s_waitcnt lgkmcnt(3)
    ds_read_b64_tr_b16 v[58:59], v14 offset:29184
    v_cvt_pk_bf16_f32 v98, v100, v101
    v_cvt_pk_bf16_f32 v99, v102, v103
    v_mfma_f32_16x16x32_bf16 v[200:203], v[220:223], v[64:67], 0
    v_mfma_f32_16x16x32_bf16 v[188:191], v[44:47], a[148:151], v[188:191]
    ds_read_b64_tr_b16 v[60:61], v15 offset:28672
    v_lshlrev_b32 v216, 30, v216
    v_mfma_f32_16x16x32_bf16 v[192:195], v[64:67], v[96:99], 0
    v_mul_f32 v224, 0x3fb8aa3b, v80
    v_mul_f32 v225, 0x3fb8aa3b, v81
    v_mfma_f32_16x16x32_bf16 v[180:183], v[44:47], a[144:147], v[180:183]
    ds_read_b64_tr_b16 v[62:63], v15 offset:29184
    v_lshrrev_b32 v217, 8, v0
    v_exp_f32 v224, v224 clamp
    v_exp_f32 v225, v225 clamp
    v_mfma_f32_16x16x32_bf16 v[172:175], v[44:47], a[20:23], v[172:175]
    buffer_load_dwordx4 v11, s[48:51], s72 offen offset:1024 sc1 lds
    v_mfma_f32_16x16x32_bf16 v[164:167], v[44:47], a[16:19], v[164:167]
    v_lshl_add_u32 v216, v217, 2, v216
    v_max_f32 v80, 0x358637bd, v80
    v_max_f32 v81, 0x358637bd, v81
    v_add_f32 v80, v80, v224
    v_add_f32 v81, v81, v225
    v_cvt_pk_bf16_f32 v80, v80, v81
    v_mfma_f32_16x16x32_bf16 v[128:131], v[48:51], a[24:27], v[128:131]
    buffer_store_dword v210, v216, s[44:47], s21 offen offset:1024 sc1
    v_mul_f32 v226, 0x3fb8aa3b, v82
    v_mfma_f32_16x16x32_bf16 v[136:139], v[48:51], a[28:31], v[136:139]
    v_mul_f32 v227, 0x3fb8aa3b, v83
    v_exp_f32 v226, v226 clamp
    v_max_f32 v82, 0x358637bd, v82
    v_mfma_f32_16x16x32_bf16 v[144:147], v[48:51], a[152:155], v[144:147]
    buffer_load_dwordx4 v12, s[48:51], s72 offen offset:2048 sc1 lds
    v_mfma_f32_16x16x32_bf16 v[152:155], v[48:51], a[156:159], v[152:155]
    s_waitcnt lgkmcnt(0)
    v_exp_f32 v227, v227 clamp
    v_max_f32 v83, 0x358637bd, v83
    v_add_f32 v82, v82, v226
    v_mfma_f32_16x16x32_bf16 v[156:159], v[52:55], a[156:159], v[156:159]
    v_add_f32 v83, v83, v227
    v_cvt_pk_bf16_f32 v81, v82, v83
    v_mfma_f32_16x16x32_bf16 v[148:151], v[52:55], a[152:155], v[148:151]
    v_mul_f32 v224, 0x3fb8aa3b, v84
    v_mul_f32 v225, 0x3fb8aa3b, v85
    v_mfma_f32_16x16x32_bf16 v[140:143], v[52:55], a[28:31], v[140:143]
    buffer_load_dwordx4 v13, s[48:51], s72 offen offset:3072 sc1 lds
    v_mfma_f32_16x16x32_bf16 v[132:135], v[52:55], a[24:27], v[132:135]
    s_add_u32 m0, s97, 16384
    v_exp_f32 v224, v224 clamp
    v_exp_f32 v225, v225 clamp
    v_mfma_f32_16x16x32_bf16 v[160:163], v[56:59], a[24:27], v[160:163]
    s_waitcnt vmcnt(17)
    s_barrier
    v_max_f32 v84, 0x358637bd, v84
    v_mfma_f32_16x16x32_bf16 v[168:171], v[56:59], a[28:31], v[168:171]
    ds_read_b64_tr_b16 v[32:33], v14 offset:32768
    v_max_f32 v85, 0x358637bd, v85
    v_add_f32 v84, v84, v224
    v_mfma_f32_16x16x32_bf16 v[176:179], v[56:59], a[152:155], v[176:179]
    buffer_load_dwordx4 v252, s[36:39], s89 offen offset:0  lds
    v_mfma_f32_16x16x32_bf16 v[184:187], v[56:59], a[156:159], v[184:187]
    ds_read_b64_tr_b16 v[34:35], v14 offset:33280
    v_add_f32 v85, v85, v225
    v_cvt_pk_bf16_f32 v82, v84, v85
    v_mul_f32 v226, 0x3fb8aa3b, v86
    v_mul_f32 v227, 0x3fb8aa3b, v87
    v_mfma_f32_16x16x32_bf16 v[188:191], v[60:63], a[156:159], v[188:191]
    ds_read_b64_tr_b16 v[36:37], v15 offset:32768
    v_exp_f32 v226, v226 clamp
    v_mfma_f32_16x16x32_bf16 v[180:183], v[60:63], a[152:155], v[180:183]
    ds_read_b64_tr_b16 v[38:39], v15 offset:33280
    v_exp_f32 v227, v227 clamp
    v_mfma_f32_16x16x32_bf16 v[172:175], v[60:63], a[28:31], v[172:175]
    buffer_load_dwordx4 v253, s[36:39], s89 offen offset:1024  lds
    v_mfma_f32_16x16x32_bf16 v[164:167], v[60:63], a[24:27], v[164:167]
    s_waitcnt lgkmcnt(2)
    ds_read_b64_tr_b16 v[40:41], v14 offset:40960
    v_max_f32 v86, 0x358637bd, v86
    v_max_f32 v87, 0x358637bd, v87
    v_add_f32 v86, v86, v226
    v_mfma_f32_16x16x32_bf16 v[128:131], v[32:35], a[32:35], v[128:131]
    ds_read_b64_tr_b16 v[42:43], v14 offset:41472
    v_add_f32 v87, v87, v227
    v_cvt_pk_bf16_f32 v83, v86, v87
    v_cvt_pk_bf16_f32 v112, v112, v113
    v_mfma_f32_16x16x32_bf16 v[136:139], v[32:35], a[36:39], v[136:139]
    ds_read_b64_tr_b16 v[44:45], v15 offset:40960
    v_cvt_pk_bf16_f32 v113, v114, v115
    v_cvt_pk_bf16_f32 v114, v116, v117
    v_mfma_f32_16x16x32_bf16 v[144:147], v[32:35], a[160:163], v[144:147]
    buffer_load_dwordx4 v254, s[36:39], s89 offen offset:2048  lds
    v_mfma_f32_16x16x32_bf16 v[152:155], v[32:35], a[164:167], v[152:155]
    s_waitcnt lgkmcnt(3)
    ds_read_b64_tr_b16 v[46:47], v15 offset:41472
    v_cvt_pk_bf16_f32 v115, v118, v119
    v_mfma_f32_16x16x32_bf16 v[204:207], v[220:223], v[80:83], 0
    v_mfma_f32_16x16x32_bf16 v[156:159], v[36:39], a[164:167], v[156:159]
    ds_read_b64_tr_b16 v[48:49], v14 offset:36864
    v_mfma_f32_16x16x32_bf16 v[196:199], v[80:83], v[112:115], 0
    v_mul_f32 v224, 0x3fb8aa3b, v72
    v_mul_f32 v225, 0x3fb8aa3b, v73
    v_mfma_f32_16x16x32_bf16 v[148:151], v[36:39], a[160:163], v[148:151]
    ds_read_b64_tr_b16 v[50:51], v14 offset:37376
    v_exp_f32 v224, v224 clamp
    v_exp_f32 v225, v225 clamp
    v_max_f32 v72, 0x358637bd, v72
    v_mfma_f32_16x16x32_bf16 v[140:143], v[36:39], a[36:39], v[140:143]
L_padK1:
    s_cbranch_execz L_retK
    buffer_load_dwordx4 v255, s[36:39], s89 offen offset:3072  lds
    v_mfma_f32_16x16x32_bf16 v[132:135], v[36:39], a[32:35], v[132:135]
    s_waitcnt lgkmcnt(3)
    ds_read_b64_tr_b16 v[52:53], v15 offset:36864
    v_max_f32 v73, 0x358637bd, v73
    v_add_f32 v72, v72, v224
    v_add_f32 v73, v73, v225
    v_mfma_f32_16x16x32_bf16 v[160:163], v[40:43], a[32:35], v[160:163]
    s_add_u32 m0, s97, 114688
    ds_read_b64_tr_b16 v[54:55], v15 offset:37376
    v_cvt_pk_bf16_f32 v72, v72, v73
    v_mul_f32 v226, 0x3fb8aa3b, v74
    v_mfma_f32_16x16x32_bf16 v[168:171], v[40:43], a[36:39], v[168:171]
    ds_read_b64_tr_b16 v[56:57], v14 offset:45056
    v_mul_f32 v227, 0x3fb8aa3b, v75
    v_exp_f32 v226, v226 clamp
    v_mfma_f32_16x16x32_bf16 v[176:179], v[40:43], a[160:163], v[176:179]
    buffer_load_dwordx4 v10, s[48:51], s76 offen offset:0 sc1 lds
    v_mfma_f32_16x16x32_bf16 v[184:187], v[40:43], a[164:167], v[184:187]
    s_waitcnt lgkmcnt(3)
    ds_read_b64_tr_b16 v[58:59], v14 offset:45568
    v_exp_f32 v227, v227 clamp
    v_max_f32 v74, 0x358637bd, v74
    v_mfma_f32_16x16x32_bf16 v[188:191], v[44:47], a[164:167], v[188:191]
    ds_read_b64_tr_b16 v[60:61], v15 offset:45056
    v_max_f32 v75, 0x358637bd, v75
    v_add_f32 v74, v74, v226
    v_add_f32 v75, v75, v227
    v_mfma_f32_16x16x32_bf16 v[180:183], v[44:47], a[160:163], v[180:183]
    ds_read_b64_tr_b16 v[62:63], v15 offset:45568
    v_cvt_pk_bf16_f32 v73, v74, v75
    v_mul_f32 v224, 0x3fb8aa3b, v76
    v_mfma_f32_16x16x32_bf16 v[172:175], v[44:47], a[36:39], v[172:175]
    buffer_load_dwordx4 v11, s[48:51], s76 offen offset:1024 sc1 lds
    v_mfma_f32_16x16x32_bf16 v[164:167], v[44:47], a[32:35], v[164:167]
    v_mul_f32 v225, 0x3fb8aa3b, v77
    v_exp_f32 v224, v224 clamp
    v_exp_f32 v225, v225 clamp
    v_mfma_f32_16x16x32_bf16 v[128:131], v[48:51], a[40:43], v[128:131]
    v_max_f32 v76, 0x358637bd, v76
    v_max_f32 v77, 0x358637bd, v77
    v_mfma_f32_16x16x32_bf16 v[136:139], v[48:51], a[44:47], v[136:139]
    v_add_f32 v76, v76, v224
    v_add_f32 v77, v77, v225
    v_mfma_f32_16x16x32_bf16 v[144:147], v[48:51], a[168:171], v[144:147]
    buffer_load_dwordx4 v12, s[48:51], s76 offen offset:2048 sc1 lds
    v_mfma_f32_16x16x32_bf16 v[152:155], v[48:51], a[172:175], v[152:155]
    s_waitcnt lgkmcnt(0)
    v_cvt_pk_bf16_f32 v74, v76, v77
    v_mul_f32 v226, 0x3fb8aa3b, v78
    v_mul_f32 v227, 0x3fb8aa3b, v79
    v_max_f32 v78, 0x358637bd, v78
    v_mfma_f32_16x16x32_bf16 v[156:159], v[52:55], a[172:175], v[156:159]
    v_exp_f32 v226, v226 clamp
    v_mfma_f32_16x16x32_bf16 v[148:151], v[52:55], a[168:171], v[148:151]
    v_exp_f32 v227, v227 clamp
    v_mfma_f32_16x16x32_bf16 v[140:143], v[52:55], a[44:47], v[140:143]
    buffer_load_dwordx4 v13, s[48:51], s76 offen offset:3072 sc1 lds
    v_mfma_f32_16x16x32_bf16 v[132:135], v[52:55], a[40:43], v[132:135]
    s_add_u32 m0, s97, 32768
    v_max_f32 v79, 0x358637bd, v79
    v_add_f32 v78, v78, v226
    v_add_f32 v79, v79, v227
    v_cvt_pk_bf16_f32 v75, v78, v79
    v_mfma_f32_16x16x32_bf16 v[160:163], v[56:59], a[40:43], v[160:163]
    s_waitcnt vmcnt(21)
    s_barrier
    v_cvt_pk_bf16_f32 v104, v104, v105
    v_mfma_f32_16x16x32_bf16 v[168:171], v[56:59], a[44:47], v[168:171]
    ds_read_b64_tr_b16 v[32:33], v14 offset:49152
    v_cvt_pk_bf16_f32 v105, v106, v107
    v_cvt_pk_bf16_f32 v106, v108, v109
    v_mfma_f32_16x16x32_bf16 v[176:179], v[56:59], a[168:171], v[176:179]
    buffer_load_dwordx4 v252, s[36:39], s90 offen offset:0  lds
    v_mfma_f32_16x16x32_bf16 v[184:187], v[56:59], a[172:175], v[184:187]
    ds_read_b64_tr_b16 v[34:35], v14 offset:49664
    v_cvt_pk_bf16_f32 v107, v110, v111
    v_mfma_f32_16x16x32_bf16 v[200:203], v[220:223], v[72:75], v[200:203]
    v_mfma_f32_16x16x32_bf16 v[188:191], v[60:63], a[172:175], v[188:191]
    ds_read_b64_tr_b16 v[36:37], v15 offset:49152
    v_mfma_f32_16x16x32_bf16 v[192:195], v[72:75], v[104:107], v[192:195]
    v_mul_f32 v224, 0x3fb8aa3b, v88
    v_mul_f32 v225, 0x3fb8aa3b, v89
    v_mfma_f32_16x16x32_bf16 v[180:183], v[60:63], a[168:171], v[180:183]
    ds_read_b64_tr_b16 v[38:39], v15 offset:49664
    v_exp_f32 v224, v224 clamp
    v_exp_f32 v225, v225 clamp
    v_max_f32 v88, 0x358637bd, v88
    v_mfma_f32_16x16x32_bf16 v[172:175], v[60:63], a[44:47], v[172:175]
    buffer_load_dwordx4 v253, s[36:39], s90 offen offset:1024  lds
    v_mfma_f32_16x16x32_bf16 v[164:167], v[60:63], a[40:43], v[164:167]
    s_waitcnt lgkmcnt(2)
    ds_read_b64_tr_b16 v[40:41], v14 offset:57344
    v_max_f32 v89, 0x358637bd, v89
    v_add_f32 v88, v88, v224
    v_add_f32 v89, v89, v225
    v_mfma_f32_16x16x32_bf16 v[128:131], v[32:35], a[48:51], v[128:131]
    ds_read_b64_tr_b16 v[42:43], v14 offset:57856
    v_cvt_pk_bf16_f32 v88, v88, v89
    v_mul_f32 v226, 0x3fb8aa3b, v90
    v_mul_f32 v227, 0x3fb8aa3b, v91
    v_mfma_f32_16x16x32_bf16 v[136:139], v[32:35], a[52:55], v[136:139]
    ds_read_b64_tr_b16 v[44:45], v15 offset:57344
    v_exp_f32 v226, v226 clamp
    v_mfma_f32_16x16x32_bf16 v[144:147], v[32:35], a[176:179], v[144:147]
    buffer_load_dwordx4 v254, s[36:39], s90 offen offset:2048  lds
    v_mfma_f32_16x16x32_bf16 v[152:155], v[32:35], a[180:183], v[152:155]
    s_waitcnt lgkmcnt(3)
    ds_read_b64_tr_b16 v[46:47], v15 offset:57856
    v_exp_f32 v227, v227 clamp
    v_max_f32 v90, 0x358637bd, v90
    v_mfma_f32_16x16x32_bf16 v[156:159], v[36:39], a[180:183], v[156:159]
    ds_read_b64_tr_b16 v[48:49], v14 offset:53248
    v_max_f32 v91, 0x358637bd, v91
    v_add_f32 v90, v90, v226
    v_add_f32 v91, v91, v227
    v_mfma_f32_16x16x32_bf16 v[148:151], v[36:39], a[176:179], v[148:151]
    ds_read_b64_tr_b16 v[50:51], v14 offset:53760
    v_cvt_pk_bf16_f32 v89, v90, v91
    v_mul_f32 v224, 0x3fb8aa3b, v92
    v_mfma_f32_16x16x32_bf16 v[140:143], v[36:39], a[52:55], v[140:143]
    buffer_load_dwordx4 v255, s[36:39], s90 offen offset:3072  lds
    v_mfma_f32_16x16x32_bf16 v[132:135], v[36:39], a[48:51], v[132:135]
    s_waitcnt lgkmcnt(3)
    ds_read_b64_tr_b16 v[52:53], v15 offset:53248
    v_mul_f32 v225, 0x3fb8aa3b, v93
    v_exp_f32 v224, v224 clamp
    v_mfma_f32_16x16x32_bf16 v[160:163], v[40:43], a[48:51], v[160:163]
    s_add_u32 m0, s97, 131072
    ds_read_b64_tr_b16 v[54:55], v15 offset:53760
    v_exp_f32 v225, v225 clamp
    v_mfma_f32_16x16x32_bf16 v[168:171], v[40:43], a[52:55], v[168:171]
    ds_read_b64_tr_b16 v[56:57], v14 offset:61440
    v_max_f32 v92, 0x358637bd, v92
    v_max_f32 v93, 0x358637bd, v93
    v_add_f32 v92, v92, v224
    v_mfma_f32_16x16x32_bf16 v[176:179], v[40:43], a[176:179], v[176:179]
    buffer_load_dwordx4 v10, s[48:51], s80 offen offset:0 sc1 lds
    v_mfma_f32_16x16x32_bf16 v[184:187], v[40:43], a[180:183], v[184:187]
    s_waitcnt lgkmcnt(3)
    ds_read_b64_tr_b16 v[58:59], v14 offset:61952
    v_add_f32 v93, v93, v225
    v_cvt_pk_bf16_f32 v90, v92, v93
    v_mul_f32 v226, 0x3fb8aa3b, v94
    v_mfma_f32_16x16x32_bf16 v[188:191], v[44:47], a[180:183], v[188:191]
    ds_read_b64_tr_b16 v[60:61], v15 offset:61440
    v_mul_f32 v227, 0x3fb8aa3b, v95
    v_exp_f32 v226, v226 clamp
    v_mfma_f32_16x16x32_bf16 v[180:183], v[44:47], a[176:179], v[180:183]
    ds_read_b64_tr_b16 v[62:63], v15 offset:61952
    v_exp_f32 v227, v227 clamp
    v_mfma_f32_16x16x32_bf16 v[172:175], v[44:47], a[52:55], v[172:175]
    buffer_load_dwordx4 v11, s[48:51], s80 offen offset:1024 sc1 lds
    v_mfma_f32_16x16x32_bf16 v[164:167], v[44:47], a[48:51], v[164:167]
    v_max_f32 v94, 0x358637bd, v94
    v_max_f32 v95, 0x358637bd, v95
    v_add_f32 v94, v94, v226
    v_add_f32 v95, v95, v227
    v_cvt_pk_bf16_f32 v91, v94, v95
    v_mfma_f32_16x16x32_bf16 v[128:131], v[48:51], a[56:59], v[128:131]
    v_cvt_pk_bf16_f32 v120, v120, v121
    v_cvt_pk_bf16_f32 v121, v122, v123
    v_mfma_f32_16x16x32_bf16 v[136:139], v[48:51], a[60:63], v[136:139]
    v_cvt_pk_bf16_f32 v122, v124, v125
    v_cvt_pk_bf16_f32 v123, v126, v127
    v_mfma_f32_16x16x32_bf16 v[204:207], v[220:223], v[88:91], v[204:207]
    v_mfma_f32_16x16x32_bf16 v[144:147], v[48:51], a[184:187], v[144:147]
    buffer_load_dwordx4 v12, s[48:51], s80 offen offset:2048 sc1 lds
    v_mfma_f32_16x16x32_bf16 v[196:199], v[88:91], v[120:123], v[196:199]
    ds_write_b128 v228, v[192:195]
    v_mfma_f32_16x16x32_bf16 v[152:155], v[48:51], a[188:191], v[152:155]
    s_waitcnt lgkmcnt(1)
    v_mfma_f32_16x16x32_bf16 v[156:159], v[52:55], a[188:191], v[156:159]
    v_mfma_f32_16x16x32_bf16 v[148:151], v[52:55], a[184:187], v[148:151]
    v_mov_b32 v201, v204
    v_mfma_f32_16x16x32_bf16 v[140:143], v[52:55], a[60:63], v[140:143]
    buffer_load_dwordx4 v13, s[48:51], s80 offen offset:3072 sc1 lds
    ds_write_b128 v228, v[196:199] offset:1024
    v_mfma_f32_16x16x32_bf16 v[132:135], v[52:55], a[56:59], v[132:135]
    s_add_u32 m0, s97, 49152
    ds_write_b64 v228, v[200:201] offset:2048
    v_mfma_f32_16x16x32_bf16 v[160:163], v[56:59], a[56:59], v[160:163]
    s_waitcnt vmcnt(21) lgkmcnt(0)
    s_barrier
    ds_read_b128 v[208:211], v229
    v_mfma_f32_16x16x32_bf16 v[168:171], v[56:59], a[60:63], v[168:171]
    ds_read_b64_tr_b16 v[32:33], v14 offset:0
    v_mfma_f32_16x16x32_bf16 v[176:179], v[56:59], a[184:187], v[176:179]
    buffer_load_dwordx4 v252, s[36:39], s91 offen offset:0  lds
    ds_read_b128 v[212:215], v229 offset:1024
    v_mfma_f32_16x16x32_bf16 v[184:187], v[56:59], a[188:191], v[184:187]
    ds_read_b64_tr_b16 v[34:35], v14 offset:512
    v_mfma_f32_16x16x32_bf16 v[188:191], v[60:63], a[188:191], v[188:191]
    ds_read_b64_tr_b16 v[36:37], v15 offset:0
    v_mfma_f32_16x16x32_bf16 v[180:183], v[60:63], a[184:187], v[180:183]
    ds_read_b64_tr_b16 v[38:39], v15 offset:512
    ds_read_b64 v[216:217], v229 offset:2048
    v_mfma_f32_16x16x32_bf16 v[172:175], v[60:63], a[60:63], v[172:175]
    buffer_load_dwordx4 v253, s[36:39], s91 offen offset:1024  lds
    v_mfma_f32_16x16x32_bf16 v[164:167], v[60:63], a[56:59], v[164:167]
    s_waitcnt lgkmcnt(3)
    ds_read_b64_tr_b16 v[40:41], v14 offset:8192
    v_mfma_f32_16x16x32_bf16 v[128:131], v[32:35], a[64:67], v[128:131]
    ds_read_b64_tr_b16 v[42:43], v14 offset:8704
    v_mfma_f32_16x16x32_bf16 v[136:139], v[32:35], a[68:71], v[136:139]
    ds_read_b64_tr_b16 v[44:45], v15 offset:8192
    v_mfma_f32_16x16x32_bf16 v[144:147], v[32:35], a[192:195], v[144:147]
    buffer_load_dwordx4 v254, s[36:39], s91 offen offset:2048  lds
    v_mfma_f32_16x16x32_bf16 v[152:155], v[32:35], a[196:199], v[152:155]
    s_waitcnt lgkmcnt(4)
    ds_read_b64_tr_b16 v[46:47], v15 offset:8704
    v_add_f32 v192, v192, v208
    v_add_f32 v193, v193, v209
    v_add_f32 v194, v194, v210
    v_add_f32 v195, v195, v211
    v_add_f32 v196, v196, v212
    v_add_f32 v197, v197, v213
    v_add_f32 v198, v198, v214
    v_add_f32 v199, v199, v215
    v_mfma_f32_16x16x32_bf16 v[156:159], v[36:39], a[196:199], v[156:159]
    ds_read_b64_tr_b16 v[48:49], v14 offset:4096
    s_waitcnt lgkmcnt(5)
    v_add_f32 v200, v200, v216
    v_add_f32 v201, v201, v217
    v_mfma_f32_16x16x32_bf16 v[148:151], v[36:39], a[192:195], v[148:151]
    ds_read_b64_tr_b16 v[50:51], v14 offset:4608
    v_cvt_pk_bf16_f32 v192, v192, v193
    v_cvt_pk_bf16_f32 v193, v194, v195
    v_cvt_pk_bf16_f32 v194, v196, v197
    v_mfma_f32_16x16x32_bf16 v[140:143], v[36:39], a[68:71], v[140:143]
    buffer_load_dwordx4 v255, s[36:39], s91 offen offset:3072  lds
    v_mfma_f32_16x16x32_bf16 v[132:135], v[36:39], a[64:67], v[132:135]
    s_waitcnt lgkmcnt(3)
    ds_read_b64_tr_b16 v[52:53], v15 offset:4096
    v_cvt_pk_bf16_f32 v195, v198, v199
    v_mfma_f32_16x16x32_bf16 v[160:163], v[40:43], a[64:67], v[160:163]
    ds_read_b64_tr_b16 v[54:55], v15 offset:4608
    buffer_store_dwordx2 v[200:201], v231, s[44:47], s14 offen sc1
    v_mfma_f32_16x16x32_bf16 v[168:171], v[40:43], a[68:71], v[168:171]
    ds_read_b64_tr_b16 v[56:57], v14 offset:12288
    buffer_store_dwordx4 v[192:195], v230, s[44:47], s13 offen sc1
    v_mfma_f32_16x16x32_bf16 v[176:179], v[40:43], a[192:195], v[176:179]
    ds_read_b64_tr_b16 v[58:59], v14 offset:12800
    v_mfma_f32_16x16x32_bf16 v[184:187], v[40:43], a[196:199], v[184:187]
    s_waitcnt lgkmcnt(4)
    ds_read_b64_tr_b16 v[60:61], v15 offset:12288
    v_mfma_f32_16x16x32_bf16 v[188:191], v[44:47], a[196:199], v[188:191]
    ds_read_b64_tr_b16 v[62:63], v15 offset:12800
    v_mfma_f32_16x16x32_bf16 v[180:183], v[44:47], a[192:195], v[180:183]
    v_mfma_f32_16x16x32_bf16 v[172:175], v[44:47], a[68:71], v[172:175]
    v_mfma_f32_16x16x32_bf16 v[164:167], v[44:47], a[64:67], v[164:167]
    v_mfma_f32_16x16x32_bf16 v[128:131], v[48:51], a[72:75], v[128:131]
    v_mfma_f32_16x16x32_bf16 v[136:139], v[48:51], a[76:79], v[136:139]
    v_mfma_f32_16x16x32_bf16 v[144:147], v[48:51], a[200:203], v[144:147]
    v_mfma_f32_16x16x32_bf16 v[152:155], v[48:51], a[204:207], v[152:155]
    s_waitcnt lgkmcnt(0)
    v_mfma_f32_16x16x32_bf16 v[156:159], v[52:55], a[204:207], v[156:159]
    v_mfma_f32_16x16x32_bf16 v[148:151], v[52:55], a[200:203], v[148:151]
    s_add_u32 m0, s97, 0
    v_mfma_f32_16x16x32_bf16 v[140:143], v[52:55], a[76:79], v[140:143]
    v_mfma_f32_16x16x32_bf16 v[132:135], v[52:55], a[72:75], v[132:135]
    v_mfma_f32_16x16x32_bf16 v[160:163], v[56:59], a[72:75], v[160:163]
    s_waitcnt vmcnt(18)
    s_barrier
    v_mfma_f32_16x16x32_bf16 v[168:171], v[56:59], a[76:79], v[168:171]
    ds_read_b64_tr_b16 v[32:33], v14 offset:16384
    v_mfma_f32_16x16x32_bf16 v[176:179], v[56:59], a[200:203], v[176:179]
    buffer_load_dwordx4 v248, s[40:43], s92 offen offset:0  lds
    v_mfma_f32_16x16x32_bf16 v[184:187], v[56:59], a[204:207], v[184:187]
    ds_read_b64_tr_b16 v[34:35], v14 offset:16896
    v_mfma_f32_16x16x32_bf16 v[188:191], v[60:63], a[204:207], v[188:191]
    ds_read_b64_tr_b16 v[36:37], v15 offset:16384
    v_mfma_f32_16x16x32_bf16 v[180:183], v[60:63], a[200:203], v[180:183]
    ds_read_b64_tr_b16 v[38:39], v15 offset:16896
    v_mfma_f32_16x16x32_bf16 v[172:175], v[60:63], a[76:79], v[172:175]
    ds_read_b64_tr_b16 v[40:41], v14 offset:24576
    v_mfma_f32_16x16x32_bf16 v[164:167], v[60:63], a[72:75], v[164:167]
    s_waitcnt lgkmcnt(3)
    ds_read_b64_tr_b16 v[42:43], v14 offset:25088
    v_mfma_f32_16x16x32_bf16 v[128:131], v[32:35], a[80:83], v[128:131]
    ds_read_b64_tr_b16 v[44:45], v15 offset:24576
    v_mfma_f32_16x16x32_bf16 v[136:139], v[32:35], a[84:87], v[136:139]
    ds_read_b64_tr_b16 v[46:47], v15 offset:25088
    v_mfma_f32_16x16x32_bf16 v[144:147], v[32:35], a[208:211], v[144:147]
    buffer_load_dwordx4 v249, s[40:43], s92 offen offset:1024  lds
    v_mfma_f32_16x16x32_bf16 v[152:155], v[32:35], a[212:215], v[152:155]
    s_waitcnt lgkmcnt(3)
    ds_read_b64_tr_b16 v[48:49], v14 offset:20480
    v_mfma_f32_16x16x32_bf16 v[156:159], v[36:39], a[212:215], v[156:159]
    ds_read_b64_tr_b16 v[50:51], v14 offset:20992
    v_mfma_f32_16x16x32_bf16 v[148:151], v[36:39], a[208:211], v[148:151]
    ds_read_b64_tr_b16 v[52:53], v15 offset:20480
    v_mfma_f32_16x16x32_bf16 v[140:143], v[36:39], a[84:87], v[140:143]
    ds_read_b64_tr_b16 v[54:55], v15 offset:20992
    v_mfma_f32_16x16x32_bf16 v[132:135], v[36:39], a[80:83], v[132:135]
    s_waitcnt lgkmcnt(4)
    ds_read_b64_tr_b16 v[56:57], v14 offset:28672
    v_mfma_f32_16x16x32_bf16 v[160:163], v[40:43], a[80:83], v[160:163]
    ds_read_b64_tr_b16 v[58:59], v14 offset:29184
    v_mfma_f32_16x16x32_bf16 v[168:171], v[40:43], a[84:87], v[168:171]
    ds_read_b64_tr_b16 v[60:61], v15 offset:28672
    v_mfma_f32_16x16x32_bf16 v[176:179], v[40:43], a[208:211], v[176:179]
    buffer_load_dwordx4 v250, s[40:43], s92 offen offset:2048  lds
    v_mfma_f32_16x16x32_bf16 v[184:187], v[40:43], a[212:215], v[184:187]
    ds_read_b64_tr_b16 v[62:63], v15 offset:29184
    v_mfma_f32_16x16x32_bf16 v[188:191], v[44:47], a[212:215], v[188:191]
    v_mfma_f32_16x16x32_bf16 v[180:183], v[44:47], a[208:211], v[180:183]
    v_mfma_f32_16x16x32_bf16 v[172:175], v[44:47], a[84:87], v[172:175]
    v_mfma_f32_16x16x32_bf16 v[164:167], v[44:47], a[80:83], v[164:167]
    s_waitcnt lgkmcnt(1)
    v_mfma_f32_16x16x32_bf16 v[128:131], v[48:51], a[88:91], v[128:131]
    v_mfma_f32_16x16x32_bf16 v[136:139], v[48:51], a[92:95], v[136:139]
    v_mfma_f32_16x16x32_bf16 v[144:147], v[48:51], a[216:219], v[144:147]
    buffer_load_dwordx4 v251, s[40:43], s92 offen offset:3072  lds
    v_mfma_f32_16x16x32_bf16 v[152:155], v[48:51], a[220:223], v[152:155]
    v_mfma_f32_16x16x32_bf16 v[156:159], v[52:55], a[220:223], v[156:159]
    v_mfma_f32_16x16x32_bf16 v[148:151], v[52:55], a[216:219], v[148:151]
    s_add_u32 m0, s97, 16384
    v_mfma_f32_16x16x32_bf16 v[140:143], v[52:55], a[92:95], v[140:143]
    s_waitcnt vmcnt(4)
    v_mfma_f32_16x16x32_bf16 v[132:135], v[52:55], a[88:91], v[132:135]
    v_mfma_f32_16x16x32_bf16 v[160:163], v[56:59], a[88:91], v[160:163]
    s_waitcnt lgkmcnt(0)
    s_barrier
    v_mfma_f32_16x16x32_bf16 v[168:171], v[56:59], a[92:95], v[168:171]
    ds_read_b64_tr_b16 v[32:33], v14 offset:32768
    buffer_store_dwordx2 v[20:21], v1, s[44:47], s11 offen offset:0 sc1
    v_mfma_f32_16x16x32_bf16 v[176:179], v[56:59], a[216:219], v[176:179]
    buffer_load_dwordx4 v248, s[40:43], s93 offen offset:0  lds
    v_mfma_f32_16x16x32_bf16 v[184:187], v[56:59], a[220:223], v[184:187]
    ds_read_b64_tr_b16 v[34:35], v14 offset:33280
    v_mfma_f32_16x16x32_bf16 v[188:191], v[60:63], a[220:223], v[188:191]
    ds_read_b64_tr_b16 v[36:37], v15 offset:32768
    v_mfma_f32_16x16x32_bf16 v[180:183], v[60:63], a[216:219], v[180:183]
    ds_read_b64_tr_b16 v[38:39], v15 offset:33280
    v_mfma_f32_16x16x32_bf16 v[172:175], v[60:63], a[92:95], v[172:175]
    ds_read_b64_tr_b16 v[40:41], v14 offset:40960
    v_mfma_f32_16x16x32_bf16 v[164:167], v[60:63], a[88:91], v[164:167]
    s_waitcnt lgkmcnt(3)
    ds_read_b64_tr_b16 v[42:43], v14 offset:41472
    v_mfma_f32_16x16x32_bf16 v[128:131], v[32:35], a[96:99], v[128:131]
    ds_read_b64_tr_b16 v[44:45], v15 offset:40960
    v_mfma_f32_16x16x32_bf16 v[136:139], v[32:35], a[100:103], v[136:139]
    ds_read_b64_tr_b16 v[46:47], v15 offset:41472
    v_mfma_f32_16x16x32_bf16 v[144:147], v[32:35], a[224:227], v[144:147]
    buffer_load_dwordx4 v249, s[40:43], s93 offen offset:1024  lds
    v_mfma_f32_16x16x32_bf16 v[152:155], v[32:35], a[228:231], v[152:155]
    s_waitcnt lgkmcnt(3)
    ds_read_b64_tr_b16 v[48:49], v14 offset:36864
    v_mfma_f32_16x16x32_bf16 v[156:159], v[36:39], a[228:231], v[156:159]
    ds_read_b64_tr_b16 v[50:51], v14 offset:37376
    v_mfma_f32_16x16x32_bf16 v[148:151], v[36:39], a[224:227], v[148:151]
    ds_read_b64_tr_b16 v[52:53], v15 offset:36864
    v_mfma_f32_16x16x32_bf16 v[140:143], v[36:39], a[100:103], v[140:143]
    ds_read_b64_tr_b16 v[54:55], v15 offset:37376
    v_mfma_f32_16x16x32_bf16 v[132:135], v[36:39], a[96:99], v[132:135]
    s_waitcnt lgkmcnt(4)
    ds_read_b64_tr_b16 v[56:57], v14 offset:45056
    v_mfma_f32_16x16x32_bf16 v[160:163], v[40:43], a[96:99], v[160:163]
    ds_read_b64_tr_b16 v[58:59], v14 offset:45568
    v_mfma_f32_16x16x32_bf16 v[168:171], v[40:43], a[100:103], v[168:171]
    ds_read_b64_tr_b16 v[60:61], v15 offset:45056
    v_mfma_f32_16x16x32_bf16 v[176:179], v[40:43], a[224:227], v[176:179]
    buffer_load_dwordx4 v250, s[40:43], s93 offen offset:2048  lds
    v_mfma_f32_16x16x32_bf16 v[184:187], v[40:43], a[228:231], v[184:187]
    ds_read_b64_tr_b16 v[62:63], v15 offset:45568
    v_mfma_f32_16x16x32_bf16 v[188:191], v[44:47], a[228:231], v[188:191]
    v_mfma_f32_16x16x32_bf16 v[180:183], v[44:47], a[224:227], v[180:183]
    v_mfma_f32_16x16x32_bf16 v[172:175], v[44:47], a[100:103], v[172:175]
    v_mfma_f32_16x16x32_bf16 v[164:167], v[44:47], a[96:99], v[164:167]
    s_waitcnt lgkmcnt(1)
    v_mfma_f32_16x16x32_bf16 v[128:131], v[48:51], a[104:107], v[128:131]
    v_mfma_f32_16x16x32_bf16 v[136:139], v[48:51], a[108:111], v[136:139]
    v_mfma_f32_16x16x32_bf16 v[144:147], v[48:51], a[232:235], v[144:147]
    buffer_load_dwordx4 v251, s[40:43], s93 offen offset:3072  lds
    v_mfma_f32_16x16x32_bf16 v[152:155], v[48:51], a[236:239], v[152:155]
    v_mfma_f32_16x16x32_bf16 v[156:159], v[52:55], a[236:239], v[156:159]
    v_mfma_f32_16x16x32_bf16 v[148:151], v[52:55], a[232:235], v[148:151]
    s_add_u32 m0, s97, 32768
    v_mfma_f32_16x16x32_bf16 v[140:143], v[52:55], a[108:111], v[140:143]
    v_mfma_f32_16x16x32_bf16 v[132:135], v[52:55], a[104:107], v[132:135]
    v_mfma_f32_16x16x32_bf16 v[160:163], v[56:59], a[104:107], v[160:163]
    s_waitcnt lgkmcnt(0)
    s_barrier
    v_mfma_f32_16x16x32_bf16 v[168:171], v[56:59], a[108:111], v[168:171]
    ds_read_b64_tr_b16 v[32:33], v14 offset:49152
    v_mfma_f32_16x16x32_bf16 v[176:179], v[56:59], a[232:235], v[176:179]
    buffer_load_dwordx4 v248, s[40:43], s94 offen offset:0  lds
    v_mfma_f32_16x16x32_bf16 v[184:187], v[56:59], a[236:239], v[184:187]
    ds_read_b64_tr_b16 v[34:35], v14 offset:49664
    v_mfma_f32_16x16x32_bf16 v[188:191], v[60:63], a[236:239], v[188:191]
    ds_read_b64_tr_b16 v[36:37], v15 offset:49152
    v_mfma_f32_16x16x32_bf16 v[180:183], v[60:63], a[232:235], v[180:183]
    ds_read_b64_tr_b16 v[38:39], v15 offset:49664
    v_mfma_f32_16x16x32_bf16 v[172:175], v[60:63], a[108:111], v[172:175]
    ds_read_b64_tr_b16 v[40:41], v14 offset:57344
    v_mfma_f32_16x16x32_bf16 v[164:167], v[60:63], a[104:107], v[164:167]
    s_waitcnt lgkmcnt(3)
    ds_read_b64_tr_b16 v[42:43], v14 offset:57856
    v_mfma_f32_16x16x32_bf16 v[128:131], v[32:35], a[112:115], v[128:131]
    ds_read_b64_tr_b16 v[44:45], v15 offset:57344
    v_mfma_f32_16x16x32_bf16 v[136:139], v[32:35], a[116:119], v[136:139]
    ds_read_b64_tr_b16 v[46:47], v15 offset:57856
    v_mfma_f32_16x16x32_bf16 v[144:147], v[32:35], a[240:243], v[144:147]
    buffer_load_dwordx4 v249, s[40:43], s94 offen offset:1024  lds
    v_mfma_f32_16x16x32_bf16 v[152:155], v[32:35], a[244:247], v[152:155]
    s_waitcnt lgkmcnt(3)
    ds_read_b64_tr_b16 v[48:49], v14 offset:53248
    v_mfma_f32_16x16x32_bf16 v[156:159], v[36:39], a[244:247], v[156:159]
    ds_read_b64_tr_b16 v[50:51], v14 offset:53760
    v_mfma_f32_16x16x32_bf16 v[148:151], v[36:39], a[240:243], v[148:151]
    ds_read_b64_tr_b16 v[52:53], v15 offset:53248
    v_mfma_f32_16x16x32_bf16 v[140:143], v[36:39], a[116:119], v[140:143]
    ds_read_b64_tr_b16 v[54:55], v15 offset:53760
    v_mfma_f32_16x16x32_bf16 v[132:135], v[36:39], a[112:115], v[132:135]
    s_waitcnt lgkmcnt(4)
    ds_read_b64_tr_b16 v[56:57], v14 offset:61440
    v_mfma_f32_16x16x32_bf16 v[160:163], v[40:43], a[112:115], v[160:163]
    ds_read_b64_tr_b16 v[58:59], v14 offset:61952
    v_mfma_f32_16x16x32_bf16 v[168:171], v[40:43], a[116:119], v[168:171]
    ds_read_b64_tr_b16 v[60:61], v15 offset:61440
    v_mfma_f32_16x16x32_bf16 v[176:179], v[40:43], a[240:243], v[176:179]
    buffer_load_dwordx4 v250, s[40:43], s94 offen offset:2048  lds
    v_mfma_f32_16x16x32_bf16 v[184:187], v[40:43], a[244:247], v[184:187]
    ds_read_b64_tr_b16 v[62:63], v15 offset:61952
    v_mfma_f32_16x16x32_bf16 v[188:191], v[44:47], a[244:247], v[188:191]
    v_mfma_f32_16x16x32_bf16 v[180:183], v[44:47], a[240:243], v[180:183]
    v_mfma_f32_16x16x32_bf16 v[172:175], v[44:47], a[116:119], v[172:175]
    v_mfma_f32_16x16x32_bf16 v[164:167], v[44:47], a[112:115], v[164:167]
    s_waitcnt lgkmcnt(1)
    v_mfma_f32_16x16x32_bf16 v[128:131], v[48:51], a[120:123], v[128:131]
    v_mfma_f32_16x16x32_bf16 v[136:139], v[48:51], a[124:127], v[136:139]
    v_mfma_f32_16x16x32_bf16 v[144:147], v[48:51], a[248:251], v[144:147]
    buffer_load_dwordx4 v251, s[40:43], s94 offen offset:3072  lds
    v_mfma_f32_16x16x32_bf16 v[152:155], v[48:51], a[252:255], v[152:155]
    v_mfma_f32_16x16x32_bf16 v[156:159], v[52:55], a[252:255], v[156:159]
    v_mfma_f32_16x16x32_bf16 v[148:151], v[52:55], a[248:251], v[148:151]
    s_add_u32 m0, s97, 49152
    v_mfma_f32_16x16x32_bf16 v[140:143], v[52:55], a[124:127], v[140:143]
    v_mfma_f32_16x16x32_bf16 v[132:135], v[52:55], a[120:123], v[132:135]
    v_mfma_f32_16x16x32_bf16 v[160:163], v[56:59], a[120:123], v[160:163]
    s_waitcnt vmcnt(9) lgkmcnt(0)
    s_barrier
    v_mfma_f32_16x16x32_bf16 v[168:171], v[56:59], a[124:127], v[168:171]
    ds_read_b64_tr_b16 v[32:33], v242 offset:0
    v_mfma_f32_16x16x32_bf16 v[176:179], v[56:59], a[248:251], v[176:179]
    buffer_load_dwordx4 v248, s[40:43], s95 offen offset:0  lds
    v_mfma_f32_16x16x32_bf16 v[184:187], v[56:59], a[252:255], v[184:187]
    ds_read_b64_tr_b16 v[34:35], v242 offset:256
    v_mfma_f32_16x16x32_bf16 v[188:191], v[60:63], a[252:255], v[188:191]
    ds_read_b64_tr_b16 v[36:37], v242 offset:8192
    v_mfma_f32_16x16x32_bf16 v[180:183], v[60:63], a[248:251], v[180:183]
    ds_read_b64_tr_b16 v[38:39], v242 offset:8448
    v_mfma_f32_16x16x32_bf16 v[172:175], v[60:63], a[124:127], v[172:175]
    ds_read_b64_tr_b16 v[40:41], v242 offset:2048
    v_mfma_f32_16x16x32_bf16 v[164:167], v[60:63], a[120:123], v[164:167]
    s_waitcnt lgkmcnt(3)
    ds_read_b64_tr_b16 v[42:43], v242 offset:2304
    v_mfma_f32_16x16x32_bf16 v[64:67], v[32:35], a[0:3], 0
    ds_read_b64_tr_b16 v[44:45], v242 offset:10240
    v_mfma_f32_16x16x32_bf16 v[68:71], v[32:35], a[4:7], 0
    ds_read_b64_tr_b16 v[46:47], v242 offset:10496
    v_mfma_f32_16x16x32_bf16 v[72:75], v[32:35], a[128:131], 0
    buffer_load_dwordx4 v249, s[40:43], s95 offen offset:1024  lds
    v_mfma_f32_16x16x32_bf16 v[76:79], v[32:35], a[132:135], 0
    s_waitcnt lgkmcnt(3)
    ds_read_b64_tr_b16 v[48:49], v242 offset:4096
    v_mfma_f32_16x16x32_bf16 v[92:95], v[36:39], a[132:135], 0
    ds_read_b64_tr_b16 v[50:51], v242 offset:4352
    v_max_f32 v128, 0, v128
    v_mfma_f32_16x16x32_bf16 v[88:91], v[36:39], a[128:131], 0
    ds_read_b64_tr_b16 v[52:53], v242 offset:12288
    v_max_f32 v129, 0, v129
    v_mfma_f32_16x16x32_bf16 v[84:87], v[36:39], a[4:7], 0
    ds_read_b64_tr_b16 v[54:55], v242 offset:12544
    v_mul_f32 v128, v128, v160
    v_mfma_f32_16x16x32_bf16 v[80:83], v[36:39], a[0:3], 0
    s_waitcnt lgkmcnt(4)
    ds_read_b64_tr_b16 v[56:57], v242 offset:6144
    v_mfma_f32_16x16x32_bf16 v[64:67], v[40:43], a[8:11], v[64:67]
    ds_read_b64_tr_b16 v[58:59], v242 offset:6400
    v_mul_f32 v129, v129, v161
    v_cvt_pk_bf16_f32 v128, v128, v129
    v_mfma_f32_16x16x32_bf16 v[68:71], v[40:43], a[12:15], v[68:71]
    ds_read_b64_tr_b16 v[60:61], v242 offset:14336
    v_max_f32 v130, 0, v130
    v_mfma_f32_16x16x32_bf16 v[72:75], v[40:43], a[136:139], v[72:75]
    buffer_load_dwordx4 v250, s[40:43], s95 offen offset:2048  lds
    v_mfma_f32_16x16x32_bf16 v[76:79], v[40:43], a[140:143], v[76:79]
    ds_read_b64_tr_b16 v[62:63], v242 offset:14592
    v_max_f32 v131, 0, v131
    v_mul_f32 v130, v130, v162
    v_mul_f32 v131, v131, v163
    v_mfma_f32_16x16x32_bf16 v[92:95], v[44:47], a[140:143], v[92:95]
    v_cvt_pk_bf16_f32 v129, v130, v131
    v_max_f32 v132, 0, v132
    v_max_f32 v133, 0, v133
    v_mfma_f32_16x16x32_bf16 v[88:91], v[44:47], a[136:139], v[88:91]
    v_mul_f32 v132, v132, v164
    v_mul_f32 v133, v133, v165
    v_mfma_f32_16x16x32_bf16 v[84:87], v[44:47], a[12:15], v[84:87]
    v_cvt_pk_bf16_f32 v130, v132, v133
    v_max_f32 v134, 0, v134
    v_mfma_f32_16x16x32_bf16 v[80:83], v[44:47], a[8:11], v[80:83]
    s_waitcnt lgkmcnt(1)
    v_max_f32 v135, 0, v135
    v_mul_f32 v134, v134, v166
    v_mfma_f32_16x16x32_bf16 v[64:67], v[48:51], a[16:19], v[64:67]
    v_mul_f32 v135, v135, v167
    v_cvt_pk_bf16_f32 v131, v134, v135
    v_mfma_f32_16x16x32_bf16 v[68:71], v[48:51], a[20:23], v[68:71]
    buffer_store_dwordx4 v[128:131], v0, s[44:47], s8 offen offset:0 sc1
    v_mfma_f32_16x16x32_bf16 v[72:75], v[48:51], a[144:147], v[72:75]
    buffer_load_dwordx4 v251, s[40:43], s95 offen offset:3072  lds
    v_mfma_f32_16x16x32_bf16 v[76:79], v[48:51], a[148:151], v[76:79]
    v_max_f32 v136, 0, v136
    v_max_f32 v137, 0, v137
    v_mul_f32 v136, v136, v168
    v_mfma_f32_16x16x32_bf16 v[92:95], v[52:55], a[148:151], v[92:95]
    v_mul_f32 v137, v137, v169
    v_cvt_pk_bf16_f32 v136, v136, v137
    v_mfma_f32_16x16x32_bf16 v[88:91], v[52:55], a[144:147], v[88:91]
    v_max_f32 v138, 0, v138
    v_max_f32 v139, 0, v139
    v_mfma_f32_16x16x32_bf16 v[84:87], v[52:55], a[20:23], v[84:87]
    v_mul_f32 v138, v138, v170
    v_mul_f32 v139, v139, v171
    v_mfma_f32_16x16x32_bf16 v[80:83], v[52:55], a[16:19], v[80:83]
    v_cvt_pk_bf16_f32 v137, v138, v139
    v_max_f32 v140, 0, v140
    v_mfma_f32_16x16x32_bf16 v[64:67], v[56:59], a[24:27], v[64:67]
    s_waitcnt vmcnt(9) lgkmcnt(0)
    s_barrier
    v_max_f32 v141, 0, v141
    v_mfma_f32_16x16x32_bf16 v[68:71], v[56:59], a[28:31], v[68:71]
    ds_read_b64_tr_b16 v[32:33], v242 offset:16384
    v_mul_f32 v140, v140, v172
    v_mfma_f32_16x16x32_bf16 v[72:75], v[56:59], a[152:155], v[72:75]
    ds_read_b64_tr_b16 v[34:35], v242 offset:16640
    v_mul_f32 v141, v141, v173
    v_mfma_f32_16x16x32_bf16 v[76:79], v[56:59], a[156:159], v[76:79]
    ds_read_b64_tr_b16 v[36:37], v242 offset:24576
    v_cvt_pk_bf16_f32 v138, v140, v141
    v_mfma_f32_16x16x32_bf16 v[92:95], v[60:63], a[156:159], v[92:95]
    ds_read_b64_tr_b16 v[38:39], v242 offset:24832
    v_max_f32 v142, 0, v142
    v_max_f32 v143, 0, v143
    v_mfma_f32_16x16x32_bf16 v[88:91], v[60:63], a[152:155], v[88:91]
    s_add_u32 m0, s97, 65536
    ds_read_b64_tr_b16 v[40:41], v242 offset:18432
    v_mfma_f32_16x16x32_bf16 v[84:87], v[60:63], a[28:31], v[84:87]
    s_lshl_b32 s23, s0, 3
    ds_read_b64_tr_b16 v[42:43], v242 offset:18688
    v_mul_f32 v142, v142, v174
    v_mul_f32 v143, v143, v175
    v_mfma_f32_16x16x32_bf16 v[80:83], v[60:63], a[24:27], v[80:83]
    s_waitcnt lgkmcnt(4)
    ds_read_b64_tr_b16 v[44:45], v242 offset:26624
    v_cvt_pk_bf16_f32 v139, v142, v143
    v_mfma_f32_16x16x32_bf16 v[64:67], v[32:35], a[32:35], v[64:67]
    ds_read_b64_tr_b16 v[46:47], v242 offset:26880
    buffer_store_dwordx4 v[136:139], v0, s[44:47], s8 offen offset:1024 sc1
    v_max_f32 v144, 0, v144
    v_mfma_f32_16x16x32_bf16 v[68:71], v[32:35], a[36:39], v[68:71]
    ds_read_b64_tr_b16 v[48:49], v242 offset:20480
    v_max_f32 v145, 0, v145
L_padK2:
    s_cbranch_execz L_retK
    v_mul_f32 v144, v144, v176
    v_mul_f32 v145, v145, v177
    v_mfma_f32_16x16x32_bf16 v[72:75], v[32:35], a[160:163], v[72:75]
    buffer_load_dwordx4 v10, s[52:55], s23 offen offset:0 sc1 lds
    ds_read_b64_tr_b16 a[128:129], v28 offset:16384
    v_mfma_f32_16x16x32_bf16 v[76:79], v[32:35], a[164:167], v[76:79]
    s_waitcnt lgkmcnt(4)
    ds_read_b64_tr_b16 v[50:51], v242 offset:20736
    v_cvt_pk_bf16_f32 v144, v144, v145
    v_max_f32 v146, 0, v146
    v_max_f32 v147, 0, v147
    v_mfma_f32_16x16x32_bf16 v[92:95], v[36:39], a[164:167], v[92:95]
    ds_read_b64_tr_b16 v[52:53], v242 offset:28672
    v_mul_f32 v146, v146, v178
    v_mul_f32 v147, v147, v179
    v_mfma_f32_16x16x32_bf16 v[88:91], v[36:39], a[160:163], v[88:91]
    ds_read_b64_tr_b16 v[54:55], v242 offset:28928
    ds_read_b64_tr_b16 a[130:131], v28 offset:18432
    v_cvt_pk_bf16_f32 v145, v146, v147
    v_mfma_f32_16x16x32_bf16 v[84:87], v[36:39], a[36:39], v[84:87]
    buffer_load_dwordx4 v11, s[52:55], s23 offen offset:1024 sc1 lds
    ds_read_b64_tr_b16 a[132:133], v29 offset:16384
    v_mfma_f32_16x16x32_bf16 v[80:83], v[36:39], a[32:35], v[80:83]
    ds_read_b64_tr_b16 v[56:57], v242 offset:22528
    v_max_f32 v148, 0, v148
    v_max_f32 v149, 0, v149
    v_mul_f32 v148, v148, v180
    v_mul_f32 v149, v149, v181
    v_mfma_f32_16x16x32_bf16 v[64:67], v[40:43], a[40:43], v[64:67]
    ds_read_b64_tr_b16 v[58:59], v242 offset:22784
    v_cvt_pk_bf16_f32 v146, v148, v149
    v_max_f32 v150, 0, v150
    v_mfma_f32_16x16x32_bf16 v[68:71], v[40:43], a[44:47], v[68:71]
    ds_read_b64_tr_b16 v[60:61], v242 offset:30720
    ds_read_b64_tr_b16 a[134:135], v29 offset:18432
    v_mfma_f32_16x16x32_bf16 v[72:75], v[40:43], a[168:171], v[72:75]
    buffer_load_dwordx4 v12, s[52:55], s23 offen offset:2048 sc1 lds
    ds_read_b64_tr_b16 a[136:137], v30 offset:16384
    v_mfma_f32_16x16x32_bf16 v[76:79], v[40:43], a[172:175], v[76:79]
    s_waitcnt lgkmcnt(7)
    ds_read_b64_tr_b16 v[62:63], v242 offset:30976
    v_max_f32 v151, 0, v151
    v_mul_f32 v150, v150, v182
    v_mul_f32 v151, v151, v183
    v_mfma_f32_16x16x32_bf16 v[92:95], v[44:47], a[172:175], v[92:95]
    ds_read_b64_tr_b16 a[138:139], v30 offset:18432
    v_cvt_pk_bf16_f32 v147, v150, v151
    v_max_f32 v152, 0, v152
    v_max_f32 v153, 0, v153
    v_mfma_f32_16x16x32_bf16 v[88:91], v[44:47], a[168:171], v[88:91]
    buffer_store_dwordx4 v[144:147], v0, s[44:47], s9 offen offset:0 sc1
    v_mul_f32 v152, v152, v184
    v_mfma_f32_16x16x32_bf16 v[84:87], v[44:47], a[44:47], v[84:87]
    buffer_load_dwordx4 v13, s[52:55], s23 offen offset:3072 sc1 lds
    ds_read_b64_tr_b16 a[140:141], v31 offset:16384
    v_mfma_f32_16x16x32_bf16 v[80:83], v[44:47], a[40:43], v[80:83]
    ds_read_b64_tr_b16 a[142:143], v31 offset:18432
    v_mul_f32 v153, v153, v185
    v_cvt_pk_bf16_f32 v152, v152, v153
    v_max_f32 v154, 0, v154
    v_max_f32 v155, 0, v155
    v_mfma_f32_16x16x32_bf16 v[64:67], v[48:51], a[48:51], v[64:67]
    ds_read_b64_tr_b16 a[0:1], v28 offset:32768
    v_mul_f32 v154, v154, v186
    v_mfma_f32_16x16x32_bf16 v[68:71], v[48:51], a[52:55], v[68:71]
    ds_read_b64_tr_b16 a[2:3], v28 offset:34816
    v_mul_f32 v155, v155, v187
    v_cvt_pk_bf16_f32 v153, v154, v155
    v_mfma_f32_16x16x32_bf16 v[72:75], v[48:51], a[176:179], v[72:75]
    ds_read_b64_tr_b16 a[4:5], v29 offset:32768
    v_max_f32 v156, 0, v156
    v_max_f32 v157, 0, v157
    v_mfma_f32_16x16x32_bf16 v[76:79], v[48:51], a[180:183], v[76:79]
    buffer_load_dwordx2 v[8:9], v6, s[44:47], s4 offen offset:512 sc1
    ds_read_b64_tr_b16 a[6:7], v29 offset:34816
    v_mfma_f32_16x16x32_bf16 v[92:95], v[52:55], a[180:183], v[92:95]
    ds_read_b64_tr_b16 a[8:9], v30 offset:32768
    v_mul_f32 v156, v156, v188
    v_mul_f32 v157, v157, v189
    v_cvt_pk_bf16_f32 v154, v156, v157
    v_mfma_f32_16x16x32_bf16 v[88:91], v[52:55], a[176:179], v[88:91]
    v_max_f32 v158, 0, v158
    v_max_f32 v159, 0, v159
    v_mfma_f32_16x16x32_bf16 v[84:87], v[52:55], a[52:55], v[84:87]
    v_mul_f32 v158, v158, v190
    v_mul_f32 v159, v159, v191
    v_mfma_f32_16x16x32_bf16 v[80:83], v[52:55], a[48:51], v[80:83]
    s_waitcnt lgkmcnt(8)
    v_cvt_pk_bf16_f32 v155, v158, v159
    v_mfma_f32_16x16x32_bf16 v[64:67], v[56:59], a[56:59], v[64:67]
    s_waitcnt vmcnt(12) lgkmcnt(0)
    s_barrier
    v_mfma_f32_16x16x32_bf16 v[68:71], v[56:59], a[60:63], v[68:71]
    ds_read_b64_tr_b16 v[32:33], v242 offset:32768
    buffer_store_dwordx4 v[152:155], v0, s[44:47], s9 offen offset:1024 sc1
    v_mfma_f32_16x16x32_bf16 v[72:75], v[56:59], a[184:187], v[72:75]
    ds_read_b64_tr_b16 v[34:35], v242 offset:33024
    v_mfma_f32_16x16x32_bf16 v[76:79], v[56:59], a[188:191], v[76:79]
    ds_read_b64_tr_b16 v[36:37], v242 offset:40960
    v_mfma_f32_16x16x32_bf16 v[92:95], v[60:63], a[188:191], v[92:95]
    ds_read_b64_tr_b16 v[38:39], v242 offset:41216
    ds_read_b64_tr_b16 a[10:11], v30 offset:34816
    v_mfma_f32_16x16x32_bf16 v[88:91], v[60:63], a[184:187], v[88:91]
    s_add_u32 m0, s97, 81920
    ds_read_b64_tr_b16 v[40:41], v242 offset:34816
    v_mfma_f32_16x16x32_bf16 v[84:87], v[60:63], a[60:63], v[84:87]
    ds_read_b64_tr_b16 v[42:43], v242 offset:35072
    v_mfma_f32_16x16x32_bf16 v[80:83], v[60:63], a[56:59], v[80:83]
    s_waitcnt lgkmcnt(5)
    ds_read_b64_tr_b16 v[44:45], v242 offset:43008
    ds_read_b64_tr_b16 a[12:13], v31 offset:32768
    v_mfma_f32_16x16x32_bf16 v[64:67], v[32:35], a[64:67], v[64:67]
    ds_read_b64_tr_b16 v[46:47], v242 offset:43264
    v_mfma_f32_16x16x32_bf16 v[68:71], v[32:35], a[68:71], v[68:71]
    ds_read_b64_tr_b16 v[48:49], v242 offset:36864
    v_mfma_f32_16x16x32_bf16 v[72:75], v[32:35], a[192:195], v[72:75]
    buffer_load_dwordx4 v10, s[48:51], s69 offen offset:0 sc1 lds
    ds_read_b64_tr_b16 a[14:15], v31 offset:34816
    v_mfma_f32_16x16x32_bf16 v[76:79], v[32:35], a[196:199], v[76:79]
    s_waitcnt lgkmcnt(5)
    ds_read_b64_tr_b16 v[50:51], v242 offset:37120
    v_mfma_f32_16x16x32_bf16 v[92:95], v[36:39], a[196:199], v[92:95]
    ds_read_b64_tr_b16 v[52:53], v242 offset:45056
    v_mfma_f32_16x16x32_bf16 v[88:91], v[36:39], a[192:195], v[88:91]
    ds_read_b64_tr_b16 v[54:55], v242 offset:45312
    ds_read_b64_tr_b16 a[144:145], v28 offset:49152
    v_mfma_f32_16x16x32_bf16 v[84:87], v[36:39], a[68:71], v[84:87]
    buffer_load_dwordx4 v11, s[48:51], s69 offen offset:1024 sc1 lds
    ds_read_b64_tr_b16 a[146:147], v28 offset:51200
    v_mfma_f32_16x16x32_bf16 v[80:83], v[36:39], a[64:67], v[80:83]
    ds_read_b64_tr_b16 v[56:57], v242 offset:38912
    v_mfma_f32_16x16x32_bf16 v[64:67], v[40:43], a[72:75], v[64:67]
    ds_read_b64_tr_b16 v[58:59], v242 offset:39168
    v_mfma_f32_16x16x32_bf16 v[68:71], v[40:43], a[76:79], v[68:71]
    ds_read_b64_tr_b16 v[60:61], v242 offset:47104
    ds_read_b64_tr_b16 a[148:149], v29 offset:49152
    v_mfma_f32_16x16x32_bf16 v[72:75], v[40:43], a[200:203], v[72:75]
    buffer_load_dwordx4 v12, s[48:51], s69 offen offset:2048 sc1 lds
    ds_read_b64_tr_b16 a[150:151], v29 offset:51200
    v_mfma_f32_16x16x32_bf16 v[76:79], v[40:43], a[204:207], v[76:79]
    s_waitcnt lgkmcnt(7)
    ds_read_b64_tr_b16 v[62:63], v242 offset:47360
    v_mfma_f32_16x16x32_bf16 v[92:95], v[44:47], a[204:207], v[92:95]
    ds_read_b64_tr_b16 a[152:153], v30 offset:49152
    v_mfma_f32_16x16x32_bf16 v[88:91], v[44:47], a[200:203], v[88:91]
    ds_read_b64_tr_b16 a[154:155], v30 offset:51200
    v_mfma_f32_16x16x32_bf16 v[84:87], v[44:47], a[76:79], v[84:87]
    buffer_load_dwordx4 v13, s[48:51], s69 offen offset:3072 sc1 lds
    ds_read_b64_tr_b16 a[156:157], v31 offset:49152
    v_mfma_f32_16x16x32_bf16 v[80:83], v[44:47], a[72:75], v[80:83]
    s_add_u32 m0, s97, 98304
    ds_read_b64_tr_b16 a[158:159], v31 offset:51200
    v_mfma_f32_16x16x32_bf16 v[64:67], v[48:51], a[80:83], v[64:67]
    v_mfma_f32_16x16x32_bf16 v[68:71], v[48:51], a[84:87], v[68:71]
    v_mfma_f32_16x16x32_bf16 v[72:75], v[48:51], a[208:211], v[72:75]
    buffer_load_dwordx4 v10, s[48:51], s70 offen offset:0 sc1 lds
    v_mfma_f32_16x16x32_bf16 v[76:79], v[48:51], a[212:215], v[76:79]
    v_mfma_f32_16x16x32_bf16 v[92:95], v[52:55], a[212:215], v[92:95]
    v_mfma_f32_16x16x32_bf16 v[88:91], v[52:55], a[208:211], v[88:91]
    v_mfma_f32_16x16x32_bf16 v[84:87], v[52:55], a[84:87], v[84:87]
    buffer_load_dwordx4 v11, s[48:51], s70 offen offset:1024 sc1 lds
    v_mfma_f32_16x16x32_bf16 v[80:83], v[52:55], a[80:83], v[80:83]
    s_waitcnt lgkmcnt(4)
    v_mfma_f32_16x16x32_bf16 v[64:67], v[56:59], a[88:91], v[64:67]
    s_waitcnt vmcnt(14) lgkmcnt(0)
    s_barrier
    v_mfma_f32_16x16x32_bf16 v[68:71], v[56:59], a[92:95], v[68:71]
    ds_read_b64_tr_b16 v[32:33], v242 offset:49152
    v_mfma_f32_16x16x32_bf16 v[72:75], v[56:59], a[216:219], v[72:75]
    buffer_load_dwordx4 v12, s[48:51], s70 offen offset:2048 sc1 lds
    v_mfma_f32_16x16x32_bf16 v[76:79], v[56:59], a[220:223], v[76:79]
    ds_read_b64_tr_b16 v[34:35], v242 offset:49408
    v_mfma_f32_16x16x32_bf16 v[92:95], v[60:63], a[220:223], v[92:95]
    ds_read_b64_tr_b16 v[36:37], v242 offset:57344
    v_mfma_f32_16x16x32_bf16 v[88:91], v[60:63], a[216:219], v[88:91]
    ds_read_b64_tr_b16 v[38:39], v242 offset:57600
    v_mfma_f32_16x16x32_bf16 v[84:87], v[60:63], a[92:95], v[84:87]
    buffer_load_dwordx4 v13, s[48:51], s70 offen offset:3072 sc1 lds
    v_mfma_f32_16x16x32_bf16 v[80:83], v[60:63], a[88:91], v[80:83]
    s_waitcnt lgkmcnt(2)
    ds_read_b64_tr_b16 v[40:41], v242 offset:51200
    v_mfma_f32_16x16x32_bf16 v[64:67], v[32:35], a[96:99], v[64:67]
    s_add_u32 m0, s97, 0
    ds_read_b64_tr_b16 v[42:43], v242 offset:51456
    v_mfma_f32_16x16x32_bf16 v[68:71], v[32:35], a[100:103], v[68:71]
    ds_read_b64_tr_b16 v[44:45], v242 offset:59392
    v_mfma_f32_16x16x32_bf16 v[72:75], v[32:35], a[224:227], v[72:75]
    buffer_load_dwordx4 v10, s[48:51], s71 offen offset:0 sc1 lds
    v_mfma_f32_16x16x32_bf16 v[76:79], v[32:35], a[228:231], v[76:79]
    s_waitcnt lgkmcnt(3)
    ds_read_b64_tr_b16 v[46:47], v242 offset:59648
    v_mfma_f32_16x16x32_bf16 v[92:95], v[36:39], a[228:231], v[92:95]
    ds_read_b64_tr_b16 v[48:49], v242 offset:53248
    v_mfma_f32_16x16x32_bf16 v[88:91], v[36:39], a[224:227], v[88:91]
    ds_read_b64_tr_b16 v[50:51], v242 offset:53504
    v_mfma_f32_16x16x32_bf16 v[84:87], v[36:39], a[100:103], v[84:87]
    buffer_load_dwordx4 v11, s[48:51], s71 offen offset:1024 sc1 lds
    v_mfma_f32_16x16x32_bf16 v[80:83], v[36:39], a[96:99], v[80:83]
    s_waitcnt lgkmcnt(3)
    ds_read_b64_tr_b16 v[52:53], v242 offset:61440
    v_mfma_f32_16x16x32_bf16 v[64:67], v[40:43], a[104:107], v[64:67]
    ds_read_b64_tr_b16 v[54:55], v242 offset:61696
    v_mfma_f32_16x16x32_bf16 v[68:71], v[40:43], a[108:111], v[68:71]
    ds_read_b64_tr_b16 v[56:57], v242 offset:55296
    v_mfma_f32_16x16x32_bf16 v[72:75], v[40:43], a[232:235], v[72:75]
    buffer_load_dwordx4 v12, s[48:51], s71 offen offset:2048 sc1 lds
    v_mfma_f32_16x16x32_bf16 v[76:79], v[40:43], a[236:239], v[76:79]
    s_waitcnt lgkmcnt(3)
    ds_read_b64_tr_b16 v[58:59], v242 offset:55552
    v_mfma_f32_16x16x32_bf16 v[92:95], v[44:47], a[236:239], v[92:95]
    ds_read_b64_tr_b16 v[60:61], v242 offset:63488
    v_mfma_f32_16x16x32_bf16 v[88:91], v[44:47], a[232:235], v[88:91]
    ds_read_b64_tr_b16 v[62:63], v242 offset:63744
    v_mfma_f32_16x16x32_bf16 v[84:87], v[44:47], a[108:111], v[84:87]
    buffer_load_dwordx4 v13, s[48:51], s71 offen offset:3072 sc1 lds
    v_mfma_f32_16x16x32_bf16 v[80:83], v[44:47], a[104:107], v[80:83]
    v_mfma_f32_16x16x32_bf16 v[64:67], v[48:51], a[112:115], v[64:67]
    v_mfma_f32_16x16x32_bf16 v[68:71], v[48:51], a[116:119], v[68:71]
    v_mfma_f32_16x16x32_bf16 v[72:75], v[48:51], a[240:243], v[72:75]
    v_mfma_f32_16x16x32_bf16 v[76:79], v[48:51], a[244:247], v[76:79]
    s_waitcnt lgkmcnt(0)
    v_mfma_f32_16x16x32_bf16 v[92:95], v[52:55], a[244:247], v[92:95]
    v_mfma_f32_16x16x32_bf16 v[88:91], v[52:55], a[240:243], v[88:91]
    v_mfma_f32_16x16x32_bf16 v[84:87], v[52:55], a[116:119], v[84:87]
    v_mfma_f32_16x16x32_bf16 v[80:83], v[52:55], a[112:115], v[80:83]
    v_mfma_f32_16x16x32_bf16 v[64:67], v[56:59], a[120:123], v[64:67]
    s_barrier
    v_mfma_f32_16x16x32_bf16 v[68:71], v[56:59], a[124:127], v[68:71]
    v_mfma_f32_16x16x32_bf16 v[72:75], v[56:59], a[248:251], v[72:75]
    v_mfma_f32_16x16x32_bf16 v[76:79], v[56:59], a[252:255], v[76:79]
    v_mfma_f32_16x16x32_bf16 v[92:95], v[60:63], a[252:255], v[92:95]
    v_mfma_f32_16x16x32_bf16 v[88:91], v[60:63], a[248:251], v[88:91]
    v_mfma_f32_16x16x32_bf16 v[84:87], v[60:63], a[124:127], v[84:87]
    v_mfma_f32_16x16x32_bf16 v[80:83], v[60:63], a[120:123], v[80:83]
    s_waitcnt vmcnt(13)
    v_cmp_eq_u64 vcc, s[6:7], v[8:9]
    s_nop 0
    s_cmp_eq_u64 vcc, -1
    s_cbranch_scc0 L_slow_vK
L_back_vK:
    s_bfe_u32 s20, s2, 5
    s_xor_b32 s20, s20, s26
    v_lshl_add_u32 v2, s20, 10, v0
    v_add_u32 v2, s18, v2
    v_xor_b32 v3, 1024, v2
    v_xor_b32 v4, 2048, v2
    v_xor_b32 v5, 3072, v2
    buffer_load_dwordx4 v[192:195], v2, s[44:47], s0 offen sc1
    v_max_f32 v64, 0, v64
    v_max_f32 v65, 0, v65
    v_mul_f32 v64, v64, v80
    v_mul_f32 v65, v65, v81
    v_cvt_pk_bf16_f32 v64, v64, v65
    v_max_f32 v66, 0, v66
    v_max_f32 v67, 0, v67
    v_mul_f32 v66, v66, v82
    v_mul_f32 v67, v67, v83
    v_cvt_pk_bf16_f32 v65, v66, v67
    v_max_f32 v68, 0, v68
    v_max_f32 v69, 0, v69
    buffer_load_dwordx4 v[196:199], v3, s[44:47], s0 offen sc1
    v_mul_f32 v68, v68, v84
    v_mul_f32 v69, v69, v85
    v_cvt_pk_bf16_f32 v66, v68, v69
    v_max_f32 v70, 0, v70
    v_max_f32 v71, 0, v71
    v_mul_f32 v70, v70, v86
    v_mul_f32 v71, v71, v87
    v_cvt_pk_bf16_f32 v67, v70, v71
    v_permlane16_swap_b32 v64, v66
    s_nop 0
    v_permlane16_swap_b32 v65, v67
    buffer_store_dwordx4 v[64:67], v243, s[44:47], s15 offen sc1
    s_xor_b32 s15, s15, 2048
    buffer_load_dwordx4 v[200:203], v4, s[44:47], s0 offen sc1
    v_max_f32 v72, 0, v72
    v_max_f32 v73, 0, v73
    v_mul_f32 v72, v72, v88
    v_mul_f32 v73, v73, v89
    v_cvt_pk_bf16_f32 v72, v72, v73
    v_max_f32 v74, 0, v74
    v_max_f32 v75, 0, v75
    v_mul_f32 v74, v74, v90
    v_mul_f32 v75, v75, v91
    v_cvt_pk_bf16_f32 v73, v74, v75
    v_max_f32 v76, 0, v76
    v_max_f32 v77, 0, v77
    buffer_load_dwordx4 v[204:207], v5, s[44:47], s0 offen sc1
    v_mul_f32 v76, v76, v92
    v_mul_f32 v77, v77, v93
    v_cvt_pk_bf16_f32 v74, v76, v77
    v_max_f32 v78, 0, v78
    v_max_f32 v79, 0, v79
    v_mul_f32 v78, v78, v94
    v_mul_f32 v79, v79, v95
    v_cvt_pk_bf16_f32 v75, v78, v79
    v_permlane16_swap_b32 v72, v74
    s_nop 0
    v_permlane16_swap_b32 v73, v75
    buffer_store_dwordx4 v[72:75], v243, s[44:47], s15 offen sc1
    s_waitcnt vmcnt(14)
    ds_read_b64_tr_b16 a[16:17], v28 offset:16384
    ds_read_b64_tr_b16 a[18:19], v28 offset:18432
    ds_read_b64_tr_b16 a[20:21], v29 offset:16384
    ds_read_b64_tr_b16 a[22:23], v29 offset:18432
    ds_read_b64_tr_b16 a[24:25], v30 offset:16384
    ds_read_b64_tr_b16 a[26:27], v30 offset:18432
    ds_read_b64_tr_b16 a[28:29], v31 offset:16384
    ds_read_b64_tr_b16 a[30:31], v31 offset:18432
    buffer_load_dwordx4 v[208:211], v2, s[44:47], s5 offen sc1
    buffer_load_dwordx4 v[212:215], v3, s[44:47], s5 offen sc1
    buffer_load_dwordx4 v[216:219], v4, s[44:47], s5 offen sc1
    buffer_load_dwordx4 v[220:223], v5, s[44:47], s5 offen sc1
    buffer_store_dwordx2 v[20:21], v1, s[44:47], s10 offen offset:1024 sc1
    s_add_u32 m0, s97, 16384
    s_nop 0
    buffer_load_dwordx4 v10, s[48:51], s73 offen offset:0 sc1 lds
    buffer_load_dwordx4 v11, s[48:51], s73 offen offset:1024 sc1 lds
    buffer_load_dwordx4 v12, s[48:51], s73 offen offset:2048 sc1 lds
    buffer_load_dwordx4 v13, s[48:51], s73 offen offset:3072 sc1 lds
    s_add_u32 m0, s97, 32768
    s_nop 0
    buffer_load_dwordx4 v10, s[48:51], s74 offen offset:0 sc1 lds
    v_lshlrev_b32 v14, 3, v0
    v_and_b32 v14, 0x380, v14
    v_bfe_u32 v57, v0, 6, 1
    v_lshl_add_u32 v57, v57, 13, v6
    s_andn2_b32 s19, s4, 0x2000
    v_add_u32 v40, 0x20000, v24
    v_add_u32 v41, 0x20000, v25
    v_add_u32 v42, 0x20000, v26
    v_add_u32 v43, 0x20000, v27
    v_lshrrev_b32 v7, 2, v0
    s_waitcnt vmcnt(15)
    v_mfma_f32_16x16x32_bf16 v[64:67], a[128:131], v[192:195], 0
    v_and_b32 v7, 0x3c, v7
    v_lshl_add_u32 v7, s20, 6, v7
    v_mfma_f32_16x16x32_bf16 v[68:71], a[132:135], v[192:195], 0
    buffer_load_dwordx4 v11, s[48:51], s74 offen offset:1024 sc1 lds
    v_mfma_f32_16x16x32_bf16 v[72:75], a[136:139], v[192:195], 0
    v_xor_b32 v15, 64, v7
    s_lshl_b32 s98, s17, 8
    v_mfma_f32_16x16x32_bf16 v[76:79], a[140:143], v[192:195], 0
    s_waitcnt vmcnt(15)
    s_mul_i32 s9, s100, -294912
    s_add_u32 s9, s9, 147456
    v_mfma_f32_16x16x32_bf16 v[92:95], a[140:143], v[196:199], 0
    ds_read_b64_tr_b16 a[160:161], v28 offset:32768
    v_xor_b32 v32, 0x2000, v24
    v_mfma_f32_16x16x32_bf16 v[88:91], a[136:139], v[196:199], 0
    buffer_load_dwordx4 v12, s[48:51], s74 offen offset:2048 sc1 lds
    v_mfma_f32_16x16x32_bf16 v[84:87], a[132:135], v[196:199], 0
    ds_read_b64_tr_b16 a[162:163], v28 offset:34816
    v_xor_b32 v33, 0x2000, v25
    v_mfma_f32_16x16x32_bf16 v[80:83], a[128:131], v[196:199], 0
    s_waitcnt vmcnt(14)
    ds_read_b64_tr_b16 a[164:165], v29 offset:32768
    v_mfma_f32_16x16x32_bf16 v[96:99], a[128:131], v[200:203], 0
    ds_read_b64_tr_b16 a[166:167], v29 offset:34816
    v_xor_b32 v34, 0x2000, v26
    v_mfma_f32_16x16x32_bf16 v[100:103], a[132:135], v[200:203], 0
    buffer_load_dwordx4 v13, s[48:51], s74 offen offset:3072 sc1 lds
    v_mfma_f32_16x16x32_bf16 v[104:107], a[136:139], v[200:203], 0
    ds_read_b64_tr_b16 a[168:169], v30 offset:32768
    v_xor_b32 v35, 0x2000, v27
    v_mfma_f32_16x16x32_bf16 v[108:111], a[140:143], v[200:203], 0
    s_waitcnt vmcnt(14)
    ds_read_b64_tr_b16 a[170:171], v30 offset:34816
    v_mfma_f32_16x16x32_bf16 v[124:127], a[140:143], v[204:207], 0
    ds_read_b64_tr_b16 a[172:173], v31 offset:32768
    v_xor_b32 v36, 0x2000, v28
    v_mfma_f32_16x16x32_bf16 v[120:123], a[136:139], v[204:207], 0
    s_add_u32 m0, s97, 114688
    s_nop 0
    buffer_load_dwordx4 v10, s[48:51], s77 offen offset:0 sc1 lds
    v_mfma_f32_16x16x32_bf16 v[116:119], a[132:135], v[204:207], 0
    ds_read_b64_tr_b16 a[174:175], v31 offset:34816
    v_xor_b32 v37, 0x2000, v29
    v_mfma_f32_16x16x32_bf16 v[112:115], a[128:131], v[204:207], 0
    s_waitcnt vmcnt(13)
    ds_read_b64_tr_b16 a[32:33], v24 offset:0
    s_waitcnt lgkmcnt(14)
    v_mfma_f32_16x16x32_bf16 v[64:67], a[16:19], v[208:211], v[64:67]
    ds_read_b64_tr_b16 a[34:35], v24 offset:2048
    v_xor_b32 v38, 0x2000, v30
    s_waitcnt lgkmcnt(14)
    v_mfma_f32_16x16x32_bf16 v[68:71], a[20:23], v[208:211], v[68:71]
    buffer_load_dwordx4 v11, s[48:51], s77 offen offset:1024 sc1 lds
    s_waitcnt lgkmcnt(12)
    v_mfma_f32_16x16x32_bf16 v[72:75], a[24:27], v[208:211], v[72:75]
    ds_read_b64_tr_b16 a[36:37], v25 offset:0
    v_xor_b32 v39, 0x2000, v31
    s_waitcnt lgkmcnt(11)
    v_mfma_f32_16x16x32_bf16 v[76:79], a[28:31], v[208:211], v[76:79]
    s_waitcnt vmcnt(13)
    ds_read_b64_tr_b16 a[38:39], v25 offset:2048
    v_mfma_f32_16x16x32_bf16 v[92:95], a[28:31], v[212:215], v[92:95]
    ds_read_b64_tr_b16 a[40:41], v26 offset:0
    v_lshrrev_b32 v48, 0, v0
    v_mfma_f32_16x16x32_bf16 v[88:91], a[24:27], v[212:215], v[88:91]
    buffer_load_dwordx4 v12, s[48:51], s77 offen offset:2048 sc1 lds
    v_mfma_f32_16x16x32_bf16 v[84:87], a[20:23], v[212:215], v[84:87]
    ds_read_b64_tr_b16 a[42:43], v26 offset:2048
    v_add_u32 v48, s97, v48
    v_mfma_f32_16x16x32_bf16 v[80:83], a[16:19], v[212:215], v[80:83]
    s_waitcnt vmcnt(13)
    ds_read_b64_tr_b16 a[44:45], v27 offset:0
    v_mfma_f32_16x16x32_bf16 v[96:99], a[16:19], v[216:219], v[96:99]
    ds_read_b64_tr_b16 a[46:47], v27 offset:2048
    v_xor_b32 v49, 0x1000, v48
    v_mfma_f32_16x16x32_bf16 v[100:103], a[20:23], v[216:219], v[100:103]
    buffer_load_dwordx4 v13, s[48:51], s77 offen offset:3072 sc1 lds
    v_mfma_f32_16x16x32_bf16 v[104:107], a[24:27], v[216:219], v[104:107]
    v_xor_b32 v50, 0x2000, v48
    v_xor_b32 v51, 0x3000, v48
    v_mfma_f32_16x16x32_bf16 v[108:111], a[28:31], v[216:219], v[108:111]
    s_waitcnt vmcnt(13)
    s_lshl2_add_u32 s24, s17, s20
    s_lshl_b32 s24, s24, 14
    v_mfma_f32_16x16x32_bf16 v[124:127], a[28:31], v[220:223], v[124:127]
    s_bfe_u32 s25, s2, 0x30003
    s_lshl_b32 s25, s25, 7
    s_add_u32 s24, s24, s25
    v_mfma_f32_16x16x32_bf16 v[120:123], a[24:27], v[220:223], v[120:123]
    buffer_load_dwordx4 v[224:227], v2, s[44:47], s12 offen sc1
    v_mfma_f32_16x16x32_bf16 v[116:119], a[20:23], v[220:223], v[116:119]
    s_add_u32 s25, s97, 147456
    v_bfe_u32 v54, v0, 4, 4
    v_lshrrev_b32 v55, 5, v0
    v_mfma_f32_16x16x32_bf16 v[112:115], a[16:19], v[220:223], v[112:115]
    v_and_b32 v55, 24, v55
    v_and_b32 v56, 0x70, v0
    buffer_load_dwordx4 v[228:231], v3, s[44:47], s12 offen sc1
    v_xor_b32 v55, v55, v56
    v_lshl_add_u32 v55, v54, 7, v55
    v_add_u32 v58, s25, v55
    v_xor_b32 v59, 32, v58
    v_xor_b32 v60, 64, v58
    v_xor_b32 v61, 96, v58
    v_lshrrev_b32 v54, 7, v0
    v_lshl_add_u32 v52, v54, 10, v56
    v_lshlrev_b32 v54, 4, v54
    v_xad_u32 v53, v54, v0, s25
    buffer_load_dwordx4 v[232:235], v4, s[44:47], s12 offen sc1
    s_add_u32 s25, s24, 8192
    buffer_load_dwordx4 v[236:239], v5, s[44:47], s12 offen sc1
    s_add_u32 m0, s97, 49152
    s_nop 0
    buffer_load_dwordx4 v10, s[48:51], s75 offen offset:0 sc1 lds
    buffer_load_dwordx4 v11, s[48:51], s75 offen offset:1024 sc1 lds
    buffer_load_dwordx4 v12, s[48:51], s75 offen offset:2048 sc1 lds
    buffer_load_dwordx4 v13, s[48:51], s75 offen offset:3072 sc1 lds
    s_waitcnt vmcnt(8)
    ds_read_b64_tr_b16 a[64:65], v28 offset:49152
    ds_read_b64_tr_b16 a[66:67], v28 offset:51200
    ds_read_b64_tr_b16 a[68:69], v29 offset:49152
    ds_read_b64_tr_b16 a[70:71], v29 offset:51200
    buffer_load_dwordx4 v[240:243], v2, s[44:47], s16 offen sc1
    ds_read_b64_tr_b16 a[72:73], v30 offset:49152
    ds_read_b64_tr_b16 a[74:75], v30 offset:51200
    ds_read_b64_tr_b16 a[76:77], v31 offset:49152
    ds_read_b64_tr_b16 a[78:79], v31 offset:51200
    s_waitcnt vmcnt(8) lgkmcnt(14)
    v_mfma_f32_16x16x32_bf16 v[64:67], a[160:163], v[224:227], v[64:67]
    v_mfma_f32_16x16x32_bf16 v[68:71], a[164:167], v[224:227], v[68:71]
    buffer_load_dwordx4 v[244:247], v3, s[44:47], s16 offen sc1
    v_mfma_f32_16x16x32_bf16 v[72:75], a[168:171], v[224:227], v[72:75]
    v_mfma_f32_16x16x32_bf16 v[76:79], a[172:175], v[224:227], v[76:79]
    s_waitcnt vmcnt(8)
    v_mfma_f32_16x16x32_bf16 v[92:95], a[172:175], v[228:231], v[92:95]
    v_mfma_f32_16x16x32_bf16 v[88:91], a[168:171], v[228:231], v[88:91]
    buffer_load_dwordx4 v[248:251], v4, s[44:47], s16 offen sc1
    v_mfma_f32_16x16x32_bf16 v[84:87], a[164:167], v[228:231], v[84:87]
    v_mfma_f32_16x16x32_bf16 v[80:83], a[160:163], v[228:231], v[80:83]
    s_waitcnt vmcnt(8)
    v_mfma_f32_16x16x32_bf16 v[96:99], a[160:163], v[232:235], v[96:99]
    v_mfma_f32_16x16x32_bf16 v[100:103], a[164:167], v[232:235], v[100:103]
    buffer_load_dwordx4 v[252:255], v5, s[44:47], s16 offen sc1
    v_mfma_f32_16x16x32_bf16 v[104:107], a[168:171], v[232:235], v[104:107]
    v_mfma_f32_16x16x32_bf16 v[108:111], a[172:175], v[232:235], v[108:111]
    s_waitcnt vmcnt(8)
    v_mfma_f32_16x16x32_bf16 v[124:127], a[172:175], v[236:239], v[124:127]
    v_mfma_f32_16x16x32_bf16 v[120:123], a[168:171], v[236:239], v[120:123]
    buffer_store_dwordx2 v[20:21], v1, s[44:47], s10 offen offset:2048 sc1
    s_add_u32 m0, s97, 81920
    s_lshl_b32 s23, s12, 3
    buffer_load_dwordx4 v10, s[52:55], s23 offen offset:0 sc1 lds
    v_mfma_f32_16x16x32_bf16 v[116:119], a[164:167], v[236:239], v[116:119]
    ds_read_b64_tr_b16 a[176:177], v24 offset:16384
    v_mfma_f32_16x16x32_bf16 v[112:115], a[160:163], v[236:239], v[112:115]
    ds_read_b64_tr_b16 a[178:179], v24 offset:18432
    buffer_load_dwordx4 v11, s[52:55], s23 offen offset:1024 sc1 lds
    ds_read_b64_tr_b16 a[180:181], v25 offset:16384
    ds_read_b64_tr_b16 a[182:183], v25 offset:18432
    ds_read_b64_tr_b16 a[184:185], v26 offset:16384
    ds_read_b64_tr_b16 a[186:187], v26 offset:18432
    buffer_load_dwordx4 v12, s[52:55], s23 offen offset:2048 sc1 lds
    ds_read_b64_tr_b16 a[188:189], v27 offset:16384
    ds_read_b64_tr_b16 a[190:191], v27 offset:18432
    buffer_load_dwordx4 v13, s[52:55], s23 offen offset:3072 sc1 lds
    s_add_u32 m0, s97, 98304
    s_lshl_b32 s23, s16, 3
    buffer_load_dwordx4 v10, s[52:55], s23 offen offset:0 sc1 lds
    ds_read_b64_tr_b16 a[48:49], v24 offset:32768
    ds_read_b64_tr_b16 a[50:51], v24 offset:34816
    ds_read_b64_tr_b16 a[52:53], v25 offset:32768
    ds_read_b64_tr_b16 a[54:55], v25 offset:34816
    s_waitcnt vmcnt(9)
    v_mfma_f32_16x16x32_bf16 v[64:67], a[32:35], v[240:243], v[64:67]
    ds_read_b64_tr_b16 a[56:57], v26 offset:32768
    s_waitcnt lgkmcnt(14)
    v_mfma_f32_16x16x32_bf16 v[68:71], a[36:39], v[240:243], v[68:71]
    buffer_load_dwordx4 v11, s[52:55], s23 offen offset:1024 sc1 lds
    v_mfma_f32_16x16x32_bf16 v[72:75], a[40:43], v[240:243], v[72:75]
    ds_read_b64_tr_b16 a[58:59], v26 offset:34816
    v_mfma_f32_16x16x32_bf16 v[76:79], a[44:47], v[240:243], v[76:79]
    s_waitcnt vmcnt(9)
    ds_read_b64_tr_b16 a[60:61], v27 offset:32768
    v_mfma_f32_16x16x32_bf16 v[92:95], a[44:47], v[244:247], v[92:95]
    ds_read_b64_tr_b16 a[62:63], v27 offset:34816
    v_mfma_f32_16x16x32_bf16 v[88:91], a[40:43], v[244:247], v[88:91]
    buffer_load_dwordx4 v12, s[52:55], s23 offen offset:2048 sc1 lds
    v_mfma_f32_16x16x32_bf16 v[84:87], a[36:39], v[244:247], v[84:87]
    v_mfma_f32_16x16x32_bf16 v[80:83], a[32:35], v[244:247], v[80:83]
    s_waitcnt vmcnt(9)
    v_mfma_f32_16x16x32_bf16 v[96:99], a[32:35], v[248:251], v[96:99]
    v_mfma_f32_16x16x32_bf16 v[100:103], a[36:39], v[248:251], v[100:103]
    buffer_load_dwordx4 v13, s[52:55], s23 offen offset:3072 sc1 lds
    v_mfma_f32_16x16x32_bf16 v[104:107], a[40:43], v[248:251], v[104:107]
    v_mfma_f32_16x16x32_bf16 v[108:111], a[44:47], v[248:251], v[108:111]
    s_waitcnt vmcnt(9)
    v_mfma_f32_16x16x32_bf16 v[124:127], a[44:47], v[252:255], v[124:127]
    v_mfma_f32_16x16x32_bf16 v[120:123], a[40:43], v[252:255], v[120:123]
    s_waitcnt lgkmcnt(0)
    s_buffer_load_dword s84, s[44:47], s4 offset:1024 glc
    s_buffer_load_dword s85, s[44:47], s4 offset:1156 glc
    s_buffer_load_dword s86, s[44:47], s4 offset:1280 glc
    s_buffer_load_dword s87, s[44:47], s4 offset:1412 glc
    s_add_u32 m0, s97, 0
    s_nop 0
    buffer_load_dwordx4 v10, s[48:51], s78 offen offset:0 sc1 lds
    v_mfma_f32_16x16x32_bf16 v[116:119], a[36:39], v[252:255], v[116:119]
    v_mfma_f32_16x16x32_bf16 v[112:115], a[32:35], v[252:255], v[112:115]
    buffer_load_dwordx4 v11, s[48:51], s78 offen offset:1024 sc1 lds
    buffer_load_dwordx4 v12, s[48:51], s78 offen offset:2048 sc1 lds
    buffer_load_dwordx4 v13, s[48:51], s78 offen offset:3072 sc1 lds
    s_add_u32 m0, s97, 16384
    s_nop 0
    buffer_load_dwordx4 v10, s[48:51], s79 offen offset:0 sc1 lds
    ds_read_b64_tr_b16 a[192:193], v24 offset:49152
    ds_read_b64_tr_b16 a[194:195], v24 offset:51200
    ds_read_b64_tr_b16 a[196:197], v25 offset:49152
    ds_read_b64_tr_b16 a[198:199], v25 offset:51200
    buffer_load_dwordx4 v11, s[48:51], s79 offen offset:1024 sc1 lds
    ds_read_b64_tr_b16 a[200:201], v26 offset:49152
    ds_read_b64_tr_b16 a[202:203], v26 offset:51200
    ds_read_b64_tr_b16 a[204:205], v27 offset:49152
    ds_read_b64_tr_b16 a[206:207], v27 offset:51200
    buffer_load_dwordx4 v12, s[48:51], s79 offen offset:2048 sc1 lds
    buffer_load_dwordx4 v13, s[48:51], s79 offen offset:3072 sc1 lds
    s_waitcnt lgkmcnt(0)
    s_cmp_eq_u64 s[84:85], s[6:7]
    s_cbranch_scc0 L_slow_eK
    s_cmp_eq_u64 s[86:87], s[6:7]
    s_cbranch_scc0 L_slow_eK
L_back_eK:
    s_add_u32 s99, s0, 16384
    buffer_load_dwordx4 v[192:195], v2, s[44:47], s99 offen sc1
    buffer_load_dwordx4 v[196:199], v3, s[44:47], s99 offen sc1
    buffer_load_dwordx4 v[200:203], v4, s[44:47], s99 offen sc1
    buffer_load_dwordx4 v[204:207], v5, s[44:47], s99 offen sc1
    s_waitcnt vmcnt(8)
    ds_read_b64_tr_b16 a[208:209], v24 offset:0
    ds_read_b64_tr_b16 a[210:211], v24 offset:2048
    ds_read_b64_tr_b16 a[212:213], v25 offset:0
    ds_read_b64_tr_b16 a[214:215], v25 offset:2048
    s_add_u32 m0, s97, 32768
    s_nop 0
    buffer_load_dwordx4 v10, s[48:51], s81 offen offset:0 sc1 lds
    ds_read_b64_tr_b16 a[216:217], v26 offset:0
    ds_read_b64_tr_b16 a[218:219], v26 offset:2048
    ds_read_b64_tr_b16 a[220:221], v27 offset:0
    ds_read_b64_tr_b16 a[222:223], v27 offset:2048
    buffer_load_dwordx4 v11, s[48:51], s81 offen offset:1024 sc1 lds
    buffer_load_dwordx4 v12, s[48:51], s81 offen offset:2048 sc1 lds
    buffer_load_dwordx4 v13, s[48:51], s81 offen offset:3072 sc1 lds
    s_waitcnt vmcnt(8)
    ds_read_b64_tr_b16 a[80:81], v24 offset:16384
    ds_read_b64_tr_b16 a[82:83], v24 offset:18432
    ds_read_b64_tr_b16 a[84:85], v25 offset:16384
    ds_read_b64_tr_b16 a[86:87], v25 offset:18432
L_padK3:
    s_cbranch_execz L_retK
    s_add_u32 s99, s5, 16384
    buffer_load_dwordx4 v[208:211], v2, s[44:47], s99 offen sc1
    ds_read_b64_tr_b16 a[88:89], v26 offset:16384
    ds_read_b64_tr_b16 a[90:91], v26 offset:18432
    ds_read_b64_tr_b16 a[92:93], v27 offset:16384
    ds_read_b64_tr_b16 a[94:95], v27 offset:18432
    s_waitcnt vmcnt(8)
    v_mfma_f32_16x16x32_bf16 v[64:67], a[0:3], v[192:195], v[64:67]
    ds_read_b64_tr_b16 a[224:225], v40 offset:0
    v_mfma_f32_16x16x32_bf16 v[68:71], a[4:7], v[192:195], v[68:71]
    buffer_load_dwordx4 v[212:215], v3, s[44:47], s99 offen sc1
    v_mfma_f32_16x16x32_bf16 v[72:75], a[8:11], v[192:195], v[72:75]
    ds_read_b64_tr_b16 a[226:227], v40 offset:2048
    v_mfma_f32_16x16x32_bf16 v[76:79], a[12:15], v[192:195], v[76:79]
    s_waitcnt vmcnt(8)
    ds_read_b64_tr_b16 a[228:229], v41 offset:0
    v_mfma_f32_16x16x32_bf16 v[92:95], a[12:15], v[196:199], v[92:95]
    ds_read_b64_tr_b16 a[230:231], v41 offset:2048
    v_mfma_f32_16x16x32_bf16 v[88:91], a[8:11], v[196:199], v[88:91]
    buffer_load_dwordx4 v[216:219], v4, s[44:47], s99 offen sc1
    v_mfma_f32_16x16x32_bf16 v[84:87], a[4:7], v[196:199], v[84:87]
    ds_read_b64_tr_b16 a[232:233], v42 offset:0
    v_mfma_f32_16x16x32_bf16 v[80:83], a[0:3], v[196:199], v[80:83]
    s_waitcnt vmcnt(8)
    ds_read_b64_tr_b16 a[234:235], v42 offset:2048
    v_mfma_f32_16x16x32_bf16 v[96:99], a[0:3], v[200:203], v[96:99]
    ds_read_b64_tr_b16 a[236:237], v43 offset:0
    v_mfma_f32_16x16x32_bf16 v[100:103], a[4:7], v[200:203], v[100:103]
    buffer_load_dwordx4 v[220:223], v5, s[44:47], s99 offen sc1
    v_mfma_f32_16x16x32_bf16 v[104:107], a[8:11], v[200:203], v[104:107]
    ds_read_b64_tr_b16 a[238:239], v43 offset:2048
    v_mfma_f32_16x16x32_bf16 v[108:111], a[12:15], v[200:203], v[108:111]
    s_waitcnt vmcnt(8)
    v_mfma_f32_16x16x32_bf16 v[124:127], a[12:15], v[204:207], v[124:127]
    s_add_u32 m0, s97, 49152
    s_lshl_b32 s23, s5, 3
    v_mfma_f32_16x16x32_bf16 v[120:123], a[8:11], v[204:207], v[120:123]
    buffer_load_dwordx4 v10, s[52:55], s23 offen offset:0 sc1 lds
    v_mfma_f32_16x16x32_bf16 v[116:119], a[4:7], v[204:207], v[116:119]
    v_mfma_f32_16x16x32_bf16 v[112:115], a[0:3], v[204:207], v[112:115]
    buffer_load_dwordx4 v11, s[52:55], s23 offen offset:1024 sc1 lds
    buffer_load_dwordx4 v12, s[52:55], s23 offen offset:2048 sc1 lds
    buffer_load_dwordx4 v13, s[52:55], s23 offen offset:3072 sc1 lds
    s_waitcnt vmcnt(8)
    ds_read_b64_tr_b16 a[96:97], v24 offset:32768
    ds_read_b64_tr_b16 a[98:99], v24 offset:34816
    ds_read_b64_tr_b16 a[100:101], v25 offset:32768
    ds_read_b64_tr_b16 a[102:103], v25 offset:34816
    s_waitcnt lgkmcnt(0)
    s_buffer_load_dword s84, s[44:47], s4 offset:2048 glc
    s_buffer_load_dword s85, s[44:47], s4 offset:2180 glc
    s_buffer_load_dword s86, s[44:47], s4 offset:2304 glc
    s_buffer_load_dword s87, s[44:47], s4 offset:2436 glc
    s_buffer_load_dword s88, s[44:47], s4 offset:2560 glc
    s_buffer_load_dword s89, s[44:47], s4 offset:2692 glc
    s_buffer_load_dword s90, s[44:47], s4 offset:2816 glc
    s_buffer_load_dword s91, s[44:47], s4 offset:2948 glc
    s_add_u32 s99, s12, 16384
    buffer_load_dwordx4 v[224:227], v2, s[44:47], s99 offen sc1
    s_waitcnt vmcnt(8)
    v_mfma_f32_16x16x32_bf16 v[64:67], a[176:179], v[208:211], v[64:67]
    ds_read_b64_tr_b16 a[104:105], v26 offset:32768
    v_mfma_f32_16x16x32_bf16 v[68:71], a[180:183], v[208:211], v[68:71]
    buffer_load_dwordx4 v[228:231], v3, s[44:47], s99 offen sc1
    v_mfma_f32_16x16x32_bf16 v[72:75], a[184:187], v[208:211], v[72:75]
    ds_read_b64_tr_b16 a[106:107], v26 offset:34816
    v_mfma_f32_16x16x32_bf16 v[76:79], a[188:191], v[208:211], v[76:79]
    s_waitcnt vmcnt(8)
    ds_read_b64_tr_b16 a[108:109], v27 offset:32768
    v_mfma_f32_16x16x32_bf16 v[92:95], a[188:191], v[212:215], v[92:95]
    ds_read_b64_tr_b16 a[110:111], v27 offset:34816
    v_mfma_f32_16x16x32_bf16 v[88:91], a[184:187], v[212:215], v[88:91]
    buffer_load_dwordx4 v[232:235], v4, s[44:47], s99 offen sc1
    v_mfma_f32_16x16x32_bf16 v[84:87], a[180:183], v[212:215], v[84:87]
    ds_read_b64_tr_b16 a[240:241], v28 offset:0
    v_mfma_f32_16x16x32_bf16 v[80:83], a[176:179], v[212:215], v[80:83]
    s_waitcnt vmcnt(8)
    ds_read_b64_tr_b16 a[242:243], v28 offset:2048
    v_mfma_f32_16x16x32_bf16 v[96:99], a[176:179], v[216:219], v[96:99]
    v_mfma_f32_16x16x32_bf16 v[100:103], a[180:183], v[216:219], v[100:103]
    buffer_load_dwordx4 v[236:239], v5, s[44:47], s99 offen sc1
    v_mfma_f32_16x16x32_bf16 v[104:107], a[184:187], v[216:219], v[104:107]
    v_mfma_f32_16x16x32_bf16 v[108:111], a[188:191], v[216:219], v[108:111]
    s_waitcnt vmcnt(8)
    v_mfma_f32_16x16x32_bf16 v[124:127], a[188:191], v[220:223], v[124:127]
    s_add_u32 s99, s16, 16384
    v_mfma_f32_16x16x32_bf16 v[120:123], a[184:187], v[220:223], v[120:123]
    buffer_load_dwordx4 v[240:243], v2, s[44:47], s99 offen sc1
    v_mfma_f32_16x16x32_bf16 v[116:119], a[180:183], v[220:223], v[116:119]
    v_mfma_f32_16x16x32_bf16 v[112:115], a[176:179], v[220:223], v[112:115]
    buffer_load_dwordx4 v[244:247], v3, s[44:47], s99 offen sc1
    buffer_load_dwordx4 v[248:251], v4, s[44:47], s99 offen sc1
    buffer_load_dwordx4 v[252:255], v5, s[44:47], s99 offen sc1
    s_waitcnt lgkmcnt(0)
    s_cmp_eq_u64 s[84:85], s[6:7]
    s_cbranch_scc0 L_slow_lK
    s_cmp_eq_u64 s[86:87], s[6:7]
    s_cbranch_scc0 L_slow_lK
    s_cmp_eq_u64 s[88:89], s[6:7]
    s_cbranch_scc0 L_slow_lK
    s_cmp_eq_u64 s[90:91], s[6:7]
    s_cbranch_scc0 L_slow_lK
L_back_lK:
    s_add_u32 s99, s0, 32768
    buffer_load_dwordx4 v[192:195], v2, s[44:47], s99 offen sc1
    s_waitcnt vmcnt(8)
    v_mfma_f32_16x16x32_bf16 v[64:67], a[48:51], v[224:227], v[64:67]
    ds_read_b64_tr_b16 a[244:245], v29 offset:0
    v_mfma_f32_16x16x32_bf16 v[68:71], a[52:55], v[224:227], v[68:71]
    buffer_load_dwordx4 v[196:199], v3, s[44:47], s99 offen sc1
    v_mfma_f32_16x16x32_bf16 v[72:75], a[56:59], v[224:227], v[72:75]
    ds_read_b64_tr_b16 a[246:247], v29 offset:2048
    v_mfma_f32_16x16x32_bf16 v[76:79], a[60:63], v[224:227], v[76:79]
    s_waitcnt vmcnt(8)
    ds_read_b64_tr_b16 a[248:249], v30 offset:0
    v_mfma_f32_16x16x32_bf16 v[92:95], a[60:63], v[228:231], v[92:95]
    ds_read_b64_tr_b16 a[250:251], v30 offset:2048
    v_mfma_f32_16x16x32_bf16 v[88:91], a[56:59], v[228:231], v[88:91]
    buffer_load_dwordx4 v[200:203], v4, s[44:47], s99 offen sc1
    v_mfma_f32_16x16x32_bf16 v[84:87], a[52:55], v[228:231], v[84:87]
    ds_read_b64_tr_b16 a[252:253], v31 offset:0
    v_mfma_f32_16x16x32_bf16 v[80:83], a[48:51], v[228:231], v[80:83]
    s_waitcnt vmcnt(8)
    ds_read_b64_tr_b16 a[254:255], v31 offset:2048
    v_mfma_f32_16x16x32_bf16 v[96:99], a[48:51], v[232:235], v[96:99]
    ds_read_b64_tr_b16 a[112:113], v24 offset:49152
    v_mfma_f32_16x16x32_bf16 v[100:103], a[52:55], v[232:235], v[100:103]
    buffer_load_dwordx4 v[204:207], v5, s[44:47], s99 offen sc1
    v_mfma_f32_16x16x32_bf16 v[104:107], a[56:59], v[232:235], v[104:107]
    ds_read_b64_tr_b16 a[114:115], v24 offset:51200
    v_mfma_f32_16x16x32_bf16 v[108:111], a[60:63], v[232:235], v[108:111]
    s_waitcnt vmcnt(8)
    ds_read_b64_tr_b16 a[116:117], v25 offset:49152
    v_mfma_f32_16x16x32_bf16 v[124:127], a[60:63], v[236:239], v[124:127]
    ds_read_b64_tr_b16 a[118:119], v25 offset:51200
    v_mfma_f32_16x16x32_bf16 v[120:123], a[56:59], v[236:239], v[120:123]
    s_barrier
    s_add_u32 s99, s5, 32768
    buffer_load_dwordx4 v[216:219], v4, s[44:47], s99 offen sc1
    v_mfma_f32_16x16x32_bf16 v[116:119], a[52:55], v[236:239], v[116:119]
    ds_read_b64_tr_b16 a[120:121], v26 offset:49152
    v_mfma_f32_16x16x32_bf16 v[112:115], a[48:51], v[236:239], v[112:115]
    s_waitcnt vmcnt(8)
    ds_read_b64_tr_b16 a[122:123], v26 offset:51200
    v_mfma_f32_16x16x32_bf16 v[64:67], a[192:195], v[240:243], v[64:67]
    ds_read_b64_tr_b16 a[124:125], v27 offset:49152
    v_mfma_f32_16x16x32_bf16 v[68:71], a[196:199], v[240:243], v[68:71]
    buffer_load_dwordx4 v[220:223], v5, s[44:47], s99 offen sc1
    v_mfma_f32_16x16x32_bf16 v[72:75], a[200:203], v[240:243], v[72:75]
    ds_read_b64_tr_b16 a[126:127], v27 offset:51200
    v_mfma_f32_16x16x32_bf16 v[76:79], a[204:207], v[240:243], v[76:79]
    s_waitcnt vmcnt(8)
    ds_read_b64_tr_b16 a[128:129], v28 offset:16384
    v_mfma_f32_16x16x32_bf16 v[92:95], a[204:207], v[244:247], v[92:95]
    ds_read_b64_tr_b16 a[130:131], v28 offset:18432
    v_mfma_f32_16x16x32_bf16 v[88:91], a[200:203], v[244:247], v[88:91]
    buffer_load_dwordx4 v[212:215], v3, s[44:47], s99 offen sc1
    v_mfma_f32_16x16x32_bf16 v[84:87], a[196:199], v[244:247], v[84:87]
    ds_read_b64_tr_b16 a[132:133], v29 offset:16384
    v_mfma_f32_16x16x32_bf16 v[80:83], a[192:195], v[244:247], v[80:83]
    s_waitcnt vmcnt(8)
    ds_read_b64_tr_b16 a[134:135], v29 offset:18432
    v_mfma_f32_16x16x32_bf16 v[96:99], a[192:195], v[248:251], v[96:99]
    ds_read_b64_tr_b16 a[136:137], v30 offset:16384
    v_mfma_f32_16x16x32_bf16 v[100:103], a[196:199], v[248:251], v[100:103]
    buffer_load_dwordx4 v[208:211], v2, s[44:47], s99 offen sc1
    v_mfma_f32_16x16x32_bf16 v[104:107], a[200:203], v[248:251], v[104:107]
    ds_read_b64_tr_b16 a[138:139], v30 offset:18432
    v_mfma_f32_16x16x32_bf16 v[108:111], a[204:207], v[248:251], v[108:111]
    s_waitcnt vmcnt(8)
    ds_read_b64_tr_b16 a[140:141], v31 offset:16384
    v_mfma_f32_16x16x32_bf16 v[124:127], a[204:207], v[252:255], v[124:127]
    s_add_u32 s99, s12, 32768
    ds_read_b64_tr_b16 a[142:143], v31 offset:18432
    v_mfma_f32_16x16x32_bf16 v[120:123], a[200:203], v[252:255], v[120:123]
    buffer_load_dwordx4 v[224:227], v2, s[44:47], s99 offen sc1
    v_mfma_f32_16x16x32_bf16 v[116:119], a[196:199], v[252:255], v[116:119]
    ds_read_b64_tr_b16 a[16:17], v28 offset:32768
    v_mfma_f32_16x16x32_bf16 v[112:115], a[192:195], v[252:255], v[112:115]
    s_waitcnt vmcnt(8)
    ds_read_b64_tr_b16 a[18:19], v28 offset:34816
    v_mfma_f32_16x16x32_bf16 v[64:67], a[144:147], v[192:195], v[64:67]
    ds_read_b64_tr_b16 a[20:21], v29 offset:32768
    v_mfma_f32_16x16x32_bf16 v[68:71], a[148:151], v[192:195], v[68:71]
    buffer_load_dwordx4 v[228:231], v3, s[44:47], s99 offen sc1
    v_mfma_f32_16x16x32_bf16 v[72:75], a[152:155], v[192:195], v[72:75]
    ds_read_b64_tr_b16 a[22:23], v29 offset:34816
    v_mfma_f32_16x16x32_bf16 v[76:79], a[156:159], v[192:195], v[76:79]
    s_waitcnt vmcnt(8)
    ds_read_b64_tr_b16 a[24:25], v30 offset:32768
    v_mfma_f32_16x16x32_bf16 v[92:95], a[156:159], v[196:199], v[92:95]
    ds_read_b64_tr_b16 a[26:27], v30 offset:34816
    v_mfma_f32_16x16x32_bf16 v[88:91], a[152:155], v[196:199], v[88:91]
    buffer_load_dwordx4 v[232:235], v4, s[44:47], s99 offen sc1
    v_mfma_f32_16x16x32_bf16 v[84:87], a[148:151], v[196:199], v[84:87]
    ds_read_b64_tr_b16 a[28:29], v31 offset:32768
    v_mfma_f32_16x16x32_bf16 v[80:83], a[144:147], v[196:199], v[80:83]
    s_waitcnt vmcnt(8)
    ds_read_b64_tr_b16 a[30:31], v31 offset:34816
    v_mfma_f32_16x16x32_bf16 v[96:99], a[144:147], v[200:203], v[96:99]
    ds_read_b64_tr_b16 a[160:161], v36 offset:0
    v_mfma_f32_16x16x32_bf16 v[100:103], a[148:151], v[200:203], v[100:103]
    buffer_load_dwordx4 v[236:239], v5, s[44:47], s99 offen sc1
    v_mfma_f32_16x16x32_bf16 v[104:107], a[152:155], v[200:203], v[104:107]
    ds_read_b64_tr_b16 a[162:163], v36 offset:2048
    v_mfma_f32_16x16x32_bf16 v[108:111], a[156:159], v[200:203], v[108:111]
    s_waitcnt vmcnt(8)
    ds_read_b64_tr_b16 a[164:165], v37 offset:0
    v_mfma_f32_16x16x32_bf16 v[124:127], a[156:159], v[204:207], v[124:127]
    s_add_u32 s99, s16, 32768
    ds_read_b64_tr_b16 a[166:167], v37 offset:2048
    v_mfma_f32_16x16x32_bf16 v[120:123], a[152:155], v[204:207], v[120:123]
    buffer_load_dwordx4 v[240:243], v2, s[44:47], s99 offen sc1
    v_mfma_f32_16x16x32_bf16 v[116:119], a[148:151], v[204:207], v[116:119]
    ds_read_b64_tr_b16 a[168:169], v38 offset:0
    v_mfma_f32_16x16x32_bf16 v[112:115], a[144:147], v[204:207], v[112:115]
    s_waitcnt vmcnt(8)
    ds_read_b64_tr_b16 a[170:171], v38 offset:2048
    v_mfma_f32_16x16x32_bf16 v[96:99], a[64:67], v[216:219], v[96:99]
    ds_read_b64_tr_b16 a[172:173], v39 offset:0
    v_mfma_f32_16x16x32_bf16 v[100:103], a[68:71], v[216:219], v[100:103]
    buffer_load_dwordx4 v[244:247], v3, s[44:47], s99 offen sc1
    v_mfma_f32_16x16x32_bf16 v[104:107], a[72:75], v[216:219], v[104:107]
    ds_read_b64_tr_b16 a[174:175], v39 offset:2048
    v_mfma_f32_16x16x32_bf16 v[108:111], a[76:79], v[216:219], v[108:111]
    s_waitcnt vmcnt(8)
    ds_read_b64_tr_b16 a[32:33], v32 offset:49152
    v_mfma_f32_16x16x32_bf16 v[124:127], a[76:79], v[220:223], v[124:127]
    ds_read_b64_tr_b16 a[34:35], v32 offset:51200
    v_mfma_f32_16x16x32_bf16 v[120:123], a[72:75], v[220:223], v[120:123]
    buffer_load_dwordx4 v[248:251], v4, s[44:47], s99 offen sc1
    v_mfma_f32_16x16x32_bf16 v[116:119], a[68:71], v[220:223], v[116:119]
    ds_read_b64_tr_b16 a[36:37], v33 offset:49152
    v_mfma_f32_16x16x32_bf16 v[112:115], a[64:67], v[220:223], v[112:115]
    s_waitcnt vmcnt(8)
    ds_read_b64_tr_b16 a[38:39], v33 offset:51200
    v_mfma_f32_16x16x32_bf16 v[80:83], a[64:67], v[212:215], v[80:83]
    ds_read_b64_tr_b16 a[40:41], v34 offset:49152
    v_mfma_f32_16x16x32_bf16 v[84:87], a[68:71], v[212:215], v[84:87]
    buffer_load_dwordx4 v[252:255], v5, s[44:47], s99 offen sc1
    v_mfma_f32_16x16x32_bf16 v[88:91], a[72:75], v[212:215], v[88:91]
    ds_read_b64_tr_b16 a[42:43], v34 offset:51200
    v_mfma_f32_16x16x32_bf16 v[92:95], a[76:79], v[212:215], v[92:95]
    s_waitcnt vmcnt(8)
    ds_read_b64_tr_b16 a[44:45], v35 offset:49152
    v_mfma_f32_16x16x32_bf16 v[76:79], a[76:79], v[208:211], v[76:79]
    ds_read_b64_tr_b16 a[46:47], v35 offset:51200
    v_mfma_f32_16x16x32_bf16 v[72:75], a[72:75], v[208:211], v[72:75]
    buffer_load_dword v16, v7, s[44:47], s98 offen offset:1024 sc1
    buffer_load_dword v17, v15, s[44:47], s98 offen offset:1024 sc1
    buffer_load_dwordx2 v[8:9], v57, s[44:47], s19 offen offset:3584 sc1
    s_add_u32 s99, s22, 49152
    buffer_load_dwordx4 v[192:195], v2, s[44:47], s99 offen sc1
    v_mfma_f32_16x16x32_bf16 v[68:71], a[68:71], v[208:211], v[68:71]
    ds_read_b64_tr_b16 a[0:1], v36 offset:16384
    v_mfma_f32_16x16x32_bf16 v[64:67], a[64:67], v[208:211], v[64:67]
    s_waitcnt vmcnt(11)
    ds_read_b64_tr_b16 a[2:3], v36 offset:18432
    v_mfma_f32_16x16x32_bf16 v[64:67], a[208:211], v[224:227], v[64:67]
    ds_read_b64_tr_b16 a[4:5], v37 offset:16384
    v_mfma_f32_16x16x32_bf16 v[68:71], a[212:215], v[224:227], v[68:71]
    buffer_load_dwordx4 v[196:199], v3, s[44:47], s99 offen sc1
    v_mfma_f32_16x16x32_bf16 v[72:75], a[216:219], v[224:227], v[72:75]
    ds_read_b64_tr_b16 a[6:7], v37 offset:18432
    v_mfma_f32_16x16x32_bf16 v[76:79], a[220:223], v[224:227], v[76:79]
    s_waitcnt vmcnt(11)
    ds_read_b64_tr_b16 a[8:9], v38 offset:16384
    v_mfma_f32_16x16x32_bf16 v[92:95], a[220:223], v[228:231], v[92:95]
    ds_read_b64_tr_b16 a[10:11], v38 offset:18432
    v_mfma_f32_16x16x32_bf16 v[88:91], a[216:219], v[228:231], v[88:91]
    buffer_load_dwordx4 v[200:203], v4, s[44:47], s99 offen sc1
    v_mfma_f32_16x16x32_bf16 v[84:87], a[212:215], v[228:231], v[84:87]
    ds_read_b64_tr_b16 a[12:13], v39 offset:16384
    v_mfma_f32_16x16x32_bf16 v[80:83], a[208:211], v[228:231], v[80:83]
    s_waitcnt vmcnt(11)
    ds_read_b64_tr_b16 a[14:15], v39 offset:18432
    v_mfma_f32_16x16x32_bf16 v[96:99], a[208:211], v[232:235], v[96:99]
    ds_read_b64_tr_b16 a[176:177], v36 offset:32768
    v_mfma_f32_16x16x32_bf16 v[100:103], a[212:215], v[232:235], v[100:103]
    buffer_load_dwordx4 v[204:207], v5, s[44:47], s99 offen sc1
    v_mfma_f32_16x16x32_bf16 v[104:107], a[216:219], v[232:235], v[104:107]
    ds_read_b64_tr_b16 a[178:179], v36 offset:34816
    v_mfma_f32_16x16x32_bf16 v[108:111], a[220:223], v[232:235], v[108:111]
    s_waitcnt vmcnt(11)
    ds_read_b64_tr_b16 a[180:181], v37 offset:32768
    v_mfma_f32_16x16x32_bf16 v[124:127], a[220:223], v[236:239], v[124:127]
    s_add_u32 s99, s27, 49152
    ds_read_b64_tr_b16 a[182:183], v37 offset:34816
    v_mfma_f32_16x16x32_bf16 v[120:123], a[216:219], v[236:239], v[120:123]
    buffer_load_dwordx4 v[216:219], v4, s[44:47], s99 offen sc1
    v_mfma_f32_16x16x32_bf16 v[116:119], a[212:215], v[236:239], v[116:119]
    ds_read_b64_tr_b16 a[184:185], v38 offset:32768
    v_mfma_f32_16x16x32_bf16 v[112:115], a[208:211], v[236:239], v[112:115]
    s_waitcnt vmcnt(11)
    ds_read_b64_tr_b16 a[186:187], v38 offset:34816
    v_mfma_f32_16x16x32_bf16 v[64:67], a[80:83], v[240:243], v[64:67]
    ds_read_b64_tr_b16 a[188:189], v39 offset:32768
    v_mfma_f32_16x16x32_bf16 v[68:71], a[84:87], v[240:243], v[68:71]
    buffer_load_dwordx4 v[220:223], v5, s[44:47], s99 offen sc1
    v_mfma_f32_16x16x32_bf16 v[72:75], a[88:91], v[240:243], v[72:75]
    ds_read_b64_tr_b16 a[190:191], v39 offset:34816
    v_mfma_f32_16x16x32_bf16 v[76:79], a[92:95], v[240:243], v[76:79]
    s_waitcnt vmcnt(11)
    v_mfma_f32_16x16x32_bf16 v[92:95], a[92:95], v[244:247], v[92:95]
    v_mfma_f32_16x16x32_bf16 v[88:91], a[88:91], v[244:247], v[88:91]
    buffer_load_dwordx4 v[212:215], v3, s[44:47], s99 offen sc1
    v_mfma_f32_16x16x32_bf16 v[84:87], a[84:87], v[244:247], v[84:87]
    v_mfma_f32_16x16x32_bf16 v[80:83], a[80:83], v[244:247], v[80:83]
    s_waitcnt vmcnt(11)
    v_mfma_f32_16x16x32_bf16 v[96:99], a[80:83], v[248:251], v[96:99]
    v_mfma_f32_16x16x32_bf16 v[100:103], a[84:87], v[248:251], v[100:103]
    buffer_load_dwordx4 v[208:211], v2, s[44:47], s99 offen sc1
    v_mfma_f32_16x16x32_bf16 v[104:107], a[88:91], v[248:251], v[104:107]
    v_mfma_f32_16x16x32_bf16 v[108:111], a[92:95], v[248:251], v[108:111]
    s_waitcnt vmcnt(11)
    v_mfma_f32_16x16x32_bf16 v[124:127], a[92:95], v[252:255], v[124:127]
    v_mfma_f32_16x16x32_bf16 v[120:123], a[88:91], v[252:255], v[120:123]
    s_waitcnt vmcnt(8)
    v_cmp_eq_u64 vcc, s[6:7], v[8:9]
    s_nop 0
    s_cmp_eq_u64 vcc, -1
    s_cbranch_scc0 L_slow_oK
L_back_oK:
    v_add_u32 v4, s9, v2
    v_add_u32 v5, s9, v3
    s_add_u32 s99, s0, 57344
    buffer_load_dwordx4 v[224:227], v3, s[44:47], s99 offen sc1
    v_mfma_f32_16x16x32_bf16 v[116:119], a[84:87], v[252:255], v[116:119]
    v_mfma_f32_16x16x32_bf16 v[112:115], a[80:83], v[252:255], v[112:115]
    s_waitcnt vmcnt(8)
    v_mfma_f32_16x16x32_bf16 v[64:67], a[224:227], v[192:195], v[64:67]
    v_mfma_f32_16x16x32_bf16 v[68:71], a[228:231], v[192:195], v[68:71]
    buffer_load_dwordx4 v[228:231], v5, s[44:47], s99 offen sc1
    v_mfma_f32_16x16x32_bf16 v[72:75], a[232:235], v[192:195], v[72:75]
    v_mfma_f32_16x16x32_bf16 v[76:79], a[236:239], v[192:195], v[76:79]
    s_waitcnt vmcnt(8)
    v_mfma_f32_16x16x32_bf16 v[92:95], a[236:239], v[196:199], v[92:95]
    s_add_u32 s99, s5, 57344
    v_mfma_f32_16x16x32_bf16 v[88:91], a[232:235], v[196:199], v[88:91]
    buffer_load_dwordx4 v[232:235], v3, s[44:47], s99 offen sc1
    v_mfma_f32_16x16x32_bf16 v[84:87], a[228:231], v[196:199], v[84:87]
    v_mfma_f32_16x16x32_bf16 v[80:83], a[224:227], v[196:199], v[80:83]
    s_waitcnt vmcnt(8)
    v_mfma_f32_16x16x32_bf16 v[96:99], a[224:227], v[200:203], v[96:99]
    v_mfma_f32_16x16x32_bf16 v[100:103], a[228:231], v[200:203], v[100:103]
    buffer_load_dwordx4 v[236:239], v5, s[44:47], s99 offen sc1
    v_mfma_f32_16x16x32_bf16 v[104:107], a[232:235], v[200:203], v[104:107]
    v_mfma_f32_16x16x32_bf16 v[108:111], a[236:239], v[200:203], v[108:111]
    s_waitcnt vmcnt(8)
    v_mfma_f32_16x16x32_bf16 v[124:127], a[236:239], v[204:207], v[124:127]
    s_add_u32 s99, s12, 57344
    v_mfma_f32_16x16x32_bf16 v[120:123], a[232:235], v[204:207], v[120:123]
    buffer_load_dwordx4 v[240:243], v3, s[44:47], s99 offen sc1
    v_mfma_f32_16x16x32_bf16 v[116:119], a[228:231], v[204:207], v[116:119]
    v_mfma_f32_16x16x32_bf16 v[112:115], a[224:227], v[204:207], v[112:115]
    s_waitcnt vmcnt(8)
    v_mfma_f32_16x16x32_bf16 v[96:99], a[96:99], v[216:219], v[96:99]
    v_mfma_f32_16x16x32_bf16 v[100:103], a[100:103], v[216:219], v[100:103]
    buffer_load_dwordx4 v[244:247], v5, s[44:47], s99 offen sc1
    v_mfma_f32_16x16x32_bf16 v[104:107], a[104:107], v[216:219], v[104:107]
    v_mfma_f32_16x16x32_bf16 v[108:111], a[108:111], v[216:219], v[108:111]
    s_waitcnt vmcnt(8)
    v_mfma_f32_16x16x32_bf16 v[124:127], a[108:111], v[220:223], v[124:127]
    s_add_u32 s99, s16, 57344
    v_mfma_f32_16x16x32_bf16 v[120:123], a[104:107], v[220:223], v[120:123]
    buffer_load_dwordx4 v[248:251], v3, s[44:47], s99 offen sc1
    v_mfma_f32_16x16x32_bf16 v[116:119], a[100:103], v[220:223], v[116:119]
    v_mfma_f32_16x16x32_bf16 v[112:115], a[96:99], v[220:223], v[112:115]
    s_waitcnt vmcnt(8)
    v_mfma_f32_16x16x32_bf16 v[80:83], a[96:99], v[212:215], v[80:83]
    v_mfma_f32_16x16x32_bf16 v[84:87], a[100:103], v[212:215], v[84:87]
    buffer_load_dwordx4 v[252:255], v5, s[44:47], s99 offen sc1
    v_mfma_f32_16x16x32_bf16 v[88:91], a[104:107], v[212:215], v[88:91]
    v_mfma_f32_16x16x32_bf16 v[92:95], a[108:111], v[212:215], v[92:95]
    s_waitcnt vmcnt(8)
    v_mfma_f32_16x16x32_bf16 v[76:79], a[108:111], v[208:211], v[76:79]
    s_add_u32 s99, s0, 57344
    v_mfma_f32_16x16x32_bf16 v[72:75], a[104:107], v[208:211], v[72:75]
    buffer_load_dwordx4 v[192:195], v2, s[44:47], s99 offen sc1
    v_mfma_f32_16x16x32_bf16 v[68:71], a[100:103], v[208:211], v[68:71]
    v_mfma_f32_16x16x32_bf16 v[64:67], a[96:99], v[208:211], v[64:67]
    s_waitcnt vmcnt(8)
    v_mfma_f32_16x16x32_bf16 v[144:147], a[240:243], v[224:227], 0
    ds_write_b128 v48, v[96:99] offset:16384
    s_waitcnt lgkmcnt(14)
    v_mfma_f32_16x16x32_bf16 v[148:151], a[244:247], v[224:227], 0
    buffer_load_dwordx4 v[196:199], v4, s[44:47], s99 offen sc1
    v_mfma_f32_16x16x32_bf16 v[152:155], a[248:251], v[224:227], 0
    v_mfma_f32_16x16x32_bf16 v[156:159], a[252:255], v[224:227], 0
    s_waitcnt vmcnt(8)
    ds_write_b128 v48, v[100:103] offset:17408
    v_mfma_f32_16x16x32_bf16 v[144:147], a[160:163], v[228:231], v[144:147]
    s_add_u32 s99, s5, 57344
    v_sub_f32 v18, 1.0, v16
    v_sub_f32 v19, 1.0, v17
    v_mfma_f32_16x16x32_bf16 v[148:151], a[164:167], v[228:231], v[148:151]
    buffer_load_dwordx4 v[200:203], v2, s[44:47], s99 offen sc1
    v_mfma_f32_16x16x32_bf16 v[152:155], a[168:171], v[228:231], v[152:155]
    v_mul_f32 v80, v80, v19
    v_mfma_f32_16x16x32_bf16 v[156:159], a[172:175], v[228:231], v[156:159]
    s_waitcnt vmcnt(8)
    ds_write_b128 v48, v[104:107] offset:18432
    v_mfma_f32_16x16x32_bf16 v[144:147], a[112:115], v[232:235], v[144:147]
    v_mul_f32 v81, v81, v19
    v_mul_f32 v82, v82, v19
    v_mfma_f32_16x16x32_bf16 v[148:151], a[116:119], v[232:235], v[148:151]
    buffer_load_dwordx4 v[204:207], v4, s[44:47], s99 offen sc1
    v_mfma_f32_16x16x32_bf16 v[152:155], a[120:123], v[232:235], v[152:155]
    v_mul_f32 v83, v83, v19
    v_mfma_f32_16x16x32_bf16 v[156:159], a[124:127], v[232:235], v[156:159]
    s_waitcnt vmcnt(8)
    ds_write_b128 v48, v[108:111] offset:19456
    v_mfma_f32_16x16x32_bf16 v[144:147], a[32:35], v[236:239], v[144:147]
    s_add_u32 s99, s12, 57344
    v_mul_f32 v84, v84, v19
    v_mul_f32 v85, v85, v19
    v_mfma_f32_16x16x32_bf16 v[148:151], a[36:39], v[236:239], v[148:151]
    buffer_load_dwordx4 v[208:211], v2, s[44:47], s99 offen sc1
    v_mfma_f32_16x16x32_bf16 v[152:155], a[40:43], v[236:239], v[152:155]
    v_mul_f32 v86, v86, v19
    v_mfma_f32_16x16x32_bf16 v[156:159], a[44:47], v[236:239], v[156:159]
    s_waitcnt vmcnt(8)
    ds_write_b128 v48, v[112:115] offset:32768
    v_mfma_f32_16x16x32_bf16 v[144:147], a[128:131], v[240:243], v[144:147]
    v_mul_f32 v87, v87, v19
    v_mul_f32 v88, v88, v19
    v_mfma_f32_16x16x32_bf16 v[148:151], a[132:135], v[240:243], v[148:151]
    buffer_load_dwordx4 v[212:215], v4, s[44:47], s99 offen sc1
    v_mfma_f32_16x16x32_bf16 v[152:155], a[136:139], v[240:243], v[152:155]
    v_mul_f32 v89, v89, v19
    v_mfma_f32_16x16x32_bf16 v[156:159], a[140:143], v[240:243], v[156:159]
    s_waitcnt vmcnt(8)
    ds_write_b128 v48, v[116:119] offset:33792
    v_mfma_f32_16x16x32_bf16 v[144:147], a[0:3], v[244:247], v[144:147]
    s_add_u32 s99, s16, 57344
    v_mul_f32 v90, v90, v19
    v_mul_f32 v91, v91, v19
    s_waitcnt lgkmcnt(14)
    v_mfma_f32_16x16x32_bf16 v[148:151], a[4:7], v[244:247], v[148:151]
    buffer_load_dwordx4 v[216:219], v2, s[44:47], s99 offen sc1
    v_mfma_f32_16x16x32_bf16 v[152:155], a[8:11], v[244:247], v[152:155]
    v_mul_f32 v92, v92, v19
    v_mfma_f32_16x16x32_bf16 v[156:159], a[12:15], v[244:247], v[156:159]
    s_waitcnt vmcnt(8)
    ds_write_b128 v48, v[120:123] offset:34816
    v_mfma_f32_16x16x32_bf16 v[144:147], a[16:19], v[248:251], v[144:147]
    v_mul_f32 v93, v93, v19
    v_mul_f32 v94, v94, v19
    v_mfma_f32_16x16x32_bf16 v[148:151], a[20:23], v[248:251], v[148:151]
    buffer_load_dwordx4 v[220:223], v4, s[44:47], s99 offen sc1
    v_mfma_f32_16x16x32_bf16 v[152:155], a[24:27], v[248:251], v[152:155]
    v_mul_f32 v95, v95, v19
    v_mfma_f32_16x16x32_bf16 v[156:159], a[28:31], v[248:251], v[156:159]
    s_waitcnt vmcnt(8)
    ds_write_b128 v48, v[124:127] offset:35840
    s_waitcnt lgkmcnt(14)
    v_mfma_f32_16x16x32_bf16 v[144:147], a[176:179], v[252:255], v[144:147]
    s_waitcnt lgkmcnt(12)
    v_mfma_f32_16x16x32_bf16 v[148:151], a[180:183], v[252:255], v[148:151]
    s_waitcnt lgkmcnt(10)
    v_mfma_f32_16x16x32_bf16 v[152:155], a[184:187], v[252:255], v[152:155]
    s_waitcnt lgkmcnt(8)
    v_mfma_f32_16x16x32_bf16 v[156:159], a[188:191], v[252:255], v[156:159]
    s_waitcnt vmcnt(7)
    v_mfma_f32_16x16x32_bf16 v[128:131], a[240:243], v[192:195], 0
    v_mfma_f32_16x16x32_bf16 v[132:135], a[244:247], v[192:195], 0
    v_fmac_f32 v80, v144, v17
    v_fmac_f32 v81, v145, v17
    v_mfma_f32_16x16x32_bf16 v[136:139], a[248:251], v[192:195], 0
    v_fmac_f32 v82, v146, v17
    v_fmac_f32 v83, v147, v17
    v_mfma_f32_16x16x32_bf16 v[140:143], a[252:255], v[192:195], 0
    s_waitcnt vmcnt(6)
    ds_write_b128 v48, v[80:83] offset:0
    v_mfma_f32_16x16x32_bf16 v[128:131], a[160:163], v[196:199], v[128:131]
    v_fmac_f32 v84, v148, v17
    v_fmac_f32 v85, v149, v17
    v_mfma_f32_16x16x32_bf16 v[132:135], a[164:167], v[196:199], v[132:135]
    v_fmac_f32 v86, v150, v17
    v_fmac_f32 v87, v151, v17
    v_mfma_f32_16x16x32_bf16 v[136:139], a[168:171], v[196:199], v[136:139]
    ds_write_b128 v48, v[84:87] offset:1024
    v_fmac_f32 v88, v152, v17
    v_mfma_f32_16x16x32_bf16 v[140:143], a[172:175], v[196:199], v[140:143]
    s_waitcnt vmcnt(5)
    v_fmac_f32 v89, v153, v17
    v_fmac_f32 v90, v154, v17
    v_mfma_f32_16x16x32_bf16 v[128:131], a[112:115], v[200:203], v[128:131]
    v_fmac_f32 v91, v155, v17
    v_fmac_f32 v92, v156, v17
    v_mfma_f32_16x16x32_bf16 v[132:135], a[116:119], v[200:203], v[132:135]
    ds_write_b128 v48, v[88:91] offset:2048
    v_fmac_f32 v93, v157, v17
    v_mfma_f32_16x16x32_bf16 v[136:139], a[120:123], v[200:203], v[136:139]
    v_fmac_f32 v94, v158, v17
    v_fmac_f32 v95, v159, v17
    v_mfma_f32_16x16x32_bf16 v[140:143], a[124:127], v[200:203], v[140:143]
    s_waitcnt vmcnt(4)
    ds_write_b128 v48, v[92:95] offset:3072
    v_mfma_f32_16x16x32_bf16 v[128:131], a[32:35], v[204:207], v[128:131]
    v_mfma_f32_16x16x32_bf16 v[132:135], a[36:39], v[204:207], v[132:135]
    s_waitcnt lgkmcnt(0)
    s_barrier
    v_mfma_f32_16x16x32_bf16 v[136:139], a[40:43], v[204:207], v[136:139]
    ds_read_b128 v[96:99], v50 offset:16384
    v_mfma_f32_16x16x32_bf16 v[140:143], a[44:47], v[204:207], v[140:143]
    s_waitcnt vmcnt(3)
    ds_read_b128 v[112:115], v51 offset:32768
    v_mfma_f32_16x16x32_bf16 v[128:131], a[128:131], v[208:211], v[128:131]
    ds_read_b128 v[100:103], v50 offset:17408
    v_mfma_f32_16x16x32_bf16 v[132:135], a[132:135], v[208:211], v[132:135]
    ds_read_b128 v[116:119], v51 offset:33792
    v_mfma_f32_16x16x32_bf16 v[136:139], a[136:139], v[208:211], v[136:139]
    ds_read_b128 v[104:107], v50 offset:18432
    s_waitcnt lgkmcnt(4)
    v_add_f32 v64, v64, v96
    v_mfma_f32_16x16x32_bf16 v[140:143], a[140:143], v[208:211], v[140:143]
    s_waitcnt vmcnt(2)
    ds_read_b128 v[120:123], v51 offset:34816
    v_mfma_f32_16x16x32_bf16 v[128:131], a[0:3], v[212:215], v[128:131]
    ds_read_b128 v[108:111], v50 offset:19456
    v_add_f32 v65, v65, v97
    v_mfma_f32_16x16x32_bf16 v[132:135], a[4:7], v[212:215], v[132:135]
    ds_read_b128 v[124:127], v51 offset:35840
    v_add_f32 v66, v66, v98
    v_mfma_f32_16x16x32_bf16 v[136:139], a[8:11], v[212:215], v[136:139]
    ds_read_b128 v[80:83], v49 offset:0
    v_add_f32 v67, v67, v99
    v_mfma_f32_16x16x32_bf16 v[140:143], a[12:15], v[212:215], v[140:143]
    s_waitcnt vmcnt(1)
    ds_read_b128 v[84:87], v49 offset:1024
    v_mfma_f32_16x16x32_bf16 v[128:131], a[16:19], v[216:219], v[128:131]
    ds_read_b128 v[88:91], v49 offset:2048
    s_waitcnt lgkmcnt(9)
    v_add_f32 v64, v64, v112
    v_mfma_f32_16x16x32_bf16 v[132:135], a[20:23], v[216:219], v[132:135]
    ds_read_b128 v[92:95], v49 offset:3072
    v_add_f32 v65, v65, v113
    v_mfma_f32_16x16x32_bf16 v[136:139], a[24:27], v[216:219], v[136:139]
    v_add_f32 v66, v66, v114
    v_add_f32 v67, v67, v115
    v_mfma_f32_16x16x32_bf16 v[140:143], a[28:31], v[216:219], v[140:143]
    s_waitcnt vmcnt(0)
    s_waitcnt lgkmcnt(9)
    v_add_f32 v68, v68, v100
    v_mfma_f32_16x16x32_bf16 v[128:131], a[176:179], v[220:223], v[128:131]
    v_add_f32 v69, v69, v101
    v_add_f32 v70, v70, v102
    v_mfma_f32_16x16x32_bf16 v[132:135], a[180:183], v[220:223], v[132:135]
    v_add_f32 v71, v71, v103
    s_waitcnt lgkmcnt(8)
    v_add_f32 v68, v68, v116
    v_mfma_f32_16x16x32_bf16 v[136:139], a[184:187], v[220:223], v[136:139]
    v_add_f32 v69, v69, v117
    v_add_f32 v70, v70, v118
    v_mfma_f32_16x16x32_bf16 v[140:143], a[188:191], v[220:223], v[140:143]
    v_add_f32 v71, v71, v119
    s_waitcnt lgkmcnt(7)
    v_add_f32 v72, v72, v104
    s_waitcnt lgkmcnt(0)
    v_add_f32 v73, v73, v105
    v_pk_add_f32 v[74:75], v[74:75], v[106:107]
    v_pk_add_f32 v[72:73], v[72:73], v[120:121]
    v_pk_add_f32 v[74:75], v[74:75], v[122:123]
    v_pk_add_f32 v[76:77], v[76:77], v[108:109]
    v_pk_add_f32 v[78:79], v[78:79], v[110:111]
    v_pk_add_f32 v[76:77], v[76:77], v[124:125]
    v_pk_add_f32 v[78:79], v[78:79], v[126:127]
    v_pk_fma_f32 v[64:65], v[64:65], v[18:19], v[80:81] op_sel_hi:[1,0,1]
    v_pk_fma_f32 v[66:67], v[66:67], v[18:19], v[82:83] op_sel_hi:[1,0,1]
    v_pk_fma_f32 v[68:69], v[68:69], v[18:19], v[84:85] op_sel_hi:[1,0,1]
    v_pk_fma_f32 v[70:71], v[70:71], v[18:19], v[86:87] op_sel_hi:[1,0,1]
    v_pk_fma_f32 v[72:73], v[72:73], v[18:19], v[88:89] op_sel_hi:[1,0,1]
    v_pk_fma_f32 v[74:75], v[74:75], v[18:19], v[90:91] op_sel_hi:[1,0,1]
    v_pk_fma_f32 v[76:77], v[76:77], v[18:19], v[92:93] op_sel_hi:[1,0,1]
    v_pk_fma_f32 v[78:79], v[78:79], v[18:19], v[94:95] op_sel_hi:[1,0,1]
    v_pk_fma_f32 v[64:65], v[128:129], v[16:17], v[64:65] op_sel_hi:[1,0,1]
    v_pk_fma_f32 v[66:67], v[130:131], v[16:17], v[66:67] op_sel_hi:[1,0,1]
    v_cvt_pk_bf16_f32 v64, v64, v65
    v_cvt_pk_bf16_f32 v65, v66, v67
    ds_write_b64 v58, v[64:65]
    v_pk_fma_f32 v[68:69], v[132:133], v[16:17], v[68:69] op_sel_hi:[1,0,1]
    v_pk_fma_f32 v[70:71], v[134:135], v[16:17], v[70:71] op_sel_hi:[1,0,1]
    v_cvt_pk_bf16_f32 v68, v68, v69
L_padK4:
    s_cbranch_execz L_retK
    v_cvt_pk_bf16_f32 v69, v70, v71
    ds_write_b64 v59, v[68:69]
    v_pk_fma_f32 v[72:73], v[136:137], v[16:17], v[72:73] op_sel_hi:[1,0,1]
    v_pk_fma_f32 v[74:75], v[138:139], v[16:17], v[74:75] op_sel_hi:[1,0,1]
    v_cvt_pk_bf16_f32 v72, v72, v73
    v_cvt_pk_bf16_f32 v73, v74, v75
    ds_write_b64 v60, v[72:73]
    v_pk_fma_f32 v[76:77], v[140:141], v[16:17], v[76:77] op_sel_hi:[1,0,1]
    v_pk_fma_f32 v[78:79], v[142:143], v[16:17], v[78:79] op_sel_hi:[1,0,1]
    v_cvt_pk_bf16_f32 v76, v76, v77
    v_cvt_pk_bf16_f32 v77, v78, v79
    ds_write_b64 v61, v[76:77]
    ds_read_b128 v[80:83], v53 offset:0
    ds_read_b128 v[84:87], v53 offset:1024
    s_waitcnt lgkmcnt(1)
    buffer_store_dwordx4 v[80:83], v52, s[56:59], s24 offen sc1 nt
    s_waitcnt lgkmcnt(0)
    buffer_store_dwordx4 v[84:87], v52, s[56:59], s25 offen sc1 nt
    s_endpgm
L_slow_tagK:
    s_mov_b32 s3, 0
L_spin_tagK:
    s_nop 4
    buffer_load_dwordx2 v[20:21], off, s[60:63], 0 sc1
    s_waitcnt vmcnt(0)
    v_readfirstlane_b32 s6, v20
    s_nop 4
    v_readfirstlane_b32 s7, v21
    s_nop 4
    s_cmp_lg_u32 s7, 0
    s_cbranch_scc1 L_back_tagK
    s_add_u32 s3, s3, 1
    s_cmp_lt_u32 s3, 0x40000
    s_cbranch_scc1 L_spin_tagK
    s_branch L_back_tagK
L_slow_vK:
    s_mov_b32 s3, 0
L_spin_vK:
    s_nop 4
    buffer_load_dwordx2 v[8:9], v6, s[44:47], s4 offen offset:512 sc1
    s_waitcnt vmcnt(0)
    v_cmp_eq_u64 vcc, s[6:7], v[8:9]
    s_nop 4
    s_cmp_eq_u64 vcc, -1
    s_cbranch_scc1 L_back_vK
    s_add_u32 s3, s3, 1
    s_cmp_lt_u32 s3, 0x40000
    s_cbranch_scc1 L_spin_vK
    s_branch L_back_vK
L_slow_eK:
    s_mov_b32 s3, 0
L_spin_eK:
    s_nop 4
    buffer_load_dwordx2 v[8:9], v6, s[44:47], s4 offen offset:1024 sc1
    s_waitcnt vmcnt(0)
    v_cmp_eq_u64 vcc, s[6:7], v[8:9]
    s_nop 4
    s_cmp_eq_u64 vcc, -1
    s_cbranch_scc1 L_back_eK
    s_add_u32 s3, s3, 1
    s_cmp_lt_u32 s3, 0x40000
    s_cbranch_scc1 L_spin_eK
    s_branch L_back_eK
L_slow_lK:
    s_mov_b32 s3, 0
L_spin_lK:
    s_nop 4
    buffer_load_dwordx2 v[8:9], v14, s[44:47], s4 offen offset:2048 sc1
    s_waitcnt vmcnt(0)
    v_cmp_eq_u64 vcc, s[6:7], v[8:9]
    s_nop 4
    s_cmp_eq_u64 vcc, -1
    s_cbranch_scc1 L_back_lK
    s_add_u32 s3, s3, 1
    s_cmp_lt_u32 s3, 0x40000
    s_cbranch_scc1 L_spin_lK
    s_branch L_back_lK
L_slow_oK:
    s_mov_b32 s3, 0
L_spin_oK:
    s_nop 4
    buffer_load_dwordx2 v[8:9], v57, s[44:47], s19 offen offset:3584 sc1
    s_waitcnt vmcnt(0)
    v_cmp_eq_u64 vcc, s[6:7], v[8:9]
    s_nop 4
    s_cmp_eq_u64 vcc, -1
    s_cbranch_scc1 L_back_oK
    s_add_u32 s3, s3, 1
    s_cmp_lt_u32 s3, 0x40000
    s_cbranch_scc1 L_spin_oK
    s_branch L_back_oK
.p2align 12
L_typeQ:
    s_mov_b32 s39, 0x20000
    s_mov_b32 s43, 0x20000
    s_mul_i32 s99, s93, 5
    s_add_u32 s98, s94, s99
    s_mul_i32 s3, s98, 11
    s_lshr_b32 s3, s3, 5
    s_add_u32 s98, s98, s3
    s_lshl_b32 s98, s98, 7
    s_sub_u32 s38, 1835008, s98
    s_add_u32 s36, s12, s98
    s_addc_u32 s37, s13, 0
    s_and_b32 s37, s37, 0xffff
    v_xor_b32 v253, 32, v252
    v_add_u32 v254, 47104, v252
    v_add_u32 v255, 70656, v253
    v_add_u32 v253, 23552, v253
    s_lshl1_add_u32 s98, s93, s94
    s_sub_u32 s98, s98, 2
    s_lshl_b32 s98, s98, 7
    s_sub_u32 s42, 1572864, s98
    s_add_u32 s40, s6, s98
    s_addc_u32 s41, s7, 0
    s_and_b32 s41, s41, 0xffff
    s_mov_b32 s48, s16
    s_and_b32 s49, s17, 0xffff
    s_mov_b32 s50, 1835008
    s_mov_b32 s51, 0x20000
    s_lshl_b32 s98, s26, 17
    s_add_u32 s52, s8, s98
    s_addc_u32 s53, s9, 0
    s_and_b32 s53, s53, 0xffff
    s_mov_b32 s54, 131072
    s_mov_b32 s55, 0x20000
    s_bfe_u32 s99, s2, 0x30003
    s_lshr_b32 s98, s2, 6
    s_mul_i32 s98, s98, 7
    s_add_u32 s98, s98, s99
    s_cmp_gt_u32 s99, 3
    s_subb_u32 s98, s98, 0
    s_mul_i32 s24, s26, 458752
    s_cmp_eq_u32 s99, 3
    s_cselect_b32 s24, 1073741824, s24
    s_cselect_b32 s25, 1073741824, 0
    s_and_b32 s99, s2, 7
    s_lshl3_add_u32 s99, s98, s99
    v_bfe_u32 v246, v0, 4, 4
    v_min_u32 v247, 4, v246
    v_lshl_add_u32 v246, s99, 4, v246
    v_mad_u32_u24 v247, s99, 5, v247
    v_lshl_add_u32 v246, v246, 7, s24
    v_lshl_add_u32 v247, v247, 7, s25
    v_bfe_u32 v244, v0, 4, 4
    v_min_u32 v245, 4, v244
    v_lshl_add_u32 v244, s98, 4, v244
    v_mad_u32_u24 v245, s98, 5, v245
    v_lshl_add_u32 v244, v244, 10, s24
    v_lshl_add_u32 v245, v245, 10, s25
    s_mov_b32 s56, s20
    s_and_b32 s57, s21, 0xffff
    s_mov_b32 s58, 2097152
    s_mov_b32 s59, 0x20000
    s_mov_b32 s21, s23
    v_mov_b32 v25, s97
    s_lshl_b32 s98, s101, 6
    v_xad_u32 v24, v24, s98, v25
    v_xor_b32 v25, 32, v24
    v_xor_b32 v26, 64, v24
    v_xor_b32 v27, 96, v24
    v_add_u32 v28, 0x10000, v24
    v_add_u32 v29, 0x10000, v25
    v_add_u32 v30, 0x10000, v26
    v_add_u32 v31, 0x10000, v27
    s_bfe_u32 s3, s2, 0x30003
    s_mov_b64 exec, 0
    s_cmp_eq_u32 s26, 0
    s_cbranch_scc1 L_padQ0
    s_cmp_eq_u32 s26, 1
    s_cbranch_scc1 L_padQ1
    s_cmp_eq_u32 s26, 2
    s_cbranch_scc1 L_padQ2
    s_cmp_eq_u32 s26, 3
    s_cbranch_scc1 L_padQ3
L_retQ:
    s_mov_b64 exec, -1
    s_add_u32 m0, s96, 16384
    s_nop 0
    buffer_load_dwordx4 v6, s[28:31], s69 offen offset:0  lds
    buffer_load_dwordx4 v7, s[28:31], s69 offen offset:1024  lds
    buffer_load_dwordx4 v8, s[28:31], s69 offen offset:2048  lds
    buffer_load_dwordx4 v9, s[28:31], s69 offen offset:3072  lds
    s_add_u32 m0, s97, 16384
    s_nop 0
    buffer_load_dwordx4 v2, s[32:35], s77 offen offset:0  lds
    buffer_load_dwordx4 v3, s[32:35], s77 offen offset:1024  lds
    buffer_load_dwordx4 v4, s[32:35], s77 offen offset:2048  lds
    buffer_load_dwordx4 v5, s[32:35], s77 offen offset:3072  lds
    s_waitcnt vmcnt(8)
    s_waitcnt lgkmcnt(0)
    s_barrier
    ds_read_b64_tr_b16 v[32:33], v14 offset:0
    ds_read_b64_tr_b16 v[34:35], v14 offset:512
    ds_read_b128 a[0:3], v16 offset:0
    ds_read_b128 a[4:7], v16 offset:2048
    ds_read_b128 a[128:131], v18 offset:0
    ds_read_b128 a[132:135], v18 offset:2048
    ds_read_b64_tr_b16 v[36:37], v15 offset:0
    ds_read_b64_tr_b16 v[38:39], v15 offset:512
    s_waitcnt lgkmcnt(5)
    v_mfma_f32_16x16x32_bf16 v[64:67], v[32:35], a[0:3], 0
    ds_read_b64_tr_b16 v[40:41], v14 offset:8192
    s_add_u32 m0, s96, 32768
    s_nop 0
    buffer_load_dwordx4 v6, s[28:31], s70 offen offset:0  lds
    s_waitcnt lgkmcnt(5)
    v_mfma_f32_16x16x32_bf16 v[72:75], v[32:35], a[4:7], 0
    ds_read_b64_tr_b16 v[42:43], v14 offset:8704
    s_waitcnt lgkmcnt(5)
    v_mfma_f32_16x16x32_bf16 v[80:83], v[32:35], a[128:131], 0
    ds_read_b64_tr_b16 v[44:45], v15 offset:8192
    buffer_load_dwordx4 v7, s[28:31], s70 offen offset:1024  lds
    s_waitcnt lgkmcnt(5)
    v_mfma_f32_16x16x32_bf16 v[88:91], v[32:35], a[132:135], 0
    ds_read_b64_tr_b16 v[46:47], v15 offset:8704
    s_waitcnt lgkmcnt(4)
    v_mfma_f32_16x16x32_bf16 v[92:95], v[36:39], a[132:135], 0
    ds_read_b64_tr_b16 v[48:49], v14 offset:4096
    buffer_load_dwordx4 v8, s[28:31], s70 offen offset:2048  lds
    v_mfma_f32_16x16x32_bf16 v[84:87], v[36:39], a[128:131], 0
    ds_read_b64_tr_b16 v[50:51], v14 offset:4608
    v_mfma_f32_16x16x32_bf16 v[76:79], v[36:39], a[4:7], 0
    ds_read_b128 a[8:11], v17 offset:0
    buffer_load_dwordx4 v9, s[28:31], s70 offen offset:3072  lds
    v_mfma_f32_16x16x32_bf16 v[68:71], v[36:39], a[0:3], 0
    s_waitcnt lgkmcnt(4)
    s_add_u32 m0, s97, 32768
    ds_read_b128 a[12:15], v17 offset:2048
    v_mfma_f32_16x16x32_bf16 v[96:99], v[40:43], a[0:3], 0
    ds_read_b128 a[136:139], v19 offset:0
    buffer_load_dwordx4 v2, s[32:35], s78 offen offset:0  lds
    v_mfma_f32_16x16x32_bf16 v[104:107], v[40:43], a[4:7], 0
    ds_read_b128 a[140:143], v19 offset:2048
    v_mfma_f32_16x16x32_bf16 v[112:115], v[40:43], a[128:131], 0
    ds_read_b64_tr_b16 v[52:53], v15 offset:4096
    buffer_load_dwordx4 v3, s[32:35], s78 offen offset:1024  lds
    v_mfma_f32_16x16x32_bf16 v[120:123], v[40:43], a[132:135], 0
    s_waitcnt lgkmcnt(4)
    ds_read_b64_tr_b16 v[54:55], v15 offset:4608
    v_mfma_f32_16x16x32_bf16 v[124:127], v[44:47], a[132:135], 0
    buffer_load_dwordx4 v4, s[32:35], s78 offen offset:2048  lds
    v_mfma_f32_16x16x32_bf16 v[116:119], v[44:47], a[128:131], 0
    ds_read_b64_tr_b16 v[32:33], v14 offset:12288
    v_mfma_f32_16x16x32_bf16 v[108:111], v[44:47], a[4:7], 0
    buffer_load_dwordx4 v5, s[32:35], s78 offen offset:3072  lds
    v_mfma_f32_16x16x32_bf16 v[100:103], v[44:47], a[0:3], 0
    s_waitcnt lgkmcnt(2)
    s_add_u32 m0, s96, 49152
    ds_read_b64_tr_b16 v[34:35], v14 offset:12800
    v_mfma_f32_16x16x32_bf16 v[64:67], v[48:51], a[8:11], v[64:67]
    buffer_load_dwordx4 v6, s[28:31], s71 offen offset:0  lds
    v_mfma_f32_16x16x32_bf16 v[72:75], v[48:51], a[12:15], v[72:75]
    ds_read_b64_tr_b16 v[36:37], v15 offset:12288
    v_lshrrev_b32 v1, 8, v0
    v_mfma_f32_16x16x32_bf16 v[80:83], v[48:51], a[136:139], v[80:83]
    buffer_load_dwordx4 v7, s[28:31], s71 offen offset:1024  lds
    v_mfma_f32_16x16x32_bf16 v[88:91], v[48:51], a[140:143], v[88:91]
    s_waitcnt lgkmcnt(2)
    ds_read_b64_tr_b16 v[38:39], v15 offset:12800
    v_mfma_f32_16x16x32_bf16 v[92:95], v[52:55], a[140:143], v[92:95]
    buffer_load_dwordx4 v8, s[28:31], s71 offen offset:2048  lds
    v_mfma_f32_16x16x32_bf16 v[84:87], v[52:55], a[136:139], v[84:87]
    v_min_u32 v1, 1, v1
    v_lshlrev_b32 v1, 31, v1
    v_or_b32 v1, v1, v0
    v_mfma_f32_16x16x32_bf16 v[76:79], v[52:55], a[12:15], v[76:79]
    buffer_load_dwordx4 v9, s[28:31], s71 offen offset:3072  lds
    v_mfma_f32_16x16x32_bf16 v[68:71], v[52:55], a[8:11], v[68:71]
    s_waitcnt lgkmcnt(1)
    s_add_u32 m0, s97, 49152
    v_lshrrev_b32 v1, 1, v1
    v_mfma_f32_16x16x32_bf16 v[96:99], v[32:35], a[8:11], v[96:99]
    s_waitcnt vmcnt(12) lgkmcnt(0)
    s_barrier
    buffer_load_dwordx4 v2, s[32:35], s79 offen offset:0  lds
    v_mfma_f32_16x16x32_bf16 v[104:107], v[32:35], a[12:15], v[104:107]
    ds_read_b64_tr_b16 v[40:41], v14 offset:16384
    ds_read_b64_tr_b16 v[42:43], v14 offset:16896
    s_lshr_b32 s17, s2, 6
    v_mfma_f32_16x16x32_bf16 v[112:115], v[32:35], a[136:139], v[112:115]
    ds_read_b128 a[16:19], v16 offset:16384
    buffer_load_dwordx4 v3, s[32:35], s79 offen offset:1024  lds
    v_mfma_f32_16x16x32_bf16 v[120:123], v[32:35], a[140:143], v[120:123]
    ds_read_b128 a[20:23], v16 offset:18432
    s_add_u32 s20, s3, s17
    v_lshl_add_u32 v10, s3, 7, v10
    v_add_u32 v11, 7168, v10
    v_mfma_f32_16x16x32_bf16 v[124:127], v[36:39], a[140:143], v[124:127]
    ds_read_b128 a[144:147], v18 offset:16384
    buffer_load_dwordx4 v4, s[32:35], s79 offen offset:2048  lds
    v_mfma_f32_16x16x32_bf16 v[116:119], v[36:39], a[136:139], v[116:119]
    ds_read_b128 a[148:151], v18 offset:18432
    v_add_u32 v12, 14336, v10
    v_add_u32 v13, 21504, v10
    v_mfma_f32_16x16x32_bf16 v[108:111], v[36:39], a[12:15], v[108:111]
    ds_read_b64_tr_b16 v[44:45], v15 offset:16384
    buffer_load_dwordx4 v5, s[32:35], s79 offen offset:3072  lds
    v_mfma_f32_16x16x32_bf16 v[100:103], v[36:39], a[8:11], v[100:103]
    s_waitcnt lgkmcnt(3)
    ds_read_b64_tr_b16 v[46:47], v15 offset:16896
    s_lshl1_add_u32 s98, s92, s100
    v_mfma_f32_16x16x32_bf16 v[64:67], v[40:43], a[16:19], v[64:67]
    ds_read_b64_tr_b16 v[48:49], v14 offset:24576
    buffer_load_dword v246, v246, s[48:51], 0 offen
    v_mfma_f32_16x16x32_bf16 v[72:75], v[40:43], a[20:23], v[72:75]
    s_waitcnt lgkmcnt(3)
    ds_read_b64_tr_b16 v[50:51], v14 offset:25088
    s_lshl2_add_u32 s99, s98, s93
    s_mul_i32 s8, s99, 73728
    v_mfma_f32_16x16x32_bf16 v[80:83], v[40:43], a[144:147], v[80:83]
    ds_read_b64_tr_b16 v[52:53], v15 offset:24576
    buffer_load_dword v247, v247, s[52:55], 0 offen
    v_mfma_f32_16x16x32_bf16 v[88:91], v[40:43], a[148:151], v[88:91]
    s_waitcnt lgkmcnt(3)
    ds_read_b64_tr_b16 v[54:55], v15 offset:25088
    s_lshl_b32 s9, s101, 11
    s_add_u32 s8, s8, s9
    v_mfma_f32_16x16x32_bf16 v[92:95], v[44:47], a[148:151], v[92:95]
    s_add_u32 m0, s96, 0
    ds_read_b64_tr_b16 v[32:33], v14 offset:20480
    s_add_u32 s8, s8, 1048576
    v_mfma_f32_16x16x32_bf16 v[84:87], v[44:47], a[144:147], v[84:87]
    ds_read_b64_tr_b16 v[34:35], v14 offset:20992
    s_lshl_b32 s10, s99, 5
    s_lshl1_add_u32 s3, s94, s101
    v_mfma_f32_16x16x32_bf16 v[76:79], v[44:47], a[20:23], v[76:79]
    ds_read_b128 a[24:27], v17 offset:16384
    buffer_load_dwordx4 v6, s[28:31], s72 offen offset:0  lds
    v_mfma_f32_16x16x32_bf16 v[68:71], v[44:47], a[16:19], v[68:71]
    s_waitcnt lgkmcnt(4)
    ds_read_b128 a[28:31], v17 offset:18432
    s_add_u32 s10, s3, s10
    v_mfma_f32_16x16x32_bf16 v[96:99], v[48:51], a[16:19], v[96:99]
    ds_read_b128 a[152:155], v19 offset:16384
    s_lshl_b32 s10, s10, 7
    s_add_u32 s10, s10, 524288
    v_mfma_f32_16x16x32_bf16 v[104:107], v[48:51], a[20:23], v[104:107]
    ds_read_b128 a[156:159], v19 offset:18432
    s_and_b32 s99, s2, 7
    v_mfma_f32_16x16x32_bf16 v[112:115], v[48:51], a[144:147], v[112:115]
    ds_read_b64_tr_b16 v[36:37], v15 offset:20480
    buffer_load_dwordx4 v7, s[28:31], s72 offen offset:1024  lds
    v_mfma_f32_16x16x32_bf16 v[120:123], v[48:51], a[148:151], v[120:123]
    s_waitcnt lgkmcnt(4)
    ds_read_b64_tr_b16 v[38:39], v15 offset:20992
    s_lshl2_add_u32 s17, s99, s17
    v_mfma_f32_16x16x32_bf16 v[124:127], v[52:55], a[148:151], v[124:127]
    ds_read_b64_tr_b16 v[40:41], v14 offset:28672
    s_lshl2_add_u32 s99, s17, s26
    s_mul_i32 s18, s99, 73728
    v_mfma_f32_16x16x32_bf16 v[116:119], v[52:55], a[144:147], v[116:119]
    ds_read_b64_tr_b16 v[42:43], v14 offset:29184
    s_add_u32 s18, s18, 1048576
    v_mfma_f32_16x16x32_bf16 v[108:111], v[52:55], a[20:23], v[108:111]
    ds_read_b64_tr_b16 v[44:45], v15 offset:28672
    buffer_load_dwordx4 v8, s[28:31], s72 offen offset:2048  lds
    v_mfma_f32_16x16x32_bf16 v[100:103], v[52:55], a[16:19], v[100:103]
    ds_read_b64_tr_b16 v[46:47], v15 offset:29184
    s_lshl_b32 s4, s99, 12
    s_add_u32 s4, s4, 524288
    v_mfma_f32_16x16x32_bf16 v[64:67], v[32:35], a[24:27], v[64:67]
    s_waitcnt lgkmcnt(4)
    s_sub_u32 s3, s3, 4
    s_lshl_b32 s99, s3, 12
    v_mfma_f32_16x16x32_bf16 v[72:75], v[32:35], a[28:31], v[72:75]
    s_add_u32 s8, s8, s99
    s_xor_b32 s9, s8, 2048
    s_lshl2_add_u32 s99, s93, s3
    v_mfma_f32_16x16x32_bf16 v[80:83], v[32:35], a[152:155], v[80:83]
    buffer_load_dwordx4 v9, s[28:31], s72 offen offset:3072  lds
    v_mfma_f32_16x16x32_bf16 v[88:91], v[32:35], a[156:159], v[88:91]
    s_add_u32 m0, s97, 0
    s_lshl_b32 s11, s99, 10
    s_add_u32 s11, s11, 65536
    v_mfma_f32_16x16x32_bf16 v[92:95], v[36:39], a[156:159], v[92:95]
    s_cmp_eq_u32 s26, 0
    s_cselect_b32 s11, s11, 1073741824
    s_cselect_b32 s15, -1, 0
    v_mfma_f32_16x16x32_bf16 v[84:87], v[36:39], a[152:155], v[84:87]
    v_mfma_f32_16x16x32_bf16 v[76:79], v[36:39], a[28:31], v[76:79]
    buffer_load_dwordx4 v2, s[32:35], s80 offen offset:0  lds
    v_mfma_f32_16x16x32_bf16 v[68:71], v[36:39], a[24:27], v[68:71]
    s_waitcnt lgkmcnt(0)
    s_lshl_b32 s14, s99, 11
    v_mfma_f32_16x16x32_bf16 v[96:99], v[40:43], a[24:27], v[96:99]
    s_waitcnt vmcnt(15)
    s_barrier
    s_add_u32 s14, s14, 131072
    v_mfma_f32_16x16x32_bf16 v[104:107], v[40:43], a[28:31], v[104:107]
    ds_read_b64_tr_b16 v[48:49], v14 offset:32768
    ds_read_b64_tr_b16 v[50:51], v14 offset:33280
    v_mfma_f32_16x16x32_bf16 v[112:115], v[40:43], a[152:155], v[112:115]
    ds_read_b128 a[32:35], v16 offset:32768
    buffer_load_dwordx4 v3, s[32:35], s80 offen offset:1024  lds
    v_mfma_f32_16x16x32_bf16 v[120:123], v[40:43], a[156:159], v[120:123]
    ds_read_b128 a[36:39], v16 offset:34816
    s_lshl1_add_u32 s99, s99, s100
    v_mfma_f32_16x16x32_bf16 v[124:127], v[44:47], a[156:159], v[124:127]
    ds_read_b128 a[160:163], v18 offset:32768
    s_lshl_b32 s13, s99, 13
    v_mfma_f32_16x16x32_bf16 v[116:119], v[44:47], a[152:155], v[116:119]
    ds_read_b128 a[164:167], v18 offset:34816
    s_add_u32 s13, s13, 262144
    v_mfma_f32_16x16x32_bf16 v[108:111], v[44:47], a[28:31], v[108:111]
    ds_read_b64_tr_b16 v[52:53], v15 offset:32768
    buffer_load_dwordx4 v4, s[32:35], s80 offen offset:2048  lds
    v_mfma_f32_16x16x32_bf16 v[100:103], v[44:47], a[24:27], v[100:103]
    s_waitcnt lgkmcnt(4)
    ds_read_b64_tr_b16 v[54:55], v15 offset:33280
    v_mfma_f32_16x16x32_bf16 v[64:67], v[48:51], a[32:35], v[64:67]
    s_waitcnt lgkmcnt(4)
    ds_read_b64_tr_b16 v[32:33], v14 offset:40960
    v_mfma_f32_16x16x32_bf16 v[72:75], v[48:51], a[36:39], v[72:75]
    s_waitcnt lgkmcnt(3)
    ds_read_b64_tr_b16 v[34:35], v14 offset:41472
    v_mfma_f32_16x16x32_bf16 v[80:83], v[48:51], a[160:163], v[80:83]
    ds_read_b64_tr_b16 v[36:37], v15 offset:40960
    buffer_load_dwordx4 v5, s[32:35], s80 offen offset:3072  lds
    v_mfma_f32_16x16x32_bf16 v[88:91], v[48:51], a[164:167], v[88:91]
    s_waitcnt lgkmcnt(3)
    ds_read_b64_tr_b16 v[38:39], v15 offset:41472
    v_mfma_f32_16x16x32_bf16 v[92:95], v[52:55], a[164:167], v[92:95]
    s_add_u32 m0, s96, 16384
    ds_read_b64_tr_b16 v[40:41], v14 offset:36864
    v_mfma_f32_16x16x32_bf16 v[84:87], v[52:55], a[160:163], v[84:87]
    ds_read_b64_tr_b16 v[42:43], v14 offset:37376
    s_cmp_eq_u32 s100, 0
    s_cselect_b32 s92, s68, s69
    s_cselect_b32 s93, s70, s71
    s_cselect_b32 s94, s72, s73
    s_cselect_b32 s95, s74, s75
    s_mul_i32 s92, s92, 1536
    s_mul_i32 s93, s93, 1536
    v_mfma_f32_16x16x32_bf16 v[76:79], v[52:55], a[36:39], v[76:79]
    ds_read_b128 a[40:43], v17 offset:32768
    buffer_load_dwordx4 v6, s[28:31], s73 offen offset:0  lds
    v_mfma_f32_16x16x32_bf16 v[68:71], v[52:55], a[32:35], v[68:71]
    s_waitcnt lgkmcnt(4)
    ds_read_b128 a[44:47], v17 offset:34816
    s_mul_i32 s94, s94, 1536
    v_mfma_f32_16x16x32_bf16 v[96:99], v[32:35], a[32:35], v[96:99]
    ds_read_b128 a[168:171], v19 offset:32768
    s_mul_i32 s95, s95, 1536
    s_add_u32 s98, s20, 0
    v_mfma_f32_16x16x32_bf16 v[104:107], v[32:35], a[36:39], v[104:107]
    ds_read_b128 a[172:175], v19 offset:34816
    s_and_b32 s98, s98, 3
    v_mfma_f32_16x16x32_bf16 v[112:115], v[32:35], a[160:163], v[112:115]
    ds_read_b64_tr_b16 v[44:45], v15 offset:36864
    buffer_load_dwordx4 v7, s[28:31], s73 offen offset:1024  lds
    v_mfma_f32_16x16x32_bf16 v[120:123], v[32:35], a[164:167], v[120:123]
    s_waitcnt lgkmcnt(4)
    ds_read_b64_tr_b16 v[46:47], v15 offset:37376
    s_lshl_b32 s0, s98, 12
    v_mfma_f32_16x16x32_bf16 v[124:127], v[36:39], a[164:167], v[124:127]
    ds_read_b64_tr_b16 v[48:49], v14 offset:45056
    s_add_u32 s98, s20, 1
    s_and_b32 s98, s98, 3
    v_mfma_f32_16x16x32_bf16 v[116:119], v[36:39], a[160:163], v[116:119]
    ds_read_b64_tr_b16 v[50:51], v14 offset:45568
    s_lshl_b32 s5, s98, 12
    v_mfma_f32_16x16x32_bf16 v[108:111], v[36:39], a[36:39], v[108:111]
    ds_read_b64_tr_b16 v[52:53], v15 offset:45056
    buffer_load_dwordx4 v8, s[28:31], s73 offen offset:2048  lds
    v_mfma_f32_16x16x32_bf16 v[100:103], v[36:39], a[32:35], v[100:103]
    ds_read_b64_tr_b16 v[54:55], v15 offset:45568
    s_add_u32 s98, s20, 2
    s_and_b32 s98, s98, 3
    v_mfma_f32_16x16x32_bf16 v[64:67], v[40:43], a[40:43], v[64:67]
    s_waitcnt lgkmcnt(4)
    s_lshl_b32 s12, s98, 12
    s_add_u32 s98, s20, 3
    v_mfma_f32_16x16x32_bf16 v[72:75], v[40:43], a[44:47], v[72:75]
    s_and_b32 s98, s98, 3
    s_lshl_b32 s16, s98, 12
    s_and_b32 s22, s0, 4096
    v_mfma_f32_16x16x32_bf16 v[80:83], v[40:43], a[168:171], v[80:83]
    buffer_load_dwordx4 v9, s[28:31], s73 offen offset:3072  lds
    v_mfma_f32_16x16x32_bf16 v[88:91], v[40:43], a[172:175], v[88:91]
    s_add_u32 m0, s97, 16384
    s_and_b32 s27, s5, 4096
    v_lshrrev_b32 v135, 4, v0
    v_mfma_f32_16x16x32_bf16 v[92:95], v[44:47], a[172:175], v[92:95]
    v_add_u32 v132, s20, v135
    s_mov_b32 s24, 0x3000
    v_mfma_f32_16x16x32_bf16 v[84:87], v[44:47], a[168:171], v[84:87]
    s_mov_b32 s25, 0
    v_mfma_f32_16x16x32_bf16 v[76:79], v[44:47], a[44:47], v[76:79]
    buffer_load_dwordx4 v2, s[32:35], s81 offen offset:0  lds
    v_mfma_f32_16x16x32_bf16 v[68:71], v[44:47], a[40:43], v[68:71]
    s_waitcnt lgkmcnt(0)
    v_cndmask_b32 v133, 3, 1, s[24:25]
    v_bfi_b32 v132, v133, v132, v135
    v_mfma_f32_16x16x32_bf16 v[96:99], v[48:51], a[40:43], v[96:99]
    s_waitcnt vmcnt(15)
    s_barrier
    v_lshrrev_b32 v133, 1, v132
    v_mfma_f32_16x16x32_bf16 v[104:107], v[48:51], a[44:47], v[104:107]
    ds_read_b64_tr_b16 v[32:33], v14 offset:49152
    ds_read_b64_tr_b16 v[34:35], v14 offset:49664
    v_mfma_f32_16x16x32_bf16 v[112:115], v[48:51], a[168:171], v[112:115]
    ds_read_b128 a[48:51], v16 offset:49152
    buffer_load_dwordx4 v3, s[32:35], s81 offen offset:1024  lds
    v_mfma_f32_16x16x32_bf16 v[120:123], v[48:51], a[172:175], v[120:123]
    ds_read_b128 a[52:55], v16 offset:51200
    v_lshl_add_u32 v134, s26, 1, v133
    v_mfma_f32_16x16x32_bf16 v[124:127], v[52:55], a[172:175], v[124:127]
    ds_read_b128 a[176:179], v18 offset:49152
    v_lshl_add_u32 v134, v134, 2, 3
    v_mfma_f32_16x16x32_bf16 v[116:119], v[52:55], a[168:171], v[116:119]
    ds_read_b128 a[180:183], v18 offset:51200
    v_xor_b32 v134, 16, v134
    v_mfma_f32_16x16x32_bf16 v[108:111], v[52:55], a[44:47], v[108:111]
    ds_read_b64_tr_b16 v[36:37], v15 offset:49152
    buffer_load_dwordx4 v4, s[32:35], s81 offen offset:2048  lds
    v_mfma_f32_16x16x32_bf16 v[100:103], v[52:55], a[40:43], v[100:103]
    s_waitcnt lgkmcnt(4)
    ds_read_b64_tr_b16 v[38:39], v15 offset:49664
    v_mfma_f32_16x16x32_bf16 v[64:67], v[32:35], a[48:51], v[64:67]
    s_waitcnt lgkmcnt(4)
    ds_read_b64_tr_b16 v[40:41], v14 offset:57344
    v_cmp_eq_u32 s[24:25], 31, v134
    v_mfma_f32_16x16x32_bf16 v[72:75], v[32:35], a[52:55], v[72:75]
    s_waitcnt lgkmcnt(3)
    ds_read_b64_tr_b16 v[42:43], v14 offset:57856
    s_mul_i32 s98, s26, 5
    v_mfma_f32_16x16x32_bf16 v[80:83], v[32:35], a[176:179], v[80:83]
    ds_read_b64_tr_b16 v[44:45], v15 offset:57344
    buffer_load_dwordx4 v5, s[32:35], s81 offen offset:3072  lds
    v_mfma_f32_16x16x32_bf16 v[88:91], v[32:35], a[180:183], v[88:91]
    s_waitcnt lgkmcnt(3)
    ds_read_b64_tr_b16 v[46:47], v15 offset:57856
    s_sub_u32 s98, s98, 2
    v_cndmask_b32 v134, v134, 26, s[24:25]
    v_mfma_f32_16x16x32_bf16 v[92:95], v[36:39], a[180:183], v[92:95]
    s_add_u32 m0, s96, 32768
    ds_read_b64_tr_b16 v[48:49], v14 offset:53248
    v_add_u32 v133, s98, v133
    v_mfma_f32_16x16x32_bf16 v[84:87], v[36:39], a[176:179], v[84:87]
    ds_read_b64_tr_b16 v[50:51], v14 offset:53760
    v_mul_u32_u24 v23, 11, v133
    v_lshrrev_b32 v23, 5, v23
    v_mfma_f32_16x16x32_bf16 v[76:79], v[36:39], a[52:55], v[76:79]
    ds_read_b128 a[56:59], v17 offset:49152
    buffer_load_dwordx4 v6, s[28:31], s74 offen offset:0  lds
    v_mfma_f32_16x16x32_bf16 v[68:71], v[36:39], a[48:51], v[68:71]
    s_waitcnt lgkmcnt(4)
    ds_read_b128 a[60:63], v17 offset:51200
    v_add_u32 v133, v133, v23
    v_mfma_f32_16x16x32_bf16 v[96:99], v[40:43], a[48:51], v[96:99]
    ds_read_b128 a[184:187], v19 offset:49152
    s_mov_b32 s24, 15
    s_mov_b32 s25, 0
    v_mfma_f32_16x16x32_bf16 v[104:107], v[40:43], a[52:55], v[104:107]
    ds_read_b128 a[188:191], v19 offset:51200
    v_cndmask_b32 v133, v133, v134, s[24:25]
    v_mfma_f32_16x16x32_bf16 v[112:115], v[40:43], a[176:179], v[112:115]
    ds_read_b64_tr_b16 v[52:53], v15 offset:53248
    buffer_load_dwordx4 v7, s[28:31], s74 offen offset:1024  lds
    v_mfma_f32_16x16x32_bf16 v[120:123], v[40:43], a[180:183], v[120:123]
    s_waitcnt lgkmcnt(4)
    ds_read_b64_tr_b16 v[54:55], v15 offset:53760
    v_and_b32 v132, 1, v132
    v_mfma_f32_16x16x32_bf16 v[124:127], v[44:47], a[180:183], v[124:127]
    ds_read_b64_tr_b16 v[32:33], v14 offset:61440
    v_lshl_add_u32 v132, v133, 1, v132
    v_lshlrev_b32 v23, 15, v132
    v_mfma_f32_16x16x32_bf16 v[116:119], v[44:47], a[176:179], v[116:119]
    ds_read_b64_tr_b16 v[34:35], v14 offset:61952
    v_mfma_f32_16x16x32_bf16 v[108:111], v[44:47], a[52:55], v[108:111]
    ds_read_b64_tr_b16 v[36:37], v15 offset:61440
    buffer_load_dwordx4 v8, s[28:31], s74 offen offset:2048  lds
    v_mfma_f32_16x16x32_bf16 v[100:103], v[44:47], a[48:51], v[100:103]
    ds_read_b64_tr_b16 v[38:39], v15 offset:61952
    v_lshrrev_b32 v238, 1, v0
    v_mfma_f32_16x16x32_bf16 v[64:67], v[48:51], a[56:59], v[64:67]
    s_waitcnt lgkmcnt(4)
    v_add_u32 v236, s97, v0
    v_add_u32 v236, 147456, v236
    v_mfma_f32_16x16x32_bf16 v[72:75], v[48:51], a[60:63], v[72:75]
    v_xor_b32 v237, 0x2000, v236
    v_mfma_f32_16x16x32_bf16 v[80:83], v[48:51], a[184:187], v[80:83]
    buffer_load_dwordx4 v9, s[28:31], s74 offen offset:3072  lds
    v_mfma_f32_16x16x32_bf16 v[88:91], v[48:51], a[188:191], v[88:91]
    s_add_u32 m0, s97, 32768
    v_lshrrev_b32 v248, 2, v0
    v_mfma_f32_16x16x32_bf16 v[92:95], v[52:55], a[188:191], v[92:95]
    v_xor_b32 v248, v248, v0
    v_mfma_f32_16x16x32_bf16 v[84:87], v[52:55], a[184:187], v[84:87]
    v_and_b32 v248, 0xc0, v248
    v_mfma_f32_16x16x32_bf16 v[76:79], v[52:55], a[60:63], v[76:79]
    buffer_load_dwordx4 v2, s[32:35], s82 offen offset:0  lds
    v_mfma_f32_16x16x32_bf16 v[68:71], v[52:55], a[56:59], v[68:71]
    s_waitcnt lgkmcnt(0)
    v_and_or_b32 v248, v0, 32, v248
    v_mfma_f32_16x16x32_bf16 v[96:99], v[32:35], a[56:59], v[96:99]
    s_waitcnt vmcnt(13)
    s_barrier
    v_and_b32 v249, 16, v0
    v_mfma_f32_16x16x32_bf16 v[104:107], v[32:35], a[60:63], v[104:107]
    ds_read_b64_tr_b16 v[40:41], v14 offset:0
    ds_read_b64_tr_b16 v[42:43], v14 offset:512
    v_mfma_f32_16x16x32_bf16 v[112:115], v[32:35], a[184:187], v[112:115]
    ds_read_b128 a[64:67], v16 offset:0
    buffer_load_dwordx4 v3, s[32:35], s82 offen offset:1024  lds
    v_mfma_f32_16x16x32_bf16 v[120:123], v[32:35], a[188:191], v[120:123]
    ds_read_b128 a[68:71], v16 offset:2048
    v_mov_b32 v250, 0x3f80
    v_mfma_f32_16x16x32_bf16 v[124:127], v[36:39], a[188:191], v[124:127]
    ds_read_b128 a[192:195], v18 offset:0
    v_lshlrev_b32 v249, v249, v250
    v_mfma_f32_16x16x32_bf16 v[116:119], v[36:39], a[184:187], v[116:119]
    ds_read_b128 a[196:199], v18 offset:2048
    v_cmp_eq_u32 vcc, 0, v248
    v_mfma_f32_16x16x32_bf16 v[108:111], v[36:39], a[60:63], v[108:111]
    ds_read_b64_tr_b16 v[44:45], v15 offset:0
    buffer_load_dwordx4 v4, s[32:35], s82 offen offset:2048  lds
    v_mfma_f32_16x16x32_bf16 v[100:103], v[36:39], a[56:59], v[100:103]
    s_waitcnt lgkmcnt(4)
    ds_read_b64_tr_b16 v[46:47], v15 offset:512
    v_mfma_f32_16x16x32_bf16 v[64:67], v[40:43], a[64:67], v[64:67]
    s_waitcnt lgkmcnt(4)
    ds_read_b64_tr_b16 v[48:49], v14 offset:8192
    v_mfma_f32_16x16x32_bf16 v[72:75], v[40:43], a[68:71], v[72:75]
    s_waitcnt lgkmcnt(3)
    ds_read_b64_tr_b16 v[50:51], v14 offset:8704
    v_mfma_f32_16x16x32_bf16 v[80:83], v[40:43], a[192:195], v[80:83]
    ds_read_b64_tr_b16 v[52:53], v15 offset:8192
    buffer_load_dwordx4 v5, s[32:35], s82 offen offset:3072  lds
    v_mfma_f32_16x16x32_bf16 v[88:91], v[40:43], a[196:199], v[88:91]
    s_waitcnt lgkmcnt(3)
    ds_read_b64_tr_b16 v[54:55], v15 offset:8704
    v_cndmask_b32 v58, 0, v249, vcc
    v_cmp_eq_u32 vcc, 32, v248
    v_mfma_f32_16x16x32_bf16 v[92:95], v[44:47], a[196:199], v[92:95]
    s_add_u32 m0, s96, 49152
    ds_read_b64_tr_b16 v[32:33], v14 offset:4096
    v_cndmask_b32 v59, 0, v249, vcc
    v_mfma_f32_16x16x32_bf16 v[84:87], v[44:47], a[192:195], v[84:87]
    ds_read_b64_tr_b16 v[34:35], v14 offset:4608
    v_mov_b32 v56, 0
    v_mfma_f32_16x16x32_bf16 v[76:79], v[44:47], a[68:71], v[76:79]
    ds_read_b128 a[72:75], v17 offset:0
    buffer_load_dwordx4 v6, s[28:31], s75 offen offset:0  lds
    v_mfma_f32_16x16x32_bf16 v[68:71], v[44:47], a[64:67], v[68:71]
    s_waitcnt lgkmcnt(4)
    ds_read_b128 a[76:79], v17 offset:2048
    v_mov_b32 v57, 0
    v_mfma_f32_16x16x32_bf16 v[96:99], v[48:51], a[64:67], v[96:99]
    ds_read_b128 a[200:203], v19 offset:0
    v_mov_b32 v60, 0
    v_mov_b32 v61, 0
    v_mfma_f32_16x16x32_bf16 v[104:107], v[48:51], a[68:71], v[104:107]
    ds_read_b128 a[204:207], v19 offset:2048
    v_mov_b32 v226, 0
    v_mfma_f32_16x16x32_bf16 v[112:115], v[48:51], a[192:195], v[112:115]
    ds_read_b64_tr_b16 v[36:37], v15 offset:4096
    buffer_load_dwordx4 v7, s[28:31], s75 offen offset:1024  lds
    v_mfma_f32_16x16x32_bf16 v[120:123], v[48:51], a[196:199], v[120:123]
    s_waitcnt lgkmcnt(4)
    ds_read_b64_tr_b16 v[38:39], v15 offset:4608
    v_mfma_f32_16x16x32_bf16 v[124:127], v[52:55], a[196:199], v[124:127]
    ds_read_b64_tr_b16 v[40:41], v14 offset:12288
    v_mov_b32 v227, 0
    v_mov_b32 v232, 0
    v_mfma_f32_16x16x32_bf16 v[116:119], v[52:55], a[192:195], v[116:119]
    ds_read_b64_tr_b16 v[42:43], v14 offset:12800
    v_mov_b32 v233, 0
    v_mfma_f32_16x16x32_bf16 v[108:111], v[52:55], a[68:71], v[108:111]
    ds_read_b64_tr_b16 v[44:45], v15 offset:12288
    buffer_load_dwordx4 v8, s[28:31], s75 offen offset:2048  lds
    v_mfma_f32_16x16x32_bf16 v[100:103], v[52:55], a[64:67], v[100:103]
    ds_read_b64_tr_b16 v[46:47], v15 offset:12800
    v_mfma_f32_16x16x32_bf16 v[64:67], v[32:35], a[72:75], v[64:67]
    s_waitcnt lgkmcnt(4)
    v_mfma_f32_16x16x32_bf16 v[72:75], v[32:35], a[76:79], v[72:75]
    v_mfma_f32_16x16x32_bf16 v[80:83], v[32:35], a[200:203], v[80:83]
    buffer_load_dwordx4 v9, s[28:31], s75 offen offset:3072  lds
    v_mfma_f32_16x16x32_bf16 v[88:91], v[32:35], a[204:207], v[88:91]
    s_add_u32 m0, s97, 49152
    v_mfma_f32_16x16x32_bf16 v[92:95], v[36:39], a[204:207], v[92:95]
    v_mfma_f32_16x16x32_bf16 v[84:87], v[36:39], a[200:203], v[84:87]
    v_mfma_f32_16x16x32_bf16 v[76:79], v[36:39], a[76:79], v[76:79]
    buffer_load_dwordx4 v2, s[32:35], s83 offen offset:0  lds
    v_mfma_f32_16x16x32_bf16 v[68:71], v[36:39], a[72:75], v[68:71]
    s_waitcnt lgkmcnt(0)
    v_mfma_f32_16x16x32_bf16 v[96:99], v[40:43], a[72:75], v[96:99]
    s_waitcnt vmcnt(13)
    s_barrier
    v_mfma_f32_16x16x32_bf16 v[104:107], v[40:43], a[76:79], v[104:107]
    ds_read_b64_tr_b16 v[48:49], v14 offset:16384
    ds_read_b64_tr_b16 v[50:51], v14 offset:16896
    v_mfma_f32_16x16x32_bf16 v[112:115], v[40:43], a[200:203], v[112:115]
    ds_read_b128 a[80:83], v16 offset:16384
    buffer_load_dwordx4 v3, s[32:35], s83 offen offset:1024  lds
    v_mfma_f32_16x16x32_bf16 v[120:123], v[40:43], a[204:207], v[120:123]
    ds_read_b128 a[84:87], v16 offset:18432
    v_mfma_f32_16x16x32_bf16 v[124:127], v[44:47], a[204:207], v[124:127]
L_padQ0:
    s_cbranch_execz L_padQ4
    ds_read_b128 a[208:211], v18 offset:16384
    v_mfma_f32_16x16x32_bf16 v[116:119], v[44:47], a[200:203], v[116:119]
    ds_read_b128 a[212:215], v18 offset:18432
    v_mfma_f32_16x16x32_bf16 v[108:111], v[44:47], a[76:79], v[108:111]
    ds_read_b64_tr_b16 v[52:53], v15 offset:16384
    buffer_load_dwordx4 v4, s[32:35], s83 offen offset:2048  lds
    v_mfma_f32_16x16x32_bf16 v[100:103], v[44:47], a[72:75], v[100:103]
    s_waitcnt lgkmcnt(4)
    ds_read_b64_tr_b16 v[54:55], v15 offset:16896
    v_mfma_f32_16x16x32_bf16 v[64:67], v[48:51], a[80:83], v[64:67]
    s_waitcnt lgkmcnt(4)
    ds_read_b64_tr_b16 v[32:33], v14 offset:24576
    v_mfma_f32_16x16x32_bf16 v[72:75], v[48:51], a[84:87], v[72:75]
    s_waitcnt lgkmcnt(3)
    ds_read_b64_tr_b16 v[34:35], v14 offset:25088
    v_mfma_f32_16x16x32_bf16 v[80:83], v[48:51], a[208:211], v[80:83]
    ds_read_b64_tr_b16 v[36:37], v15 offset:24576
    buffer_load_dwordx4 v5, s[32:35], s83 offen offset:3072  lds
    v_mfma_f32_16x16x32_bf16 v[88:91], v[48:51], a[212:215], v[88:91]
    s_waitcnt lgkmcnt(3)
    ds_read_b64_tr_b16 v[38:39], v15 offset:25088
    v_mfma_f32_16x16x32_bf16 v[92:95], v[52:55], a[212:215], v[92:95]
    s_add_u32 m0, s97, 0
    ds_read_b64_tr_b16 v[40:41], v14 offset:20480
    v_mfma_f32_16x16x32_bf16 v[84:87], v[52:55], a[208:211], v[84:87]
    ds_read_b64_tr_b16 v[42:43], v14 offset:20992
    v_mfma_f32_16x16x32_bf16 v[76:79], v[52:55], a[84:87], v[76:79]
    ds_read_b128 a[88:91], v17 offset:16384
    buffer_load_dwordx4 v252, s[40:43], s92 offen offset:0  lds
    v_mfma_f32_16x16x32_bf16 v[68:71], v[52:55], a[80:83], v[68:71]
    s_waitcnt lgkmcnt(4)
    ds_read_b128 a[92:95], v17 offset:18432
    v_mfma_f32_16x16x32_bf16 v[96:99], v[32:35], a[80:83], v[96:99]
    ds_read_b128 a[216:219], v19 offset:16384
    buffer_load_dwordx2 v[20:21], off, s[60:63], 0 sc1
    v_mfma_f32_16x16x32_bf16 v[104:107], v[32:35], a[84:87], v[104:107]
    ds_read_b128 a[220:223], v19 offset:18432
    v_mfma_f32_16x16x32_bf16 v[112:115], v[32:35], a[208:211], v[112:115]
    ds_read_b64_tr_b16 v[44:45], v15 offset:20480
    buffer_load_dwordx4 v253, s[40:43], s92 offen offset:1024  lds
    v_mfma_f32_16x16x32_bf16 v[120:123], v[32:35], a[212:215], v[120:123]
    s_waitcnt lgkmcnt(4)
    ds_read_b64_tr_b16 v[46:47], v15 offset:20992
    v_mfma_f32_16x16x32_bf16 v[124:127], v[36:39], a[212:215], v[124:127]
    ds_read_b64_tr_b16 v[48:49], v14 offset:28672
    v_readlane_b32 s68, v23, 0
    v_mfma_f32_16x16x32_bf16 v[116:119], v[36:39], a[208:211], v[116:119]
    ds_read_b64_tr_b16 v[50:51], v14 offset:29184
    v_readlane_b32 s69, v23, 1
    v_mfma_f32_16x16x32_bf16 v[108:111], v[36:39], a[84:87], v[108:111]
    ds_read_b64_tr_b16 v[52:53], v15 offset:28672
    buffer_load_dwordx4 v254, s[40:43], s92 offen offset:2048  lds
    v_mfma_f32_16x16x32_bf16 v[100:103], v[36:39], a[80:83], v[100:103]
    ds_read_b64_tr_b16 v[54:55], v15 offset:29184
    v_readlane_b32 s70, v23, 2
    v_mfma_f32_16x16x32_bf16 v[64:67], v[40:43], a[88:91], v[64:67]
    s_waitcnt lgkmcnt(4)
    v_readlane_b32 s71, v23, 3
    v_mfma_f32_16x16x32_bf16 v[72:75], v[40:43], a[92:95], v[72:75]
    v_mfma_f32_16x16x32_bf16 v[80:83], v[40:43], a[216:219], v[80:83]
    buffer_load_dwordx4 v255, s[40:43], s92 offen offset:3072  lds
    v_mfma_f32_16x16x32_bf16 v[88:91], v[40:43], a[220:223], v[88:91]
    v_readlane_b32 s72, v23, 4
    v_mfma_f32_16x16x32_bf16 v[92:95], v[44:47], a[220:223], v[92:95]
    buffer_load_dword v244, v244, s[48:51], 0 offen offset:384
    v_mfma_f32_16x16x32_bf16 v[84:87], v[44:47], a[216:219], v[84:87]
    v_readlane_b32 s73, v23, 5
    v_mfma_f32_16x16x32_bf16 v[76:79], v[44:47], a[92:95], v[76:79]
    buffer_load_dword v245, v245, s[52:55], 0 offen offset:384
    v_mfma_f32_16x16x32_bf16 v[68:71], v[44:47], a[88:91], v[68:71]
    s_waitcnt lgkmcnt(0)
    v_readlane_b32 s74, v23, 6
    v_mfma_f32_16x16x32_bf16 v[96:99], v[48:51], a[88:91], v[96:99]
    s_waitcnt vmcnt(15)
    s_barrier
    v_readlane_b32 s75, v23, 7
    v_mfma_f32_16x16x32_bf16 v[104:107], v[48:51], a[92:95], v[104:107]
    ds_read_b64_tr_b16 v[32:33], v14 offset:32768
    ds_read_b64_tr_b16 v[34:35], v14 offset:33280
    v_mfma_f32_16x16x32_bf16 v[112:115], v[48:51], a[216:219], v[112:115]
    ds_read_b128 a[96:99], v16 offset:32768
    v_readlane_b32 s76, v23, 8
    v_mfma_f32_16x16x32_bf16 v[120:123], v[48:51], a[220:223], v[120:123]
    ds_read_b128 a[100:103], v16 offset:34816
    v_mfma_f32_16x16x32_bf16 v[124:127], v[52:55], a[220:223], v[124:127]
    ds_read_b128 a[224:227], v18 offset:32768
    v_readlane_b32 s77, v23, 9
    v_mfma_f32_16x16x32_bf16 v[116:119], v[52:55], a[216:219], v[116:119]
    ds_read_b128 a[228:231], v18 offset:34816
    v_mfma_f32_16x16x32_bf16 v[108:111], v[52:55], a[92:95], v[108:111]
    ds_read_b64_tr_b16 v[36:37], v15 offset:32768
    v_readlane_b32 s78, v23, 10
    v_mfma_f32_16x16x32_bf16 v[100:103], v[52:55], a[88:91], v[100:103]
    s_waitcnt lgkmcnt(4)
    ds_read_b64_tr_b16 v[38:39], v15 offset:33280
    v_mfma_f32_16x16x32_bf16 v[64:67], v[32:35], a[96:99], v[64:67]
    s_waitcnt lgkmcnt(4)
    ds_read_b64_tr_b16 v[40:41], v14 offset:40960
    v_mfma_f32_16x16x32_bf16 v[72:75], v[32:35], a[100:103], v[72:75]
    s_waitcnt lgkmcnt(4)
    ds_read_b64_tr_b16 v[42:43], v14 offset:41472
    v_mfma_f32_16x16x32_bf16 v[80:83], v[32:35], a[224:227], v[80:83]
    s_waitcnt lgkmcnt(4)
    ds_read_b64_tr_b16 v[44:45], v15 offset:40960
    v_mfma_f32_16x16x32_bf16 v[88:91], v[32:35], a[228:231], v[88:91]
    s_waitcnt lgkmcnt(3)
    ds_read_b64_tr_b16 v[46:47], v15 offset:41472
    v_mfma_f32_16x16x32_bf16 v[92:95], v[36:39], a[228:231], v[92:95]
    ds_read_b64_tr_b16 v[48:49], v14 offset:36864
    v_readlane_b32 s79, v23, 11
    v_mfma_f32_16x16x32_bf16 v[84:87], v[36:39], a[224:227], v[84:87]
    ds_read_b64_tr_b16 v[50:51], v14 offset:37376
    v_readlane_b32 s80, v23, 12
    v_mfma_f32_16x16x32_bf16 v[76:79], v[36:39], a[100:103], v[76:79]
    ds_read_b128 a[104:107], v17 offset:32768
    v_readlane_b32 s81, v23, 13
    v_mfma_f32_16x16x32_bf16 v[68:71], v[36:39], a[96:99], v[68:71]
    s_waitcnt lgkmcnt(4)
    ds_read_b128 a[108:111], v17 offset:34816
    v_mfma_f32_16x16x32_bf16 v[96:99], v[40:43], a[96:99], v[96:99]
    ds_read_b128 a[232:235], v19 offset:32768
    v_mfma_f32_16x16x32_bf16 v[104:107], v[40:43], a[100:103], v[104:107]
    ds_read_b128 a[236:239], v19 offset:34816
    v_mfma_f32_16x16x32_bf16 v[112:115], v[40:43], a[224:227], v[112:115]
    ds_read_b64_tr_b16 v[52:53], v15 offset:36864
    v_mfma_f32_16x16x32_bf16 v[120:123], v[40:43], a[228:231], v[120:123]
    s_waitcnt lgkmcnt(4)
    ds_read_b64_tr_b16 v[54:55], v15 offset:37376
    v_mfma_f32_16x16x32_bf16 v[124:127], v[44:47], a[228:231], v[124:127]
    ds_read_b64_tr_b16 v[32:33], v14 offset:45056
    v_mfma_f32_16x16x32_bf16 v[116:119], v[44:47], a[224:227], v[116:119]
    ds_read_b64_tr_b16 v[34:35], v14 offset:45568
    v_mfma_f32_16x16x32_bf16 v[108:111], v[44:47], a[100:103], v[108:111]
    ds_read_b64_tr_b16 v[36:37], v15 offset:45056
    v_mfma_f32_16x16x32_bf16 v[100:103], v[44:47], a[96:99], v[100:103]
    ds_read_b64_tr_b16 v[38:39], v15 offset:45568
    v_mfma_f32_16x16x32_bf16 v[64:67], v[48:51], a[104:107], v[64:67]
    s_waitcnt lgkmcnt(4)
    v_mfma_f32_16x16x32_bf16 v[72:75], v[48:51], a[108:111], v[72:75]
    s_add_u32 m0, s97, 16384
    v_mfma_f32_16x16x32_bf16 v[80:83], v[48:51], a[232:235], v[80:83]
    v_mfma_f32_16x16x32_bf16 v[88:91], v[48:51], a[236:239], v[88:91]
    v_mfma_f32_16x16x32_bf16 v[92:95], v[52:55], a[236:239], v[92:95]
    v_mfma_f32_16x16x32_bf16 v[84:87], v[52:55], a[232:235], v[84:87]
    v_mfma_f32_16x16x32_bf16 v[76:79], v[52:55], a[108:111], v[76:79]
    buffer_load_dwordx4 v252, s[40:43], s93 offen offset:0  lds
    v_mfma_f32_16x16x32_bf16 v[68:71], v[52:55], a[104:107], v[68:71]
    s_waitcnt lgkmcnt(0)
    v_mfma_f32_16x16x32_bf16 v[96:99], v[32:35], a[104:107], v[96:99]
    s_waitcnt vmcnt(8)
    s_barrier
    v_mfma_f32_16x16x32_bf16 v[104:107], v[32:35], a[108:111], v[104:107]
    ds_read_b64_tr_b16 v[40:41], v14 offset:49152
    ds_read_b64_tr_b16 v[42:43], v14 offset:49664
    v_mfma_f32_16x16x32_bf16 v[112:115], v[32:35], a[232:235], v[112:115]
    ds_read_b128 a[112:115], v16 offset:49152
    buffer_load_dwordx4 v253, s[40:43], s93 offen offset:1024  lds
    v_mfma_f32_16x16x32_bf16 v[120:123], v[32:35], a[236:239], v[120:123]
    ds_read_b128 a[116:119], v16 offset:51200
    v_mfma_f32_16x16x32_bf16 v[124:127], v[36:39], a[236:239], v[124:127]
    ds_read_b128 a[240:243], v18 offset:49152
    v_mfma_f32_16x16x32_bf16 v[116:119], v[36:39], a[232:235], v[116:119]
    ds_read_b128 a[244:247], v18 offset:51200
    v_mfma_f32_16x16x32_bf16 v[108:111], v[36:39], a[108:111], v[108:111]
    ds_read_b64_tr_b16 v[44:45], v15 offset:49152
    buffer_load_dwordx4 v254, s[40:43], s93 offen offset:2048  lds
    v_mfma_f32_16x16x32_bf16 v[100:103], v[36:39], a[104:107], v[100:103]
    s_waitcnt lgkmcnt(4)
    ds_read_b64_tr_b16 v[46:47], v15 offset:49664
    v_mfma_f32_16x16x32_bf16 v[64:67], v[40:43], a[112:115], v[64:67]
    s_waitcnt lgkmcnt(4)
    ds_read_b64_tr_b16 v[48:49], v14 offset:57344
    v_mfma_f32_16x16x32_bf16 v[72:75], v[40:43], a[116:119], v[72:75]
    s_waitcnt lgkmcnt(3)
    ds_read_b64_tr_b16 v[50:51], v14 offset:57856
    v_mfma_f32_16x16x32_bf16 v[80:83], v[40:43], a[240:243], v[80:83]
    ds_read_b64_tr_b16 v[52:53], v15 offset:57344
    buffer_load_dwordx4 v255, s[40:43], s93 offen offset:3072  lds
    v_mfma_f32_16x16x32_bf16 v[88:91], v[40:43], a[244:247], v[88:91]
    s_waitcnt lgkmcnt(3)
    ds_read_b64_tr_b16 v[54:55], v15 offset:57856
    v_mfma_f32_16x16x32_bf16 v[92:95], v[44:47], a[244:247], v[92:95]
    s_add_u32 m0, s97, 32768
    ds_read_b64_tr_b16 v[32:33], v14 offset:53248
    v_mfma_f32_16x16x32_bf16 v[84:87], v[44:47], a[240:243], v[84:87]
    ds_read_b64_tr_b16 v[34:35], v14 offset:53760
    v_mfma_f32_16x16x32_bf16 v[76:79], v[44:47], a[116:119], v[76:79]
    ds_read_b128 a[120:123], v17 offset:49152
    buffer_load_dwordx4 v252, s[40:43], s94 offen offset:0  lds
    v_mfma_f32_16x16x32_bf16 v[68:71], v[44:47], a[112:115], v[68:71]
    s_waitcnt lgkmcnt(4)
    ds_read_b128 a[124:127], v17 offset:51200
    v_mfma_f32_16x16x32_bf16 v[96:99], v[48:51], a[112:115], v[96:99]
    ds_read_b128 a[248:251], v19 offset:49152
    v_mfma_f32_16x16x32_bf16 v[104:107], v[48:51], a[116:119], v[104:107]
    ds_read_b128 a[252:255], v19 offset:51200
    v_mfma_f32_16x16x32_bf16 v[112:115], v[48:51], a[240:243], v[112:115]
    ds_read_b64_tr_b16 v[36:37], v15 offset:53248
    buffer_load_dwordx4 v253, s[40:43], s94 offen offset:1024  lds
    v_mfma_f32_16x16x32_bf16 v[120:123], v[48:51], a[244:247], v[120:123]
    s_waitcnt lgkmcnt(4)
    ds_read_b64_tr_b16 v[38:39], v15 offset:53760
    v_mfma_f32_16x16x32_bf16 v[124:127], v[52:55], a[244:247], v[124:127]
    ds_read_b64_tr_b16 v[40:41], v14 offset:61440
    v_mfma_f32_16x16x32_bf16 v[116:119], v[52:55], a[240:243], v[116:119]
    ds_read_b64_tr_b16 v[42:43], v14 offset:61952
    v_mfma_f32_16x16x32_bf16 v[108:111], v[52:55], a[116:119], v[108:111]
    ds_read_b64_tr_b16 v[44:45], v15 offset:61440
    buffer_load_dwordx4 v254, s[40:43], s94 offen offset:2048  lds
    v_mfma_f32_16x16x32_bf16 v[100:103], v[52:55], a[112:115], v[100:103]
    ds_read_b64_tr_b16 v[46:47], v15 offset:61952
    v_mfma_f32_16x16x32_bf16 v[64:67], v[32:35], a[120:123], v[64:67]
    s_waitcnt lgkmcnt(4)
    v_mfma_f32_16x16x32_bf16 v[72:75], v[32:35], a[124:127], v[72:75]
    v_mfma_f32_16x16x32_bf16 v[80:83], v[32:35], a[248:251], v[80:83]
    buffer_load_dwordx4 v255, s[40:43], s94 offen offset:3072  lds
    v_mfma_f32_16x16x32_bf16 v[88:91], v[32:35], a[252:255], v[88:91]
    v_mfma_f32_16x16x32_bf16 v[92:95], v[36:39], a[252:255], v[92:95]
    v_mfma_f32_16x16x32_bf16 v[84:87], v[36:39], a[248:251], v[84:87]
    s_add_u32 m0, s97, 49152
    v_mfma_f32_16x16x32_bf16 v[76:79], v[36:39], a[124:127], v[76:79]
    v_mfma_f32_16x16x32_bf16 v[68:71], v[36:39], a[120:123], v[68:71]
    s_waitcnt lgkmcnt(0)
    v_mfma_f32_16x16x32_bf16 v[96:99], v[40:43], a[120:123], v[96:99]
    s_waitcnt vmcnt(10)
    s_barrier
    v_mfma_f32_16x16x32_bf16 v[104:107], v[40:43], a[124:127], v[104:107]
    ds_read_b64_tr_b16 v[48:49], v14 offset:0
    v_mfma_f32_16x16x32_bf16 v[112:115], v[40:43], a[248:251], v[112:115]
    buffer_load_dwordx4 v252, s[40:43], s95 offen offset:0  lds
    v_mfma_f32_16x16x32_bf16 v[120:123], v[40:43], a[252:255], v[120:123]
    ds_read_b64_tr_b16 v[50:51], v14 offset:512
    v_mfma_f32_16x16x32_bf16 v[124:127], v[44:47], a[252:255], v[124:127]
    ds_read_b64_tr_b16 v[52:53], v15 offset:0
    v_mfma_f32_16x16x32_bf16 v[116:119], v[44:47], a[248:251], v[116:119]
    ds_read_b64_tr_b16 v[54:55], v15 offset:512
    v_mfma_f32_16x16x32_bf16 v[108:111], v[44:47], a[124:127], v[108:111]
    buffer_load_dwordx4 v253, s[40:43], s95 offen offset:1024  lds
    v_mfma_f32_16x16x32_bf16 v[100:103], v[44:47], a[120:123], v[100:103]
    s_waitcnt lgkmcnt(2)
    ds_read_b64_tr_b16 v[32:33], v14 offset:4096
    v_mfma_f32_16x16x32_bf16 v[128:131], v[48:51], a[0:3], 0
    ds_read_b64_tr_b16 v[34:35], v14 offset:4608
    v_mfma_f32_16x16x32_bf16 v[136:139], v[48:51], a[4:7], 0
    ds_read_b64_tr_b16 v[36:37], v15 offset:4096
    v_mfma_f32_16x16x32_bf16 v[144:147], v[48:51], a[128:131], 0
    buffer_load_dwordx4 v254, s[40:43], s95 offen offset:2048  lds
    v_mfma_f32_16x16x32_bf16 v[152:155], v[48:51], a[132:135], 0
    s_waitcnt lgkmcnt(3)
    ds_read_b64_tr_b16 v[38:39], v15 offset:4608
    v_mfma_f32_16x16x32_bf16 v[156:159], v[52:55], a[132:135], 0
    ds_read_b64_tr_b16 v[40:41], v14 offset:8192
    v_mfma_f32_16x16x32_bf16 v[148:151], v[52:55], a[128:131], 0
    ds_read_b64_tr_b16 v[42:43], v14 offset:8704
    v_mfma_f32_16x16x32_bf16 v[140:143], v[52:55], a[4:7], 0
    buffer_load_dwordx4 v255, s[40:43], s95 offen offset:3072  lds
    v_mfma_f32_16x16x32_bf16 v[132:135], v[52:55], a[0:3], 0
    s_waitcnt lgkmcnt(3)
    ds_read_b64_tr_b16 v[44:45], v15 offset:8192
    v_mfma_f32_16x16x32_bf16 v[128:131], v[32:35], a[8:11], v[128:131]
    ds_read_b64_tr_b16 v[46:47], v15 offset:8704
    v_mfma_f32_16x16x32_bf16 v[136:139], v[32:35], a[12:15], v[136:139]
    ds_read_b64_tr_b16 v[48:49], v14 offset:12288
    v_mfma_f32_16x16x32_bf16 v[144:147], v[32:35], a[136:139], v[144:147]
    ds_read_b64_tr_b16 v[50:51], v14 offset:12800
    v_mfma_f32_16x16x32_bf16 v[152:155], v[32:35], a[140:143], v[152:155]
    s_waitcnt lgkmcnt(4)
    ds_read_b64_tr_b16 v[52:53], v15 offset:12288
    v_mfma_f32_16x16x32_bf16 v[156:159], v[36:39], a[140:143], v[156:159]
    ds_read_b64_tr_b16 v[54:55], v15 offset:12800
    v_mfma_f32_16x16x32_bf16 v[148:151], v[36:39], a[136:139], v[148:151]
    v_readfirstlane_b32 s6, v20
    v_readfirstlane_b32 s7, v21
    s_nop 0
    s_cmp_lg_u32 s7, 0
    s_cbranch_scc0 L_slow_tagQ
L_back_tagQ:
    v_lshlrev_b32 v6, 3, v0
    v_and_b32 v6, 0x180, v6
    v_mfma_f32_16x16x32_bf16 v[140:143], v[36:39], a[12:15], v[140:143]
    v_mfma_f32_16x16x32_bf16 v[132:135], v[36:39], a[8:11], v[132:135]
    v_max_f32 v64, 0, v64
    v_mfma_f32_16x16x32_bf16 v[128:131], v[40:43], a[16:19], v[128:131]
    v_max_f32 v65, 0, v65
    v_mfma_f32_16x16x32_bf16 v[136:139], v[40:43], a[20:23], v[136:139]
    v_mul_f32 v64, v64, v96
    v_mfma_f32_16x16x32_bf16 v[144:147], v[40:43], a[144:147], v[144:147]
    v_mul_f32 v65, v65, v97
    v_mfma_f32_16x16x32_bf16 v[152:155], v[40:43], a[148:151], v[152:155]
    s_waitcnt lgkmcnt(0)
    v_cvt_pk_bf16_f32 v64, v64, v65
    v_mfma_f32_16x16x32_bf16 v[156:159], v[44:47], a[148:151], v[156:159]
    v_max_f32 v66, 0, v66
    v_mfma_f32_16x16x32_bf16 v[148:151], v[44:47], a[144:147], v[148:151]
    s_add_u32 m0, s97, 0
    v_max_f32 v67, 0, v67
    v_mfma_f32_16x16x32_bf16 v[140:143], v[44:47], a[20:23], v[140:143]
    v_mul_f32 v66, v66, v98
    v_mfma_f32_16x16x32_bf16 v[132:135], v[44:47], a[16:19], v[132:135]
    v_mfma_f32_16x16x32_bf16 v[128:131], v[48:51], a[24:27], v[128:131]
    s_waitcnt vmcnt(8)
    s_barrier
    v_mul_f32 v67, v67, v99
    v_mfma_f32_16x16x32_bf16 v[136:139], v[48:51], a[28:31], v[136:139]
    ds_read_b64_tr_b16 v[32:33], v14 offset:16384
    v_cvt_pk_bf16_f32 v65, v66, v67
    v_mfma_f32_16x16x32_bf16 v[144:147], v[48:51], a[152:155], v[144:147]
    buffer_load_dwordx4 v2, s[36:39], s84 offen offset:0  lds
    v_mfma_f32_16x16x32_bf16 v[152:155], v[48:51], a[156:159], v[152:155]
    ds_read_b64_tr_b16 v[34:35], v14 offset:16896
    v_max_f32 v68, 0, v68
    v_mfma_f32_16x16x32_bf16 v[156:159], v[52:55], a[156:159], v[156:159]
    ds_read_b64_tr_b16 v[36:37], v15 offset:16384
    v_max_f32 v69, 0, v69
    v_mfma_f32_16x16x32_bf16 v[148:151], v[52:55], a[152:155], v[148:151]
    ds_read_b64_tr_b16 v[38:39], v15 offset:16896
    v_mul_f32 v68, v68, v100
    v_mfma_f32_16x16x32_bf16 v[140:143], v[52:55], a[28:31], v[140:143]
    buffer_load_dwordx4 v3, s[36:39], s84 offen offset:1024  lds
    v_mfma_f32_16x16x32_bf16 v[132:135], v[52:55], a[24:27], v[132:135]
    s_waitcnt lgkmcnt(2)
    ds_read_b64_tr_b16 v[40:41], v14 offset:20480
    v_mfma_f32_16x16x32_bf16 v[128:131], v[32:35], a[32:35], v[128:131]
    ds_read_b64_tr_b16 v[42:43], v14 offset:20992
    v_mul_f32 v69, v69, v101
    v_mfma_f32_16x16x32_bf16 v[136:139], v[32:35], a[36:39], v[136:139]
    ds_read_b64_tr_b16 v[44:45], v15 offset:20480
    v_cvt_pk_bf16_f32 v66, v68, v69
    v_mfma_f32_16x16x32_bf16 v[144:147], v[32:35], a[160:163], v[144:147]
    buffer_load_dwordx4 v4, s[36:39], s84 offen offset:2048  lds
    v_mfma_f32_16x16x32_bf16 v[152:155], v[32:35], a[164:167], v[152:155]
    s_waitcnt lgkmcnt(3)
    ds_read_b64_tr_b16 v[46:47], v15 offset:20992
    v_mfma_f32_16x16x32_bf16 v[156:159], v[36:39], a[164:167], v[156:159]
    ds_read_b64_tr_b16 v[48:49], v14 offset:24576
    v_max_f32 v70, 0, v70
    v_max_f32 v71, 0, v71
    v_mfma_f32_16x16x32_bf16 v[148:151], v[36:39], a[160:163], v[148:151]
    ds_read_b64_tr_b16 v[50:51], v14 offset:25088
    v_mul_f32 v70, v70, v102
    v_mfma_f32_16x16x32_bf16 v[140:143], v[36:39], a[36:39], v[140:143]
    buffer_load_dwordx4 v5, s[36:39], s84 offen offset:3072  lds
    v_mfma_f32_16x16x32_bf16 v[132:135], v[36:39], a[32:35], v[132:135]
    s_waitcnt lgkmcnt(3)
    ds_read_b64_tr_b16 v[52:53], v15 offset:24576
    v_mul_f32 v71, v71, v103
    v_mfma_f32_16x16x32_bf16 v[128:131], v[40:43], a[40:43], v[128:131]
    ds_read_b64_tr_b16 v[54:55], v15 offset:25088
    v_cvt_pk_bf16_f32 v67, v70, v71
    v_max_f32 v72, 0, v72
    v_mfma_f32_16x16x32_bf16 v[136:139], v[40:43], a[44:47], v[136:139]
    ds_read_b64_tr_b16 v[32:33], v14 offset:28672
    buffer_store_dwordx4 v[64:67], v0, s[44:47], s8 offen offset:0 sc1
    v_mfma_f32_16x16x32_bf16 v[144:147], v[40:43], a[168:171], v[144:147]
    ds_read_b64_tr_b16 v[34:35], v14 offset:29184
    v_max_f32 v73, 0, v73
    v_mul_f32 v72, v72, v104
    v_mfma_f32_16x16x32_bf16 v[152:155], v[40:43], a[172:175], v[152:155]
    s_waitcnt lgkmcnt(4)
    ds_read_b64_tr_b16 v[36:37], v15 offset:28672
    v_mfma_f32_16x16x32_bf16 v[156:159], v[44:47], a[172:175], v[156:159]
    ds_read_b64_tr_b16 v[38:39], v15 offset:29184
    v_mul_f32 v73, v73, v105
    v_mfma_f32_16x16x32_bf16 v[148:151], v[44:47], a[168:171], v[148:151]
    v_cvt_pk_bf16_f32 v72, v72, v73
    v_max_f32 v74, 0, v74
    v_mfma_f32_16x16x32_bf16 v[140:143], v[44:47], a[44:47], v[140:143]
    v_max_f32 v75, 0, v75
    v_mul_f32 v74, v74, v106
    v_mfma_f32_16x16x32_bf16 v[132:135], v[44:47], a[40:43], v[132:135]
    v_mul_f32 v75, v75, v107
    v_cvt_pk_bf16_f32 v73, v74, v75
    v_mfma_f32_16x16x32_bf16 v[128:131], v[48:51], a[48:51], v[128:131]
    v_max_f32 v76, 0, v76
    v_mfma_f32_16x16x32_bf16 v[136:139], v[48:51], a[52:55], v[136:139]
    v_max_f32 v77, 0, v77
    v_mfma_f32_16x16x32_bf16 v[144:147], v[48:51], a[176:179], v[144:147]
    v_mul_f32 v76, v76, v108
    v_mfma_f32_16x16x32_bf16 v[152:155], v[48:51], a[180:183], v[152:155]
    s_waitcnt lgkmcnt(0)
    v_mul_f32 v77, v77, v109
    v_mfma_f32_16x16x32_bf16 v[156:159], v[52:55], a[180:183], v[156:159]
    v_cvt_pk_bf16_f32 v74, v76, v77
    v_mfma_f32_16x16x32_bf16 v[148:151], v[52:55], a[176:179], v[148:151]
    s_add_u32 m0, s97, 16384
    v_max_f32 v78, 0, v78
    v_mfma_f32_16x16x32_bf16 v[140:143], v[52:55], a[52:55], v[140:143]
    v_mfma_f32_16x16x32_bf16 v[132:135], v[52:55], a[48:51], v[132:135]
    v_max_f32 v79, 0, v79
    v_mfma_f32_16x16x32_bf16 v[128:131], v[32:35], a[56:59], v[128:131]
    s_waitcnt vmcnt(9)
    s_barrier
    v_mul_f32 v78, v78, v110
    v_mfma_f32_16x16x32_bf16 v[136:139], v[32:35], a[60:63], v[136:139]
    ds_read_b64_tr_b16 v[40:41], v14 offset:32768
    v_mul_f32 v79, v79, v111
    v_mfma_f32_16x16x32_bf16 v[144:147], v[32:35], a[184:187], v[144:147]
    buffer_load_dwordx4 v2, s[36:39], s85 offen offset:0  lds
    v_mfma_f32_16x16x32_bf16 v[152:155], v[32:35], a[188:191], v[152:155]
    ds_read_b64_tr_b16 v[42:43], v14 offset:33280
    v_cvt_pk_bf16_f32 v75, v78, v79
    v_mfma_f32_16x16x32_bf16 v[156:159], v[36:39], a[188:191], v[156:159]
    ds_read_b64_tr_b16 v[44:45], v15 offset:32768
    buffer_store_dwordx4 v[72:75], v0, s[44:47], s8 offen offset:1024 sc1
    v_mfma_f32_16x16x32_bf16 v[148:151], v[36:39], a[184:187], v[148:151]
    ds_read_b64_tr_b16 v[46:47], v15 offset:33280
    v_max_f32 v80, 0, v80
    v_mfma_f32_16x16x32_bf16 v[140:143], v[36:39], a[60:63], v[140:143]
    buffer_load_dwordx4 v3, s[36:39], s85 offen offset:1024  lds
    v_mfma_f32_16x16x32_bf16 v[132:135], v[36:39], a[56:59], v[132:135]
    s_waitcnt lgkmcnt(2)
    ds_read_b64_tr_b16 v[48:49], v14 offset:36864
    v_mfma_f32_16x16x32_bf16 v[128:131], v[40:43], a[64:67], v[128:131]
    ds_read_b64_tr_b16 v[50:51], v14 offset:37376
    v_max_f32 v81, 0, v81
    v_mfma_f32_16x16x32_bf16 v[136:139], v[40:43], a[68:71], v[136:139]
    ds_read_b64_tr_b16 v[52:53], v15 offset:36864
    v_mul_f32 v80, v80, v112
    v_mfma_f32_16x16x32_bf16 v[144:147], v[40:43], a[192:195], v[144:147]
    buffer_load_dwordx4 v4, s[36:39], s85 offen offset:2048  lds
    v_mfma_f32_16x16x32_bf16 v[152:155], v[40:43], a[196:199], v[152:155]
    s_waitcnt lgkmcnt(3)
    ds_read_b64_tr_b16 v[54:55], v15 offset:37376
    v_mul_f32 v81, v81, v113
    v_mfma_f32_16x16x32_bf16 v[156:159], v[44:47], a[196:199], v[156:159]
    ds_read_b64_tr_b16 v[32:33], v14 offset:40960
    v_cvt_pk_bf16_f32 v80, v80, v81
    v_max_f32 v82, 0, v82
    v_mfma_f32_16x16x32_bf16 v[148:151], v[44:47], a[192:195], v[148:151]
    ds_read_b64_tr_b16 v[34:35], v14 offset:41472
    v_max_f32 v83, 0, v83
    v_mfma_f32_16x16x32_bf16 v[140:143], v[44:47], a[68:71], v[140:143]
    buffer_load_dwordx4 v5, s[36:39], s85 offen offset:3072  lds
    v_mfma_f32_16x16x32_bf16 v[132:135], v[44:47], a[64:67], v[132:135]
    s_waitcnt lgkmcnt(3)
    ds_read_b64_tr_b16 v[36:37], v15 offset:40960
    v_mul_f32 v82, v82, v114
    v_mfma_f32_16x16x32_bf16 v[128:131], v[48:51], a[72:75], v[128:131]
    ds_read_b64_tr_b16 v[38:39], v15 offset:41472
    v_mul_f32 v83, v83, v115
    v_cvt_pk_bf16_f32 v81, v82, v83
    v_mfma_f32_16x16x32_bf16 v[136:139], v[48:51], a[76:79], v[136:139]
    ds_read_b64_tr_b16 v[40:41], v14 offset:45056
    v_max_f32 v84, 0, v84
    v_mfma_f32_16x16x32_bf16 v[144:147], v[48:51], a[200:203], v[144:147]
    ds_read_b64_tr_b16 v[42:43], v14 offset:45568
    v_max_f32 v85, 0, v85
    v_mfma_f32_16x16x32_bf16 v[152:155], v[48:51], a[204:207], v[152:155]
    s_waitcnt lgkmcnt(4)
    ds_read_b64_tr_b16 v[44:45], v15 offset:45056
    v_mfma_f32_16x16x32_bf16 v[156:159], v[52:55], a[204:207], v[156:159]
    ds_read_b64_tr_b16 v[46:47], v15 offset:45568
    v_mul_f32 v84, v84, v116
    v_mfma_f32_16x16x32_bf16 v[148:151], v[52:55], a[200:203], v[148:151]
    v_mul_f32 v85, v85, v117
    v_cvt_pk_bf16_f32 v82, v84, v85
    v_mfma_f32_16x16x32_bf16 v[140:143], v[52:55], a[76:79], v[140:143]
    v_max_f32 v86, 0, v86
    v_max_f32 v87, 0, v87
    v_mfma_f32_16x16x32_bf16 v[132:135], v[52:55], a[72:75], v[132:135]
    v_mul_f32 v86, v86, v118
    v_mul_f32 v87, v87, v119
    v_mfma_f32_16x16x32_bf16 v[128:131], v[32:35], a[80:83], v[128:131]
    v_cvt_pk_bf16_f32 v83, v86, v87
    v_mfma_f32_16x16x32_bf16 v[136:139], v[32:35], a[84:87], v[136:139]
    buffer_store_dwordx4 v[80:83], v0, s[44:47], s9 offen offset:0 sc1
    v_mfma_f32_16x16x32_bf16 v[144:147], v[32:35], a[208:211], v[144:147]
    v_max_f32 v88, 0, v88
    v_max_f32 v89, 0, v89
    v_mfma_f32_16x16x32_bf16 v[152:155], v[32:35], a[212:215], v[152:155]
    s_waitcnt lgkmcnt(0)
    v_mul_f32 v88, v88, v120
    v_mfma_f32_16x16x32_bf16 v[156:159], v[36:39], a[212:215], v[156:159]
    v_mfma_f32_16x16x32_bf16 v[148:151], v[36:39], a[208:211], v[148:151]
    s_add_u32 m0, s97, 32768
    v_mul_f32 v89, v89, v121
    v_mfma_f32_16x16x32_bf16 v[140:143], v[36:39], a[84:87], v[140:143]
    v_cvt_pk_bf16_f32 v88, v88, v89
    v_mfma_f32_16x16x32_bf16 v[132:135], v[36:39], a[80:83], v[132:135]
    v_max_f32 v90, 0, v90
    v_mfma_f32_16x16x32_bf16 v[128:131], v[40:43], a[88:91], v[128:131]
    s_waitcnt vmcnt(11)
    s_barrier
    v_max_f32 v91, 0, v91
    v_mfma_f32_16x16x32_bf16 v[136:139], v[40:43], a[92:95], v[136:139]
    ds_read_b64_tr_b16 v[48:49], v14 offset:49152
    v_mul_f32 v90, v90, v122
    v_mfma_f32_16x16x32_bf16 v[144:147], v[40:43], a[216:219], v[144:147]
    buffer_load_dwordx4 v2, s[36:39], s86 offen offset:0  lds
    v_mfma_f32_16x16x32_bf16 v[152:155], v[40:43], a[220:223], v[152:155]
    ds_read_b64_tr_b16 v[50:51], v14 offset:49664
    v_mul_f32 v91, v91, v123
    v_mfma_f32_16x16x32_bf16 v[156:159], v[44:47], a[220:223], v[156:159]
    ds_read_b64_tr_b16 v[52:53], v15 offset:49152
    v_cvt_pk_bf16_f32 v89, v90, v91
    v_mfma_f32_16x16x32_bf16 v[148:151], v[44:47], a[216:219], v[148:151]
    ds_read_b64_tr_b16 v[54:55], v15 offset:49664
    v_max_f32 v92, 0, v92
    v_mfma_f32_16x16x32_bf16 v[140:143], v[44:47], a[92:95], v[140:143]
    buffer_load_dwordx4 v3, s[36:39], s86 offen offset:1024  lds
    v_mfma_f32_16x16x32_bf16 v[132:135], v[44:47], a[88:91], v[132:135]
    s_waitcnt lgkmcnt(2)
    ds_read_b64_tr_b16 v[32:33], v14 offset:53248
    v_mfma_f32_16x16x32_bf16 v[128:131], v[48:51], a[96:99], v[128:131]
    ds_read_b64_tr_b16 v[34:35], v14 offset:53760
    v_max_f32 v93, 0, v93
    v_mfma_f32_16x16x32_bf16 v[136:139], v[48:51], a[100:103], v[136:139]
    ds_read_b64_tr_b16 v[36:37], v15 offset:53248
    v_mul_f32 v92, v92, v124
    v_mfma_f32_16x16x32_bf16 v[144:147], v[48:51], a[224:227], v[144:147]
    buffer_load_dwordx4 v4, s[36:39], s86 offen offset:2048  lds
    v_mfma_f32_16x16x32_bf16 v[152:155], v[48:51], a[228:231], v[152:155]
    s_waitcnt lgkmcnt(3)
    ds_read_b64_tr_b16 v[38:39], v15 offset:53760
    v_mfma_f32_16x16x32_bf16 v[156:159], v[52:55], a[228:231], v[156:159]
    ds_read_b64_tr_b16 v[40:41], v14 offset:57344
    v_mul_f32 v93, v93, v125
    v_cvt_pk_bf16_f32 v90, v92, v93
    v_mfma_f32_16x16x32_bf16 v[148:151], v[52:55], a[224:227], v[148:151]
    ds_read_b64_tr_b16 v[42:43], v14 offset:57856
    v_max_f32 v94, 0, v94
    v_mfma_f32_16x16x32_bf16 v[140:143], v[52:55], a[100:103], v[140:143]
    buffer_load_dwordx4 v5, s[36:39], s86 offen offset:3072  lds
    v_mfma_f32_16x16x32_bf16 v[132:135], v[52:55], a[96:99], v[132:135]
    s_waitcnt lgkmcnt(3)
    ds_read_b64_tr_b16 v[44:45], v15 offset:57344
    v_max_f32 v95, 0, v95
    v_mfma_f32_16x16x32_bf16 v[128:131], v[32:35], a[104:107], v[128:131]
    s_add_u32 m0, s97, 81920
    ds_read_b64_tr_b16 v[46:47], v15 offset:57856
    v_mfma_f32_16x16x32_bf16 v[136:139], v[32:35], a[108:111], v[136:139]
    ds_read_b64_tr_b16 v[48:49], v14 offset:61440
    v_mul_f32 v94, v94, v126
    v_mul_f32 v95, v95, v127
    v_mfma_f32_16x16x32_bf16 v[144:147], v[32:35], a[232:235], v[144:147]
    buffer_load_dwordx4 v10, s[48:51], s68 offen offset:0 sc1 lds
    v_mfma_f32_16x16x32_bf16 v[152:155], v[32:35], a[236:239], v[152:155]
    s_waitcnt lgkmcnt(3)
    ds_read_b64_tr_b16 v[50:51], v14 offset:61952
    v_cvt_pk_bf16_f32 v91, v94, v95
    v_mfma_f32_16x16x32_bf16 v[156:159], v[36:39], a[236:239], v[156:159]
    ds_read_b64_tr_b16 v[52:53], v15 offset:61440
    buffer_store_dwordx4 v[88:91], v0, s[44:47], s9 offen offset:1024 sc1
    v_mfma_f32_16x16x32_bf16 v[148:151], v[36:39], a[232:235], v[148:151]
    ds_read_b64_tr_b16 v[54:55], v15 offset:61952
    s_add_u32 s8, s8, 32768
    s_add_u32 s9, s9, 32768
    v_mfma_f32_16x16x32_bf16 v[140:143], v[36:39], a[108:111], v[140:143]
    buffer_load_dwordx4 v11, s[48:51], s68 offen offset:1024 sc1 lds
    v_mfma_f32_16x16x32_bf16 v[132:135], v[36:39], a[104:107], v[132:135]
    v_lshlrev_b32 v18, 3, v0
    v_mfma_f32_16x16x32_bf16 v[128:131], v[40:43], a[112:115], v[128:131]
    v_and_b32 v18, 0x780, v18
    v_mfma_f32_16x16x32_bf16 v[136:139], v[40:43], a[116:119], v[136:139]
    v_mov_b32 v252, 0x3f803f80
    v_mfma_f32_16x16x32_bf16 v[144:147], v[40:43], a[240:243], v[144:147]
    buffer_load_dwordx4 v12, s[48:51], s68 offen offset:2048 sc1 lds
    v_mfma_f32_16x16x32_bf16 v[152:155], v[40:43], a[244:247], v[152:155]
    s_waitcnt lgkmcnt(0)
    v_mov_b32 v253, 0x3f803f80
    v_mfma_f32_16x16x32_bf16 v[156:159], v[44:47], a[244:247], v[156:159]
    v_mov_b32 v254, 0x3f803f80
    v_mfma_f32_16x16x32_bf16 v[148:151], v[44:47], a[240:243], v[148:151]
    v_mov_b32 v255, 0x3f803f80
    v_mfma_f32_16x16x32_bf16 v[140:143], v[44:47], a[116:119], v[140:143]
    buffer_load_dwordx4 v13, s[48:51], s68 offen offset:3072 sc1 lds
    v_mfma_f32_16x16x32_bf16 v[132:135], v[44:47], a[112:115], v[132:135]
    s_add_u32 m0, s97, 49152
    v_mfma_f32_16x16x32_bf16 v[128:131], v[48:51], a[120:123], v[128:131]
    s_waitcnt vmcnt(16)
    s_barrier
    v_mfma_f32_16x16x32_bf16 v[136:139], v[48:51], a[124:127], v[136:139]
    ds_read_b64_tr_b16 v[32:33], v14 offset:0
    v_mfma_f32_16x16x32_bf16 v[144:147], v[48:51], a[248:251], v[144:147]
    buffer_load_dwordx4 v2, s[36:39], s87 offen offset:0  lds
    v_mfma_f32_16x16x32_bf16 v[152:155], v[48:51], a[252:255], v[152:155]
    ds_read_b64_tr_b16 v[34:35], v14 offset:512
    v_mfma_f32_16x16x32_bf16 v[156:159], v[52:55], a[252:255], v[156:159]
L_padQ1:
    s_cbranch_execz L_retQ
    ds_read_b64_tr_b16 v[36:37], v15 offset:0
    v_mfma_f32_16x16x32_bf16 v[148:151], v[52:55], a[248:251], v[148:151]
    ds_read_b64_tr_b16 v[38:39], v15 offset:512
    v_mfma_f32_16x16x32_bf16 v[140:143], v[52:55], a[124:127], v[140:143]
    buffer_load_dwordx4 v3, s[36:39], s87 offen offset:1024  lds
    v_mfma_f32_16x16x32_bf16 v[132:135], v[52:55], a[120:123], v[132:135]
    s_waitcnt lgkmcnt(2)
    ds_read_b64_tr_b16 v[40:41], v14 offset:8192
    v_mfma_f32_16x16x32_bf16 v[64:67], v[32:35], a[0:3], 0
    ds_read_b64_tr_b16 v[42:43], v14 offset:8704
    v_mfma_f32_16x16x32_bf16 v[72:75], v[32:35], a[4:7], 0
    ds_read_b64_tr_b16 v[44:45], v15 offset:8192
    v_mfma_f32_16x16x32_bf16 v[80:83], v[32:35], a[128:131], 0
    buffer_load_dwordx4 v4, s[36:39], s87 offen offset:2048  lds
    v_mfma_f32_16x16x32_bf16 v[88:91], v[32:35], a[132:135], 0
    s_waitcnt lgkmcnt(3)
    ds_read_b64_tr_b16 v[46:47], v15 offset:8704
    v_mul_f32 v248, 0x3fb8aa3b, v128
    v_mul_f32 v249, 0x3fb8aa3b, v129
    v_exp_f32 v248, v248 clamp
    v_exp_f32 v249, v249 clamp
    v_max_f32 v128, 0x358637bd, v128
    v_mfma_f32_16x16x32_bf16 v[92:95], v[36:39], a[132:135], 0
    ds_read_b64_tr_b16 v[48:49], v14 offset:4096
    v_max_f32 v129, 0x358637bd, v129
    v_add_f32 v128, v128, v248
    v_mfma_f32_16x16x32_bf16 v[84:87], v[36:39], a[128:131], 0
    ds_read_b64_tr_b16 v[50:51], v14 offset:4608
    v_add_f32 v129, v129, v249
    v_mfma_f32_16x16x32_bf16 v[76:79], v[36:39], a[4:7], 0
    buffer_load_dwordx4 v5, s[36:39], s87 offen offset:3072  lds
    v_mfma_f32_16x16x32_bf16 v[68:71], v[36:39], a[0:3], 0
    s_waitcnt lgkmcnt(3)
    ds_read_b64_tr_b16 v[52:53], v15 offset:4096
    v_mfma_f32_16x16x32_bf16 v[96:99], v[40:43], a[0:3], 0
    s_add_u32 m0, s97, 98304
    ds_read_b64_tr_b16 v[54:55], v15 offset:4608
    v_cvt_pk_bf16_f32 v128, v128, v129
    v_mfma_f32_16x16x32_bf16 v[104:107], v[40:43], a[4:7], 0
    ds_read_b64_tr_b16 v[32:33], v14 offset:12288
    v_mul_f32 v250, 0x3fb8aa3b, v130
    v_mul_f32 v251, 0x3fb8aa3b, v131
    v_mfma_f32_16x16x32_bf16 v[112:115], v[40:43], a[128:131], 0
    buffer_load_dwordx4 v10, s[48:51], s72 offen offset:0 sc1 lds
    v_mfma_f32_16x16x32_bf16 v[120:123], v[40:43], a[132:135], 0
    s_waitcnt lgkmcnt(3)
    ds_read_b64_tr_b16 v[34:35], v14 offset:12800
    v_max_f32 v130, 0x358637bd, v130
    v_mfma_f32_16x16x32_bf16 v[124:127], v[44:47], a[132:135], 0
    ds_read_b64_tr_b16 v[36:37], v15 offset:12288
    v_max_f32 v131, 0x358637bd, v131
    v_mfma_f32_16x16x32_bf16 v[116:119], v[44:47], a[128:131], 0
    ds_read_b64_tr_b16 v[38:39], v15 offset:12800
    v_mul_f32 v248, 0x3fb8aa3b, v132
    v_mfma_f32_16x16x32_bf16 v[108:111], v[44:47], a[4:7], 0
    buffer_load_dwordx4 v11, s[48:51], s72 offen offset:1024 sc1 lds
    v_mfma_f32_16x16x32_bf16 v[100:103], v[44:47], a[0:3], 0
    v_exp_f32 v250, v250 clamp
    s_nop 0
    v_add_f32 v130, v130, v250
    v_mfma_f32_16x16x32_bf16 v[64:67], v[48:51], a[8:11], v[64:67]
    v_exp_f32 v251, v251 clamp
    v_mfma_f32_16x16x32_bf16 v[72:75], v[48:51], a[12:15], v[72:75]
    v_add_f32 v131, v131, v251
    v_mfma_f32_16x16x32_bf16 v[80:83], v[48:51], a[136:139], v[80:83]
    buffer_load_dwordx4 v12, s[48:51], s72 offen offset:2048 sc1 lds
    v_mfma_f32_16x16x32_bf16 v[88:91], v[48:51], a[140:143], v[88:91]
    s_waitcnt lgkmcnt(0)
    v_cvt_pk_bf16_f32 v129, v130, v131
    v_mul_f32 v249, 0x3fb8aa3b, v133
    v_mfma_f32_16x16x32_bf16 v[92:95], v[52:55], a[140:143], v[92:95]
    v_mfma_f32_16x16x32_bf16 v[84:87], v[52:55], a[136:139], v[84:87]
    v_exp_f32 v248, v248 clamp
    v_mfma_f32_16x16x32_bf16 v[76:79], v[52:55], a[12:15], v[76:79]
    buffer_load_dwordx4 v13, s[48:51], s72 offen offset:3072 sc1 lds
    v_mfma_f32_16x16x32_bf16 v[68:71], v[52:55], a[8:11], v[68:71]
    s_add_u32 m0, s97, 0
    v_mfma_f32_16x16x32_bf16 v[96:99], v[32:35], a[8:11], v[96:99]
    s_waitcnt vmcnt(18)
    s_barrier
    v_max_f32 v132, 0x358637bd, v132
    v_mfma_f32_16x16x32_bf16 v[104:107], v[32:35], a[12:15], v[104:107]
    ds_read_b64_tr_b16 v[40:41], v14 offset:16384
    v_max_f32 v133, 0x358637bd, v133
    v_mfma_f32_16x16x32_bf16 v[112:115], v[32:35], a[136:139], v[112:115]
    buffer_load_dwordx4 v2, s[36:39], s88 offen offset:0  lds
    v_mfma_f32_16x16x32_bf16 v[120:123], v[32:35], a[140:143], v[120:123]
    ds_read_b64_tr_b16 v[42:43], v14 offset:16896
    v_add_f32 v132, v132, v248
    v_mfma_f32_16x16x32_bf16 v[124:127], v[36:39], a[140:143], v[124:127]
    ds_read_b64_tr_b16 v[44:45], v15 offset:16384
    v_mul_f32 v250, 0x3fb8aa3b, v134
    v_mfma_f32_16x16x32_bf16 v[116:119], v[36:39], a[136:139], v[116:119]
    ds_read_b64_tr_b16 v[46:47], v15 offset:16896
    v_mul_f32 v251, 0x3fb8aa3b, v135
    v_mfma_f32_16x16x32_bf16 v[108:111], v[36:39], a[12:15], v[108:111]
    buffer_load_dwordx4 v3, s[36:39], s88 offen offset:1024  lds
    v_mfma_f32_16x16x32_bf16 v[100:103], v[36:39], a[8:11], v[100:103]
    s_waitcnt lgkmcnt(2)
    ds_read_b64_tr_b16 v[48:49], v14 offset:24576
    v_mfma_f32_16x16x32_bf16 v[64:67], v[40:43], a[16:19], v[64:67]
    ds_read_b64_tr_b16 v[50:51], v14 offset:25088
    v_max_f32 v134, 0x358637bd, v134
    v_mfma_f32_16x16x32_bf16 v[72:75], v[40:43], a[20:23], v[72:75]
    ds_read_b64_tr_b16 v[52:53], v15 offset:24576
    v_max_f32 v135, 0x358637bd, v135
    v_mfma_f32_16x16x32_bf16 v[80:83], v[40:43], a[144:147], v[80:83]
    buffer_load_dwordx4 v4, s[36:39], s88 offen offset:2048  lds
    v_mfma_f32_16x16x32_bf16 v[88:91], v[40:43], a[148:151], v[88:91]
    s_waitcnt lgkmcnt(3)
    ds_read_b64_tr_b16 v[54:55], v15 offset:25088
    v_mfma_f32_16x16x32_bf16 v[92:95], v[44:47], a[148:151], v[92:95]
    ds_read_b64_tr_b16 v[32:33], v14 offset:20480
    v_mfma_f32_16x16x32_bf16 v[84:87], v[44:47], a[144:147], v[84:87]
    ds_read_b64_tr_b16 v[34:35], v14 offset:20992
    v_exp_f32 v249, v249 clamp
    v_mfma_f32_16x16x32_bf16 v[76:79], v[44:47], a[20:23], v[76:79]
    buffer_load_dwordx4 v5, s[36:39], s88 offen offset:3072  lds
    v_mfma_f32_16x16x32_bf16 v[68:71], v[44:47], a[16:19], v[68:71]
    s_waitcnt lgkmcnt(3)
    ds_read_b64_tr_b16 v[36:37], v15 offset:20480
    v_add_f32 v133, v133, v249
    v_mfma_f32_16x16x32_bf16 v[96:99], v[48:51], a[16:19], v[96:99]
    s_add_u32 m0, s97, 114688
    ds_read_b64_tr_b16 v[38:39], v15 offset:20992
    v_cvt_pk_bf16_f32 v130, v132, v133
    v_mfma_f32_16x16x32_bf16 v[104:107], v[48:51], a[20:23], v[104:107]
    ds_read_b64_tr_b16 v[40:41], v14 offset:28672
    v_mul_f32 v248, 0x3fb8aa3b, v136
    v_mfma_f32_16x16x32_bf16 v[112:115], v[48:51], a[144:147], v[112:115]
    buffer_load_dwordx4 v10, s[48:51], s76 offen offset:0 sc1 lds
    v_mfma_f32_16x16x32_bf16 v[120:123], v[48:51], a[148:151], v[120:123]
    s_waitcnt lgkmcnt(3)
    ds_read_b64_tr_b16 v[42:43], v14 offset:29184
    v_mul_f32 v249, 0x3fb8aa3b, v137
    v_mfma_f32_16x16x32_bf16 v[124:127], v[52:55], a[148:151], v[124:127]
    ds_read_b64_tr_b16 v[44:45], v15 offset:28672
    v_exp_f32 v250, v250 clamp
    v_mfma_f32_16x16x32_bf16 v[116:119], v[52:55], a[144:147], v[116:119]
    ds_read_b64_tr_b16 v[46:47], v15 offset:29184
    v_add_f32 v134, v134, v250
    v_mfma_f32_16x16x32_bf16 v[108:111], v[52:55], a[20:23], v[108:111]
    buffer_load_dwordx4 v11, s[48:51], s76 offen offset:1024 sc1 lds
    v_mfma_f32_16x16x32_bf16 v[100:103], v[52:55], a[16:19], v[100:103]
    s_waitcnt vmcnt(14)
    ds_read_b64_tr_b16 a[128:129], v28 offset:16384
    v_mfma_f32_16x16x32_bf16 v[64:67], v[32:35], a[24:27], v[64:67]
    buffer_store_dwordx2 v[20:21], v1, s[44:47], s10 offen offset:0 sc1
    ds_read_b64_tr_b16 a[130:131], v28 offset:18432
    v_max_f32 v136, 0x358637bd, v136
    v_mfma_f32_16x16x32_bf16 v[72:75], v[32:35], a[28:31], v[72:75]
    ds_read_b64_tr_b16 a[132:133], v29 offset:16384
    v_exp_f32 v251, v251 clamp
    v_mfma_f32_16x16x32_bf16 v[80:83], v[32:35], a[152:155], v[80:83]
    buffer_load_dwordx4 v12, s[48:51], s76 offen offset:2048 sc1 lds
    ds_read_b64_tr_b16 a[134:135], v29 offset:18432
    v_mfma_f32_16x16x32_bf16 v[88:91], v[32:35], a[156:159], v[88:91]
    s_waitcnt lgkmcnt(4)
    ds_read_b64_tr_b16 a[136:137], v30 offset:16384
    v_mfma_f32_16x16x32_bf16 v[92:95], v[36:39], a[156:159], v[92:95]
    ds_read_b64_tr_b16 a[138:139], v30 offset:18432
    v_add_f32 v135, v135, v251
    v_cvt_pk_bf16_f32 v131, v134, v135
    v_mfma_f32_16x16x32_bf16 v[84:87], v[36:39], a[152:155], v[84:87]
    v_exp_f32 v248, v248 clamp
    v_mfma_f32_16x16x32_bf16 v[76:79], v[36:39], a[28:31], v[76:79]
    buffer_load_dwordx4 v13, s[48:51], s76 offen offset:3072 sc1 lds
    v_mfma_f32_16x16x32_bf16 v[68:71], v[36:39], a[24:27], v[68:71]
    s_add_u32 m0, s97, 16384
    v_exp_f32 v249, v249 clamp
    v_mfma_f32_16x16x32_bf16 v[96:99], v[40:43], a[24:27], v[96:99]
    s_waitcnt lgkmcnt(0)
    s_barrier
    v_max_f32 v137, 0x358637bd, v137
    v_mfma_f32_16x16x32_bf16 v[104:107], v[40:43], a[28:31], v[104:107]
    ds_read_b64_tr_b16 v[48:49], v14 offset:32768
    v_add_f32 v136, v136, v248
    v_mfma_f32_16x16x32_bf16 v[112:115], v[40:43], a[152:155], v[112:115]
    buffer_load_dwordx4 v2, s[36:39], s89 offen offset:0  lds
    ds_read_b64_tr_b16 a[140:141], v31 offset:16384
    v_mfma_f32_16x16x32_bf16 v[120:123], v[40:43], a[156:159], v[120:123]
    ds_read_b64_tr_b16 v[50:51], v14 offset:33280
    v_add_f32 v137, v137, v249
    v_mfma_f32_16x16x32_bf16 v[124:127], v[44:47], a[156:159], v[124:127]
    ds_read_b64_tr_b16 v[52:53], v15 offset:32768
    v_cvt_pk_bf16_f32 v136, v136, v137
    v_mfma_f32_16x16x32_bf16 v[116:119], v[44:47], a[152:155], v[116:119]
    ds_read_b64_tr_b16 v[54:55], v15 offset:33280
    ds_read_b64_tr_b16 a[142:143], v31 offset:18432
    v_mfma_f32_16x16x32_bf16 v[108:111], v[44:47], a[28:31], v[108:111]
    buffer_load_dwordx4 v3, s[36:39], s89 offen offset:1024  lds
    v_mfma_f32_16x16x32_bf16 v[100:103], v[44:47], a[24:27], v[100:103]
    s_waitcnt lgkmcnt(3)
    ds_read_b64_tr_b16 v[32:33], v14 offset:40960
    v_mfma_f32_16x16x32_bf16 v[64:67], v[48:51], a[32:35], v[64:67]
    ds_read_b64_tr_b16 v[34:35], v14 offset:41472
    v_mul_f32 v250, 0x3fb8aa3b, v138
    v_mul_f32 v251, 0x3fb8aa3b, v139
    v_mfma_f32_16x16x32_bf16 v[72:75], v[48:51], a[36:39], v[72:75]
    ds_read_b64_tr_b16 v[36:37], v15 offset:40960
    v_max_f32 v138, 0x358637bd, v138
    v_mfma_f32_16x16x32_bf16 v[80:83], v[48:51], a[160:163], v[80:83]
    buffer_load_dwordx4 v4, s[36:39], s89 offen offset:2048  lds
    v_mfma_f32_16x16x32_bf16 v[88:91], v[48:51], a[164:167], v[88:91]
    s_waitcnt lgkmcnt(4)
    ds_read_b64_tr_b16 v[38:39], v15 offset:41472
    v_mfma_f32_16x16x32_bf16 v[92:95], v[52:55], a[164:167], v[92:95]
    ds_read_b64_tr_b16 v[40:41], v14 offset:36864
    v_exp_f32 v250, v250 clamp
    v_mfma_f32_16x16x32_bf16 v[84:87], v[52:55], a[160:163], v[84:87]
    ds_read_b64_tr_b16 v[42:43], v14 offset:37376
    v_max_f32 v139, 0x358637bd, v139
    v_mfma_f32_16x16x32_bf16 v[76:79], v[52:55], a[36:39], v[76:79]
    buffer_load_dwordx4 v5, s[36:39], s89 offen offset:3072  lds
    v_mfma_f32_16x16x32_bf16 v[68:71], v[52:55], a[32:35], v[68:71]
    s_waitcnt lgkmcnt(3)
    ds_read_b64_tr_b16 v[44:45], v15 offset:36864
    v_mfma_f32_16x16x32_bf16 v[96:99], v[32:35], a[32:35], v[96:99]
    s_add_u32 m0, s97, 131072
    ds_read_b64_tr_b16 v[46:47], v15 offset:37376
    v_add_f32 v138, v138, v250
    v_mfma_f32_16x16x32_bf16 v[104:107], v[32:35], a[36:39], v[104:107]
    ds_read_b64_tr_b16 v[48:49], v14 offset:45056
    v_exp_f32 v251, v251 clamp
    v_mfma_f32_16x16x32_bf16 v[112:115], v[32:35], a[160:163], v[112:115]
    buffer_load_dwordx4 v10, s[48:51], s80 offen offset:0 sc1 lds
    v_mfma_f32_16x16x32_bf16 v[120:123], v[32:35], a[164:167], v[120:123]
    s_waitcnt lgkmcnt(3)
    ds_read_b64_tr_b16 v[50:51], v14 offset:45568
    v_add_f32 v139, v139, v251
    v_mfma_f32_16x16x32_bf16 v[124:127], v[36:39], a[164:167], v[124:127]
    ds_read_b64_tr_b16 v[52:53], v15 offset:45056
    v_cvt_pk_bf16_f32 v137, v138, v139
    v_mfma_f32_16x16x32_bf16 v[116:119], v[36:39], a[160:163], v[116:119]
    ds_read_b64_tr_b16 v[54:55], v15 offset:45568
    v_mul_f32 v248, 0x3fb8aa3b, v140
    v_mfma_f32_16x16x32_bf16 v[108:111], v[36:39], a[36:39], v[108:111]
    buffer_load_dwordx4 v11, s[48:51], s80 offen offset:1024 sc1 lds
    v_mfma_f32_16x16x32_bf16 v[100:103], v[36:39], a[32:35], v[100:103]
    s_waitcnt vmcnt(15)
    ds_read_b64_tr_b16 a[0:1], v28 offset:32768
    v_mul_f32 v249, 0x3fb8aa3b, v141
    v_mfma_f32_16x16x32_bf16 v[64:67], v[40:43], a[40:43], v[64:67]
    ds_read_b64_tr_b16 a[2:3], v28 offset:34816
    v_exp_f32 v248, v248 clamp
    v_mfma_f32_16x16x32_bf16 v[72:75], v[40:43], a[44:47], v[72:75]
    ds_read_b64_tr_b16 a[4:5], v29 offset:32768
    v_max_f32 v140, 0x358637bd, v140
    v_mfma_f32_16x16x32_bf16 v[80:83], v[40:43], a[168:171], v[80:83]
    buffer_load_dwordx4 v12, s[48:51], s80 offen offset:2048 sc1 lds
    ds_read_b64_tr_b16 a[6:7], v29 offset:34816
    v_mfma_f32_16x16x32_bf16 v[88:91], v[40:43], a[172:175], v[88:91]
    s_waitcnt lgkmcnt(4)
    ds_read_b64_tr_b16 a[8:9], v30 offset:32768
    v_mfma_f32_16x16x32_bf16 v[92:95], v[44:47], a[172:175], v[92:95]
    ds_read_b64_tr_b16 a[10:11], v30 offset:34816
    v_exp_f32 v249, v249 clamp
    v_mfma_f32_16x16x32_bf16 v[84:87], v[44:47], a[168:171], v[84:87]
    v_max_f32 v141, 0x358637bd, v141
    v_add_f32 v140, v140, v248
    v_mfma_f32_16x16x32_bf16 v[76:79], v[44:47], a[44:47], v[76:79]
    buffer_load_dwordx4 v13, s[48:51], s80 offen offset:3072 sc1 lds
    v_mfma_f32_16x16x32_bf16 v[68:71], v[44:47], a[40:43], v[68:71]
    s_add_u32 m0, s97, 32768
    v_add_f32 v141, v141, v249
    v_cvt_pk_bf16_f32 v138, v140, v141
    v_mfma_f32_16x16x32_bf16 v[96:99], v[48:51], a[40:43], v[96:99]
    s_waitcnt lgkmcnt(0)
    s_barrier
    v_mul_f32 v250, 0x3fb8aa3b, v142
    v_mfma_f32_16x16x32_bf16 v[104:107], v[48:51], a[44:47], v[104:107]
    ds_read_b64_tr_b16 v[32:33], v14 offset:49152
    v_mul_f32 v251, 0x3fb8aa3b, v143
    v_mfma_f32_16x16x32_bf16 v[112:115], v[48:51], a[168:171], v[112:115]
    buffer_load_dwordx4 v2, s[36:39], s90 offen offset:0  lds
    ds_read_b64_tr_b16 a[12:13], v31 offset:32768
    v_mfma_f32_16x16x32_bf16 v[120:123], v[48:51], a[172:175], v[120:123]
    ds_read_b64_tr_b16 v[34:35], v14 offset:49664
    v_max_f32 v142, 0x358637bd, v142
    v_mfma_f32_16x16x32_bf16 v[124:127], v[52:55], a[172:175], v[124:127]
    ds_read_b64_tr_b16 v[36:37], v15 offset:49152
    v_max_f32 v143, 0x358637bd, v143
    v_mfma_f32_16x16x32_bf16 v[116:119], v[52:55], a[168:171], v[116:119]
    ds_read_b64_tr_b16 v[38:39], v15 offset:49664
    ds_read_b64_tr_b16 a[14:15], v31 offset:34816
    v_mfma_f32_16x16x32_bf16 v[108:111], v[52:55], a[44:47], v[108:111]
    buffer_load_dwordx4 v3, s[36:39], s90 offen offset:1024  lds
    v_mfma_f32_16x16x32_bf16 v[100:103], v[52:55], a[40:43], v[100:103]
    s_waitcnt lgkmcnt(3)
    ds_read_b64_tr_b16 v[40:41], v14 offset:57344
    v_mfma_f32_16x16x32_bf16 v[64:67], v[32:35], a[48:51], v[64:67]
    ds_read_b64_tr_b16 v[42:43], v14 offset:57856
    v_mul_f32 v248, 0x3fb8aa3b, v144
    v_mfma_f32_16x16x32_bf16 v[72:75], v[32:35], a[52:55], v[72:75]
    ds_read_b64_tr_b16 v[44:45], v15 offset:57344
    v_mul_f32 v249, 0x3fb8aa3b, v145
    v_mfma_f32_16x16x32_bf16 v[80:83], v[32:35], a[176:179], v[80:83]
    buffer_load_dwordx4 v4, s[36:39], s90 offen offset:2048  lds
    v_mfma_f32_16x16x32_bf16 v[88:91], v[32:35], a[180:183], v[88:91]
    s_waitcnt lgkmcnt(4)
    ds_read_b64_tr_b16 v[46:47], v15 offset:57856
    v_max_f32 v144, 0x358637bd, v144
    v_mfma_f32_16x16x32_bf16 v[92:95], v[36:39], a[180:183], v[92:95]
    ds_read_b64_tr_b16 v[48:49], v14 offset:53248
    v_exp_f32 v250, v250 clamp
    v_mfma_f32_16x16x32_bf16 v[84:87], v[36:39], a[176:179], v[84:87]
    ds_read_b64_tr_b16 v[50:51], v14 offset:53760
    v_add_f32 v142, v142, v250
    v_mfma_f32_16x16x32_bf16 v[76:79], v[36:39], a[52:55], v[76:79]
    buffer_load_dwordx4 v5, s[36:39], s90 offen offset:3072  lds
    v_mfma_f32_16x16x32_bf16 v[68:71], v[36:39], a[48:51], v[68:71]
    s_waitcnt lgkmcnt(3)
    ds_read_b64_tr_b16 v[52:53], v15 offset:53248
    v_mfma_f32_16x16x32_bf16 v[96:99], v[40:43], a[48:51], v[96:99]
    s_add_u32 m0, s97, 65536
    ds_read_b64_tr_b16 v[54:55], v15 offset:53760
    v_max_f32 v145, 0x358637bd, v145
    v_mfma_f32_16x16x32_bf16 v[104:107], v[40:43], a[52:55], v[104:107]
    s_lshl_b32 s23, s0, 3
    ds_read_b64_tr_b16 v[32:33], v14 offset:61440
    v_mfma_f32_16x16x32_bf16 v[112:115], v[40:43], a[176:179], v[112:115]
    buffer_load_dwordx4 v10, s[52:55], s23 offen offset:0 sc1 lds
    v_mfma_f32_16x16x32_bf16 v[120:123], v[40:43], a[180:183], v[120:123]
    s_waitcnt lgkmcnt(3)
    ds_read_b64_tr_b16 v[34:35], v14 offset:61952
    v_exp_f32 v251, v251 clamp
    v_mfma_f32_16x16x32_bf16 v[124:127], v[44:47], a[180:183], v[124:127]
    ds_read_b64_tr_b16 v[36:37], v15 offset:61440
    v_add_f32 v143, v143, v251
    v_cvt_pk_bf16_f32 v139, v142, v143
    v_mfma_f32_16x16x32_bf16 v[116:119], v[44:47], a[176:179], v[116:119]
    ds_read_b64_tr_b16 v[38:39], v15 offset:61952
    v_mul_f32 v250, 0x3fb8aa3b, v146
    v_mfma_f32_16x16x32_bf16 v[108:111], v[44:47], a[52:55], v[108:111]
    buffer_load_dwordx4 v11, s[52:55], s23 offen offset:1024 sc1 lds
    v_mfma_f32_16x16x32_bf16 v[100:103], v[44:47], a[48:51], v[100:103]
    s_waitcnt vmcnt(14)
    ds_read_b64_tr_b16 a[144:145], v28 offset:49152
    v_mfma_f32_16x16x32_bf16 v[64:67], v[48:51], a[56:59], v[64:67]
    ds_read_b64_tr_b16 a[146:147], v28 offset:51200
    v_exp_f32 v248, v248 clamp
    v_mfma_f32_16x16x32_bf16 v[72:75], v[48:51], a[60:63], v[72:75]
    ds_read_b64_tr_b16 a[148:149], v29 offset:49152
    v_add_f32 v144, v144, v248
    v_mfma_f32_16x16x32_bf16 v[80:83], v[48:51], a[184:187], v[80:83]
    buffer_load_dwordx4 v12, s[52:55], s23 offen offset:2048 sc1 lds
    ds_read_b64_tr_b16 a[150:151], v29 offset:51200
    v_mfma_f32_16x16x32_bf16 v[88:91], v[48:51], a[188:191], v[88:91]
    s_waitcnt lgkmcnt(4)
    ds_read_b64_tr_b16 a[152:153], v30 offset:49152
    v_mul_f32 v251, 0x3fb8aa3b, v147
    v_mfma_f32_16x16x32_bf16 v[92:95], v[52:55], a[188:191], v[92:95]
    ds_read_b64_tr_b16 a[154:155], v30 offset:51200
    v_max_f32 v146, 0x358637bd, v146
    v_mfma_f32_16x16x32_bf16 v[84:87], v[52:55], a[184:187], v[84:87]
    v_exp_f32 v249, v249 clamp
    v_mfma_f32_16x16x32_bf16 v[76:79], v[52:55], a[60:63], v[76:79]
    buffer_load_dwordx4 v13, s[52:55], s23 offen offset:3072 sc1 lds
    v_mfma_f32_16x16x32_bf16 v[68:71], v[52:55], a[56:59], v[68:71]
    s_add_u32 m0, s97, 49152
    v_add_f32 v145, v145, v249
    v_cvt_pk_bf16_f32 v144, v144, v145
    v_mfma_f32_16x16x32_bf16 v[96:99], v[32:35], a[56:59], v[96:99]
    s_waitcnt lgkmcnt(0)
    s_barrier
    v_max_f32 v147, 0x358637bd, v147
    v_mfma_f32_16x16x32_bf16 v[104:107], v[32:35], a[60:63], v[104:107]
    ds_read_b64_tr_b16 v[40:41], v14 offset:0
    v_mul_f32 v248, 0x3fb8aa3b, v148
    v_mfma_f32_16x16x32_bf16 v[112:115], v[32:35], a[184:187], v[112:115]
    buffer_load_dwordx4 v2, s[36:39], s91 offen offset:0  lds
    ds_read_b64_tr_b16 a[156:157], v31 offset:49152
    v_mfma_f32_16x16x32_bf16 v[120:123], v[32:35], a[188:191], v[120:123]
    ds_read_b64_tr_b16 v[42:43], v14 offset:512
    v_mul_f32 v249, 0x3fb8aa3b, v149
    v_mfma_f32_16x16x32_bf16 v[124:127], v[36:39], a[188:191], v[124:127]
    ds_read_b64_tr_b16 v[44:45], v15 offset:0
    v_max_f32 v148, 0x358637bd, v148
    v_mfma_f32_16x16x32_bf16 v[116:119], v[36:39], a[184:187], v[116:119]
    ds_read_b64_tr_b16 v[46:47], v15 offset:512
    ds_read_b64_tr_b16 a[158:159], v31 offset:51200
    v_mfma_f32_16x16x32_bf16 v[108:111], v[36:39], a[60:63], v[108:111]
    buffer_load_dwordx4 v3, s[36:39], s91 offen offset:1024  lds
    v_mfma_f32_16x16x32_bf16 v[100:103], v[36:39], a[56:59], v[100:103]
    s_waitcnt lgkmcnt(3)
    ds_read_b64_tr_b16 v[48:49], v14 offset:8192
    v_mfma_f32_16x16x32_bf16 v[64:67], v[40:43], a[64:67], v[64:67]
    ds_read_b64_tr_b16 v[50:51], v14 offset:8704
    v_exp_f32 v250, v250 clamp
    v_mfma_f32_16x16x32_bf16 v[72:75], v[40:43], a[68:71], v[72:75]
    ds_read_b64_tr_b16 v[52:53], v15 offset:8192
    v_add_f32 v146, v146, v250
    v_mfma_f32_16x16x32_bf16 v[80:83], v[40:43], a[192:195], v[80:83]
    buffer_load_dwordx4 v4, s[36:39], s91 offen offset:2048  lds
    v_mfma_f32_16x16x32_bf16 v[88:91], v[40:43], a[196:199], v[88:91]
    s_waitcnt lgkmcnt(4)
    ds_read_b64_tr_b16 v[54:55], v15 offset:8704
    v_mfma_f32_16x16x32_bf16 v[92:95], v[44:47], a[196:199], v[92:95]
    ds_read_b64_tr_b16 v[32:33], v14 offset:4096
    v_exp_f32 v251, v251 clamp
    v_mfma_f32_16x16x32_bf16 v[84:87], v[44:47], a[192:195], v[84:87]
    ds_read_b64_tr_b16 v[34:35], v14 offset:4608
    v_add_f32 v147, v147, v251
    v_mfma_f32_16x16x32_bf16 v[76:79], v[44:47], a[68:71], v[76:79]
    buffer_load_dwordx4 v5, s[36:39], s91 offen offset:3072  lds
    v_mfma_f32_16x16x32_bf16 v[68:71], v[44:47], a[64:67], v[68:71]
    s_waitcnt lgkmcnt(3)
    ds_read_b64_tr_b16 v[36:37], v15 offset:4096
    v_cvt_pk_bf16_f32 v145, v146, v147
    v_mfma_f32_16x16x32_bf16 v[96:99], v[48:51], a[64:67], v[96:99]
    s_add_u32 m0, s97, 81920
    ds_read_b64_tr_b16 v[38:39], v15 offset:4608
    v_mfma_f32_16x16x32_bf16 v[104:107], v[48:51], a[68:71], v[104:107]
    ds_read_b64_tr_b16 v[40:41], v14 offset:12288
    v_exp_f32 v248, v248 clamp
    v_mfma_f32_16x16x32_bf16 v[112:115], v[48:51], a[192:195], v[112:115]
    buffer_load_dwordx4 v10, s[48:51], s69 offen offset:0 sc1 lds
    v_mfma_f32_16x16x32_bf16 v[120:123], v[48:51], a[196:199], v[120:123]
    s_waitcnt lgkmcnt(3)
    ds_read_b64_tr_b16 v[42:43], v14 offset:12800
    v_max_f32 v149, 0x358637bd, v149
    v_mfma_f32_16x16x32_bf16 v[124:127], v[52:55], a[196:199], v[124:127]
    ds_read_b64_tr_b16 v[44:45], v15 offset:12288
    v_exp_f32 v249, v249 clamp
    v_mfma_f32_16x16x32_bf16 v[116:119], v[52:55], a[192:195], v[116:119]
    ds_read_b64_tr_b16 v[46:47], v15 offset:12800
    v_add_f32 v148, v148, v248
    v_mfma_f32_16x16x32_bf16 v[108:111], v[52:55], a[68:71], v[108:111]
    buffer_load_dwordx4 v11, s[48:51], s69 offen offset:1024 sc1 lds
    v_mfma_f32_16x16x32_bf16 v[100:103], v[52:55], a[64:67], v[100:103]
    v_add_f32 v149, v149, v249
    v_cvt_pk_bf16_f32 v146, v148, v149
    v_mfma_f32_16x16x32_bf16 v[64:67], v[32:35], a[72:75], v[64:67]
    v_mul_f32 v250, 0x3fb8aa3b, v150
    v_mul_f32 v251, 0x3fb8aa3b, v151
    v_mfma_f32_16x16x32_bf16 v[72:75], v[32:35], a[76:79], v[72:75]
    v_exp_f32 v250, v250 clamp
    v_mfma_f32_16x16x32_bf16 v[80:83], v[32:35], a[200:203], v[80:83]
    buffer_load_dwordx4 v12, s[48:51], s69 offen offset:2048 sc1 lds
    v_mfma_f32_16x16x32_bf16 v[88:91], v[32:35], a[204:207], v[88:91]
    s_waitcnt lgkmcnt(0)
    v_mfma_f32_16x16x32_bf16 v[92:95], v[36:39], a[204:207], v[92:95]
    v_exp_f32 v251, v251 clamp
    v_mfma_f32_16x16x32_bf16 v[84:87], v[36:39], a[200:203], v[84:87]
    v_max_f32 v150, 0x358637bd, v150
    v_mfma_f32_16x16x32_bf16 v[76:79], v[36:39], a[76:79], v[76:79]
    buffer_load_dwordx4 v13, s[48:51], s69 offen offset:3072 sc1 lds
    v_mfma_f32_16x16x32_bf16 v[68:71], v[36:39], a[72:75], v[68:71]
    s_add_u32 m0, s97, 98304
    v_max_f32 v151, 0x358637bd, v151
    v_mfma_f32_16x16x32_bf16 v[96:99], v[40:43], a[72:75], v[96:99]
    s_waitcnt vmcnt(20)
    s_barrier
    v_add_f32 v150, v150, v250
    v_mfma_f32_16x16x32_bf16 v[104:107], v[40:43], a[76:79], v[104:107]
    ds_read_b64_tr_b16 v[48:49], v14 offset:16384
    v_add_f32 v151, v151, v251
    v_mfma_f32_16x16x32_bf16 v[112:115], v[40:43], a[200:203], v[112:115]
    buffer_load_dwordx4 v10, s[48:51], s70 offen offset:0 sc1 lds
    v_mfma_f32_16x16x32_bf16 v[120:123], v[40:43], a[204:207], v[120:123]
    ds_read_b64_tr_b16 v[50:51], v14 offset:16896
    v_cvt_pk_bf16_f32 v147, v150, v151
    v_mfma_f32_16x16x32_bf16 v[124:127], v[44:47], a[204:207], v[124:127]
    ds_read_b64_tr_b16 v[52:53], v15 offset:16384
    v_mul_f32 v248, 0x3fb8aa3b, v152
    v_mfma_f32_16x16x32_bf16 v[116:119], v[44:47], a[200:203], v[116:119]
    ds_read_b64_tr_b16 v[54:55], v15 offset:16896
    v_mul_f32 v249, 0x3fb8aa3b, v153
    v_mfma_f32_16x16x32_bf16 v[108:111], v[44:47], a[76:79], v[108:111]
    buffer_load_dwordx4 v11, s[48:51], s70 offen offset:1024 sc1 lds
    v_mfma_f32_16x16x32_bf16 v[100:103], v[44:47], a[72:75], v[100:103]
    s_waitcnt lgkmcnt(2)
    ds_read_b64_tr_b16 v[32:33], v14 offset:24576
    v_mfma_f32_16x16x32_bf16 v[64:67], v[48:51], a[80:83], v[64:67]
    ds_read_b64_tr_b16 v[34:35], v14 offset:25088
    v_max_f32 v152, 0x358637bd, v152
    v_mfma_f32_16x16x32_bf16 v[72:75], v[48:51], a[84:87], v[72:75]
    ds_read_b64_tr_b16 v[36:37], v15 offset:24576
    v_max_f32 v153, 0x358637bd, v153
    v_mfma_f32_16x16x32_bf16 v[80:83], v[48:51], a[208:211], v[80:83]
    buffer_load_dwordx4 v12, s[48:51], s70 offen offset:2048 sc1 lds
    v_mfma_f32_16x16x32_bf16 v[88:91], v[48:51], a[212:215], v[88:91]
    s_waitcnt lgkmcnt(3)
    ds_read_b64_tr_b16 v[38:39], v15 offset:25088
    v_mfma_f32_16x16x32_bf16 v[92:95], v[52:55], a[212:215], v[92:95]
    ds_read_b64_tr_b16 v[40:41], v14 offset:20480
    v_mul_f32 v250, 0x3fb8aa3b, v154
    v_mfma_f32_16x16x32_bf16 v[84:87], v[52:55], a[208:211], v[84:87]
    ds_read_b64_tr_b16 v[42:43], v14 offset:20992
    v_mul_f32 v251, 0x3fb8aa3b, v155
    v_mfma_f32_16x16x32_bf16 v[76:79], v[52:55], a[84:87], v[76:79]
    buffer_load_dwordx4 v13, s[48:51], s70 offen offset:3072 sc1 lds
    v_mfma_f32_16x16x32_bf16 v[68:71], v[52:55], a[80:83], v[68:71]
    s_waitcnt lgkmcnt(3)
    ds_read_b64_tr_b16 v[44:45], v15 offset:20480
    v_mfma_f32_16x16x32_bf16 v[96:99], v[32:35], a[80:83], v[96:99]
    s_add_u32 m0, s97, 114688
    ds_read_b64_tr_b16 v[46:47], v15 offset:20992
    v_max_f32 v154, 0x358637bd, v154
    v_mfma_f32_16x16x32_bf16 v[104:107], v[32:35], a[84:87], v[104:107]
    ds_read_b64_tr_b16 v[48:49], v14 offset:28672
    v_exp_f32 v248, v248 clamp
    v_mfma_f32_16x16x32_bf16 v[112:115], v[32:35], a[208:211], v[112:115]
    buffer_load_dwordx4 v10, s[48:51], s77 offen offset:0 sc1 lds
    v_mfma_f32_16x16x32_bf16 v[120:123], v[32:35], a[212:215], v[120:123]
    s_waitcnt lgkmcnt(3)
    ds_read_b64_tr_b16 v[50:51], v14 offset:29184
    v_mfma_f32_16x16x32_bf16 v[124:127], v[36:39], a[212:215], v[124:127]
    ds_read_b64_tr_b16 v[52:53], v15 offset:28672
    buffer_load_dwordx2 v[16:17], v18, s[44:47], s11 offen sc1
    v_add_f32 v152, v152, v248
    v_mfma_f32_16x16x32_bf16 v[116:119], v[36:39], a[208:211], v[116:119]
    ds_read_b64_tr_b16 v[54:55], v15 offset:29184
    v_exp_f32 v249, v249 clamp
    v_mfma_f32_16x16x32_bf16 v[108:111], v[36:39], a[84:87], v[108:111]
    buffer_load_dwordx4 v11, s[48:51], s77 offen offset:1024 sc1 lds
    v_mfma_f32_16x16x32_bf16 v[100:103], v[36:39], a[80:83], v[100:103]
    v_add_f32 v153, v153, v249
    v_cvt_pk_bf16_f32 v152, v152, v153
    v_max_f32 v155, 0x358637bd, v155
    v_mfma_f32_16x16x32_bf16 v[64:67], v[40:43], a[88:91], v[64:67]
    v_exp_f32 v250, v250 clamp
    v_mfma_f32_16x16x32_bf16 v[72:75], v[40:43], a[92:95], v[72:75]
    v_mfma_f32_16x16x32_bf16 v[80:83], v[40:43], a[216:219], v[80:83]
    buffer_load_dwordx4 v12, s[48:51], s77 offen offset:2048 sc1 lds
    v_mfma_f32_16x16x32_bf16 v[88:91], v[40:43], a[220:223], v[88:91]
    s_waitcnt lgkmcnt(0)
    v_exp_f32 v251, v251 clamp
    v_mfma_f32_16x16x32_bf16 v[92:95], v[44:47], a[220:223], v[92:95]
    v_add_f32 v154, v154, v250
    v_add_f32 v155, v155, v251
    v_mfma_f32_16x16x32_bf16 v[84:87], v[44:47], a[216:219], v[84:87]
    v_mfma_f32_16x16x32_bf16 v[76:79], v[44:47], a[92:95], v[76:79]
    buffer_load_dwordx4 v13, s[48:51], s77 offen offset:3072 sc1 lds
    v_mfma_f32_16x16x32_bf16 v[68:71], v[44:47], a[88:91], v[68:71]
    s_add_u32 m0, s97, 0
    v_cvt_pk_bf16_f32 v153, v154, v155
    v_mul_f32 v248, 0x3fb8aa3b, v156
    v_mfma_f32_16x16x32_bf16 v[96:99], v[48:51], a[88:91], v[96:99]
    s_waitcnt vmcnt(21)
    s_barrier
    v_mul_f32 v249, 0x3fb8aa3b, v157
    v_mfma_f32_16x16x32_bf16 v[104:107], v[48:51], a[92:95], v[104:107]
    ds_read_b64_tr_b16 v[32:33], v14 offset:32768
    v_max_f32 v156, 0x358637bd, v156
    v_mfma_f32_16x16x32_bf16 v[112:115], v[48:51], a[216:219], v[112:115]
    buffer_load_dwordx4 v10, s[48:51], s71 offen offset:0 sc1 lds
    v_mfma_f32_16x16x32_bf16 v[120:123], v[48:51], a[220:223], v[120:123]
    ds_read_b64_tr_b16 v[34:35], v14 offset:33280
    v_max_f32 v157, 0x358637bd, v157
L_padQ2:
    s_cbranch_execz L_retQ
    v_mfma_f32_16x16x32_bf16 v[124:127], v[52:55], a[220:223], v[124:127]
    ds_read_b64_tr_b16 v[36:37], v15 offset:32768
    v_mul_f32 v250, 0x3fb8aa3b, v158
    v_mfma_f32_16x16x32_bf16 v[116:119], v[52:55], a[216:219], v[116:119]
    ds_read_b64_tr_b16 v[38:39], v15 offset:33280
    v_mul_f32 v251, 0x3fb8aa3b, v159
    v_mfma_f32_16x16x32_bf16 v[108:111], v[52:55], a[92:95], v[108:111]
    buffer_load_dwordx4 v11, s[48:51], s71 offen offset:1024 sc1 lds
    v_mfma_f32_16x16x32_bf16 v[100:103], v[52:55], a[88:91], v[100:103]
    s_waitcnt lgkmcnt(2)
    ds_read_b64_tr_b16 v[40:41], v14 offset:40960
    v_mfma_f32_16x16x32_bf16 v[64:67], v[32:35], a[96:99], v[64:67]
    ds_read_b64_tr_b16 v[42:43], v14 offset:41472
    buffer_load_dwordx2 v[8:9], v6, s[44:47], s4 offen offset:512 sc1
    v_mfma_f32_16x16x32_bf16 v[72:75], v[32:35], a[100:103], v[72:75]
    ds_read_b64_tr_b16 v[44:45], v15 offset:40960
    v_max_f32 v158, 0x358637bd, v158
    v_mfma_f32_16x16x32_bf16 v[80:83], v[32:35], a[224:227], v[80:83]
    buffer_load_dwordx4 v12, s[48:51], s71 offen offset:2048 sc1 lds
    v_mfma_f32_16x16x32_bf16 v[88:91], v[32:35], a[228:231], v[88:91]
    s_waitcnt lgkmcnt(3)
    ds_read_b64_tr_b16 v[46:47], v15 offset:41472
    v_mfma_f32_16x16x32_bf16 v[92:95], v[36:39], a[228:231], v[92:95]
    ds_read_b64_tr_b16 v[48:49], v14 offset:36864
    v_max_f32 v159, 0x358637bd, v159
    v_mfma_f32_16x16x32_bf16 v[84:87], v[36:39], a[224:227], v[84:87]
    ds_read_b64_tr_b16 v[50:51], v14 offset:37376
    v_mfma_f32_16x16x32_bf16 v[76:79], v[36:39], a[100:103], v[76:79]
    buffer_load_dwordx4 v13, s[48:51], s71 offen offset:3072 sc1 lds
    v_mfma_f32_16x16x32_bf16 v[68:71], v[36:39], a[96:99], v[68:71]
    s_waitcnt lgkmcnt(3)
    ds_read_b64_tr_b16 v[52:53], v15 offset:36864
    v_exp_f32 v248, v248 clamp
    v_mfma_f32_16x16x32_bf16 v[96:99], v[40:43], a[96:99], v[96:99]
    s_add_u32 m0, s97, 16384
    ds_read_b64_tr_b16 v[54:55], v15 offset:37376
    v_add_f32 v156, v156, v248
    v_mfma_f32_16x16x32_bf16 v[104:107], v[40:43], a[100:103], v[104:107]
    ds_read_b64_tr_b16 v[32:33], v14 offset:45056
    v_mfma_f32_16x16x32_bf16 v[112:115], v[40:43], a[224:227], v[112:115]
    buffer_load_dwordx4 v10, s[48:51], s73 offen offset:0 sc1 lds
    v_mfma_f32_16x16x32_bf16 v[120:123], v[40:43], a[228:231], v[120:123]
    s_waitcnt lgkmcnt(3)
    ds_read_b64_tr_b16 v[34:35], v14 offset:45568
    v_exp_f32 v249, v249 clamp
    v_mfma_f32_16x16x32_bf16 v[124:127], v[44:47], a[228:231], v[124:127]
    ds_read_b64_tr_b16 v[36:37], v15 offset:45056
    v_add_f32 v157, v157, v249
    v_cvt_pk_bf16_f32 v154, v156, v157
    v_mfma_f32_16x16x32_bf16 v[116:119], v[44:47], a[224:227], v[116:119]
    ds_read_b64_tr_b16 v[38:39], v15 offset:45568
    v_mfma_f32_16x16x32_bf16 v[108:111], v[44:47], a[100:103], v[108:111]
    buffer_load_dwordx4 v11, s[48:51], s73 offen offset:1024 sc1 lds
    v_mfma_f32_16x16x32_bf16 v[100:103], v[44:47], a[96:99], v[100:103]
    v_exp_f32 v250, v250 clamp
    s_nop 0
    v_add_f32 v158, v158, v250
    v_mfma_f32_16x16x32_bf16 v[64:67], v[48:51], a[104:107], v[64:67]
    v_exp_f32 v251, v251 clamp
    v_mfma_f32_16x16x32_bf16 v[72:75], v[48:51], a[108:111], v[72:75]
    v_add_f32 v159, v159, v251
    v_cvt_pk_bf16_f32 v155, v158, v159
    v_mfma_f32_16x16x32_bf16 v[80:83], v[48:51], a[232:235], v[80:83]
    buffer_load_dwordx4 v12, s[48:51], s73 offen offset:2048 sc1 lds
    v_mfma_f32_16x16x32_bf16 v[88:91], v[48:51], a[236:239], v[88:91]
    s_waitcnt lgkmcnt(0)
    v_mfma_f32_16x16x32_bf16 v[92:95], v[52:55], a[236:239], v[92:95]
    v_mfma_f32_16x16x32_bf16 v[84:87], v[52:55], a[232:235], v[84:87]
    s_waitcnt vmcnt(11)
    v_cmp_eq_u64 vcc, s[6:7], v[16:17]
    s_nop 0
    s_cmp_eq_u32 vcc_lo, s15
    s_cbranch_scc0 L_slow_kv
L_back_kv:
    v_mfma_f32_16x16x32_bf16 v[76:79], v[52:55], a[108:111], v[76:79]
    buffer_load_dwordx4 v13, s[48:51], s73 offen offset:3072 sc1 lds
    v_mfma_f32_16x16x32_bf16 v[68:71], v[52:55], a[104:107], v[68:71]
    v_mfma_f32_16x16x32_bf16 v[96:99], v[32:35], a[104:107], v[96:99]
    s_barrier
    v_mfma_f32_16x16x32_bf16 v[104:107], v[32:35], a[108:111], v[104:107]
    ds_read_b64_tr_b16 v[40:41], v14 offset:49152
    v_mfma_f32_16x16x32_bf16 v[112:115], v[32:35], a[232:235], v[112:115]
    buffer_load_dwordx4 v[160:163], v0, s[44:47], s13 offen offset:0 sc1
    v_mfma_f32_16x16x32_bf16 v[120:123], v[32:35], a[236:239], v[120:123]
    ds_read_b64_tr_b16 v[42:43], v14 offset:49664
    v_mfma_f32_16x16x32_bf16 v[124:127], v[36:39], a[236:239], v[124:127]
    ds_read_b64_tr_b16 v[44:45], v15 offset:49152
    v_mfma_f32_16x16x32_bf16 v[116:119], v[36:39], a[232:235], v[116:119]
    ds_read_b64_tr_b16 v[46:47], v15 offset:49664
    v_mfma_f32_16x16x32_bf16 v[108:111], v[36:39], a[108:111], v[108:111]
    buffer_load_dwordx4 v[164:167], v0, s[44:47], s13 offen offset:1024 sc1
    v_mfma_f32_16x16x32_bf16 v[100:103], v[36:39], a[104:107], v[100:103]
    s_waitcnt lgkmcnt(2)
    ds_read_b64_tr_b16 v[48:49], v14 offset:57344
    v_mfma_f32_16x16x32_bf16 v[64:67], v[40:43], a[112:115], v[64:67]
    ds_read_b64_tr_b16 v[50:51], v14 offset:57856
    v_mfma_f32_16x16x32_bf16 v[72:75], v[40:43], a[116:119], v[72:75]
    ds_read_b64_tr_b16 v[52:53], v15 offset:57344
    v_mfma_f32_16x16x32_bf16 v[80:83], v[40:43], a[240:243], v[80:83]
    buffer_load_dwordx4 v[168:171], v0, s[44:47], s13 offen offset:2048 sc1
    v_mfma_f32_16x16x32_bf16 v[88:91], v[40:43], a[244:247], v[88:91]
    s_waitcnt lgkmcnt(3)
    ds_read_b64_tr_b16 v[54:55], v15 offset:57856
    v_mfma_f32_16x16x32_bf16 v[92:95], v[44:47], a[244:247], v[92:95]
    ds_read_b64_tr_b16 v[32:33], v14 offset:53248
    v_mfma_f32_16x16x32_bf16 v[84:87], v[44:47], a[240:243], v[84:87]
    ds_read_b64_tr_b16 v[34:35], v14 offset:53760
    v_mfma_f32_16x16x32_bf16 v[76:79], v[44:47], a[116:119], v[76:79]
    buffer_load_dwordx4 v[172:175], v0, s[44:47], s13 offen offset:3072 sc1
    v_mfma_f32_16x16x32_bf16 v[68:71], v[44:47], a[112:115], v[68:71]
    s_waitcnt lgkmcnt(3)
    ds_read_b64_tr_b16 v[36:37], v15 offset:53248
    v_mfma_f32_16x16x32_bf16 v[96:99], v[48:51], a[112:115], v[96:99]
    s_add_u32 s13, s13, 4096
    ds_read_b64_tr_b16 v[38:39], v15 offset:53760
    v_mfma_f32_16x16x32_bf16 v[104:107], v[48:51], a[116:119], v[104:107]
    ds_read_b64_tr_b16 v[40:41], v14 offset:61440
    v_mfma_f32_16x16x32_bf16 v[112:115], v[48:51], a[240:243], v[112:115]
    buffer_load_dwordx4 v[176:179], v0, s[44:47], s13 offen offset:0 sc1
    v_mfma_f32_16x16x32_bf16 v[120:123], v[48:51], a[244:247], v[120:123]
    s_waitcnt lgkmcnt(3)
    ds_read_b64_tr_b16 v[42:43], v14 offset:61952
    v_mfma_f32_16x16x32_bf16 v[124:127], v[52:55], a[244:247], v[124:127]
    ds_read_b64_tr_b16 v[44:45], v15 offset:61440
    v_mfma_f32_16x16x32_bf16 v[116:119], v[52:55], a[240:243], v[116:119]
    ds_read_b64_tr_b16 v[46:47], v15 offset:61952
    v_mfma_f32_16x16x32_bf16 v[108:111], v[52:55], a[116:119], v[108:111]
    buffer_load_dwordx4 v[180:183], v0, s[44:47], s13 offen offset:1024 sc1
    v_mfma_f32_16x16x32_bf16 v[100:103], v[52:55], a[112:115], v[100:103]
    v_mfma_f32_16x16x32_bf16 v[64:67], v[32:35], a[120:123], v[64:67]
    v_mfma_f32_16x16x32_bf16 v[72:75], v[32:35], a[124:127], v[72:75]
    v_mfma_f32_16x16x32_bf16 v[80:83], v[32:35], a[248:251], v[80:83]
    buffer_load_dwordx4 v[184:187], v0, s[44:47], s13 offen offset:2048 sc1
    v_mfma_f32_16x16x32_bf16 v[88:91], v[32:35], a[252:255], v[88:91]
    s_waitcnt lgkmcnt(0)
    v_mfma_f32_16x16x32_bf16 v[92:95], v[36:39], a[252:255], v[92:95]
    v_mfma_f32_16x16x32_bf16 v[84:87], v[36:39], a[248:251], v[84:87]
    v_mfma_f32_16x16x32_bf16 v[76:79], v[36:39], a[124:127], v[76:79]
    buffer_load_dwordx4 v[188:191], v0, s[44:47], s13 offen offset:3072 sc1
    v_mfma_f32_16x16x32_bf16 v[68:71], v[36:39], a[120:123], v[68:71]
    v_mfma_f32_16x16x32_bf16 v[96:99], v[40:43], a[120:123], v[96:99]
    s_barrier
    buffer_load_dwordx2 v[240:241], v238, s[44:47], s14 offen offset:0 sc1
    v_mfma_f32_16x16x32_bf16 v[104:107], v[40:43], a[124:127], v[104:107]
    v_mfma_f32_16x16x32_bf16 v[112:115], v[40:43], a[248:251], v[112:115]
    buffer_load_dwordx2 v[242:243], v238, s[44:47], s14 offen offset:512 sc1
    v_mfma_f32_16x16x32_bf16 v[120:123], v[40:43], a[252:255], v[120:123]
    v_mfma_f32_16x16x32_bf16 v[124:127], v[44:47], a[252:255], v[124:127]
    buffer_load_dwordx2 v[244:245], v238, s[44:47], s14 offen offset:1024 sc1
    v_mfma_f32_16x16x32_bf16 v[116:119], v[44:47], a[248:251], v[116:119]
    v_mfma_f32_16x16x32_bf16 v[108:111], v[44:47], a[124:127], v[108:111]
    buffer_load_dwordx2 v[246:247], v238, s[44:47], s14 offen offset:1536 sc1
    v_mfma_f32_16x16x32_bf16 v[100:103], v[44:47], a[120:123], v[100:103]
    s_waitcnt vmcnt(18)
    v_cmp_eq_u64 vcc, s[6:7], v[8:9]
    s_nop 0
    s_cmp_eq_u64 vcc, -1
    s_cbranch_scc0 L_slow_vQ
L_back_vQ:
    s_bfe_u32 s20, s2, 5
    s_xor_b32 s20, s20, s26
    v_lshl_add_u32 v2, s20, 10, v0
    v_add_u32 v2, s18, v2
    v_xor_b32 v3, 1024, v2
    v_xor_b32 v4, 2048, v2
    v_xor_b32 v5, 3072, v2
    buffer_load_dwordx4 v[192:195], v2, s[44:47], s0 offen sc1
    v_max_f32 v64, 0, v64
    v_max_f32 v65, 0, v65
    v_mul_f32 v64, v64, v96
    v_mul_f32 v65, v65, v97
    v_cvt_pk_bf16_f32 v64, v64, v65
    v_max_f32 v66, 0, v66
    v_max_f32 v67, 0, v67
    v_mul_f32 v66, v66, v98
    v_mul_f32 v67, v67, v99
    buffer_load_dwordx4 v[196:199], v3, s[44:47], s0 offen sc1
    v_cvt_pk_bf16_f32 v65, v66, v67
    v_max_f32 v68, 0, v68
    v_max_f32 v69, 0, v69
    v_mul_f32 v68, v68, v100
    v_mul_f32 v69, v69, v101
    v_cvt_pk_bf16_f32 v66, v68, v69
    v_max_f32 v70, 0, v70
    v_max_f32 v71, 0, v71
    v_mul_f32 v70, v70, v102
    buffer_load_dwordx4 v[200:203], v4, s[44:47], s0 offen sc1
    v_mul_f32 v71, v71, v103
    v_cvt_pk_bf16_f32 v67, v70, v71
    s_waitcnt vmcnt(14)
    v_mfma_f32_16x16x32_bf16 v[32:35], v[58:61], v[160:163], 0
    v_mfma_f32_16x16x32_bf16 v[36:39], v[56:59], v[160:163], 0
    buffer_store_dwordx4 v[64:67], v0, s[44:47], s8 offen offset:0 sc1
    v_max_f32 v72, 0, v72
    v_max_f32 v73, 0, v73
    buffer_load_dwordx4 v[204:207], v5, s[44:47], s0 offen sc1
    v_mul_f32 v72, v72, v104
    v_mul_f32 v73, v73, v105
    s_waitcnt vmcnt(15)
    v_mfma_f32_16x16x32_bf16 v[32:35], v[58:61], v[164:167], v[32:35]
    v_mfma_f32_16x16x32_bf16 v[36:39], v[56:59], v[164:167], v[36:39]
    v_cvt_pk_bf16_f32 v72, v72, v73
    v_max_f32 v74, 0, v74
    v_max_f32 v75, 0, v75
    ds_read_b64_tr_b16 a[16:17], v28 offset:16384
    ds_read_b64_tr_b16 a[18:19], v28 offset:18432
    ds_read_b64_tr_b16 a[20:21], v29 offset:16384
    ds_read_b64_tr_b16 a[22:23], v29 offset:18432
    ds_read_b64_tr_b16 a[24:25], v30 offset:16384
    ds_read_b64_tr_b16 a[26:27], v30 offset:18432
    ds_read_b64_tr_b16 a[28:29], v31 offset:16384
    ds_read_b64_tr_b16 a[30:31], v31 offset:18432
    buffer_load_dwordx4 v[208:211], v2, s[44:47], s5 offen sc1
    v_mul_f32 v74, v74, v106
    v_mul_f32 v75, v75, v107
    s_waitcnt vmcnt(15)
    v_mfma_f32_16x16x32_bf16 v[32:35], v[58:61], v[168:171], v[32:35]
    v_mfma_f32_16x16x32_bf16 v[36:39], v[56:59], v[168:171], v[36:39]
    v_cvt_pk_bf16_f32 v73, v74, v75
    v_max_f32 v76, 0, v76
    v_max_f32 v77, 0, v77
    buffer_load_dwordx4 v[212:215], v3, s[44:47], s5 offen sc1
    v_mul_f32 v76, v76, v108
    v_mul_f32 v77, v77, v109
    s_waitcnt vmcnt(15)
    v_mfma_f32_16x16x32_bf16 v[32:35], v[58:61], v[172:175], v[32:35]
    v_mfma_f32_16x16x32_bf16 v[36:39], v[56:59], v[172:175], v[36:39]
    v_cvt_pk_bf16_f32 v74, v76, v77
    v_max_f32 v78, 0, v78
    v_max_f32 v79, 0, v79
    buffer_load_dwordx4 v[216:219], v4, s[44:47], s5 offen sc1
    v_mul_f32 v78, v78, v110
    v_mul_f32 v79, v79, v111
    s_waitcnt vmcnt(15)
    v_mfma_f32_16x16x32_bf16 v[32:35], v[58:61], v[176:179], v[32:35]
    v_mfma_f32_16x16x32_bf16 v[36:39], v[56:59], v[176:179], v[36:39]
    v_cvt_pk_bf16_f32 v75, v78, v79
    buffer_store_dwordx4 v[72:75], v0, s[44:47], s8 offen offset:1024 sc1
    v_max_f32 v80, 0, v80
    buffer_load_dwordx4 v[220:223], v5, s[44:47], s5 offen sc1
    v_max_f32 v81, 0, v81
    v_mul_f32 v80, v80, v112
    s_waitcnt vmcnt(16)
    v_mfma_f32_16x16x32_bf16 v[32:35], v[58:61], v[180:183], v[32:35]
    v_mfma_f32_16x16x32_bf16 v[36:39], v[56:59], v[180:183], v[36:39]
    v_mul_f32 v81, v81, v113
    v_cvt_pk_bf16_f32 v80, v80, v81
    v_max_f32 v82, 0, v82
    ds_read_b64_tr_b16 a[160:161], v28 offset:32768
    ds_read_b64_tr_b16 a[162:163], v28 offset:34816
    ds_read_b64_tr_b16 a[164:165], v29 offset:32768
    ds_read_b64_tr_b16 a[166:167], v29 offset:34816
    ds_read_b64_tr_b16 a[168:169], v30 offset:32768
    ds_read_b64_tr_b16 a[170:171], v30 offset:34816
    ds_read_b64_tr_b16 a[172:173], v31 offset:32768
    ds_read_b64_tr_b16 a[174:175], v31 offset:34816
    s_add_u32 m0, s97, 32768
    s_nop 0
    buffer_load_dwordx4 v10, s[48:51], s74 offen offset:0 sc1 lds
    v_max_f32 v83, 0, v83
    v_mul_f32 v82, v82, v114
    s_waitcnt vmcnt(16)
    v_mfma_f32_16x16x32_bf16 v[32:35], v[58:61], v[184:187], v[32:35]
    v_mfma_f32_16x16x32_bf16 v[36:39], v[56:59], v[184:187], v[36:39]
    v_mul_f32 v83, v83, v115
    v_cvt_pk_bf16_f32 v81, v82, v83
    v_max_f32 v84, 0, v84
    buffer_load_dwordx4 v11, s[48:51], s74 offen offset:1024 sc1 lds
    v_max_f32 v85, 0, v85
    v_mul_f32 v84, v84, v116
    s_waitcnt vmcnt(16)
    v_mfma_f32_16x16x32_bf16 v[32:35], v[58:61], v[188:191], v[32:35]
    v_mfma_f32_16x16x32_bf16 v[36:39], v[56:59], v[188:191], v[36:39]
    v_mul_f32 v85, v85, v117
    v_cvt_pk_bf16_f32 v82, v84, v85
    v_max_f32 v86, 0, v86
    buffer_load_dwordx4 v12, s[48:51], s74 offen offset:2048 sc1 lds
    v_max_f32 v87, 0, v87
    v_mul_f32 v86, v86, v118
    v_mov_b32 v49, 0
    v_mov_b32 v50, 0
    v_mov_b32 v51, 0
    v_mov_b32 v52, 0
    s_waitcnt vmcnt(15)
    v_add_f32 v240, v240, v242
    s_waitcnt vmcnt(13)
    v_add_f32 v244, v244, v246
    v_add_f32 v241, v241, v243
    buffer_load_dwordx4 v13, s[48:51], s74 offen offset:3072 sc1 lds
    v_add_f32 v245, v245, v247
    v_add_f32 v240, v240, v244
    v_add_f32 v241, v241, v245
    v_cvt_pk_bf16_f32 v242, v240, v241
    v_lshlrev_b32 v243, 16, v242
    v_and_b32 v244, 0xffff0000, v242
    v_sub_f32 v243, v240, v243
    v_sub_f32 v244, v241, v244
    v_cvt_pk_bf16_f32 v48, v240, v243
    ds_read_b64_tr_b16 a[32:33], v24 offset:0
    ds_read_b64_tr_b16 a[34:35], v24 offset:2048
    ds_read_b64_tr_b16 a[36:37], v25 offset:0
    ds_read_b64_tr_b16 a[38:39], v25 offset:2048
    ds_read_b64_tr_b16 a[40:41], v26 offset:0
    ds_read_b64_tr_b16 a[42:43], v26 offset:2048
    ds_read_b64_tr_b16 a[44:45], v27 offset:0
    ds_read_b64_tr_b16 a[46:47], v27 offset:2048
    s_add_u32 m0, s97, 49152
    s_nop 0
    buffer_load_dwordx4 v10, s[48:51], s75 offen offset:0 sc1 lds
    v_cvt_pk_bf16_f32 v53, v241, v244
    ds_write_b128 v236, v[32:35]
    ds_write_b128 v236, v[36:39] offset:1024
    v_mfma_f32_16x16x32_bf16 v[40:43], v[48:51], v[252:255], 0
    v_mfma_f32_16x16x32_bf16 v[44:47], v[50:53], v[252:255], 0
    v_mul_f32 v87, v87, v119
    v_cvt_pk_bf16_f32 v83, v86, v87
    buffer_load_dwordx4 v11, s[48:51], s75 offen offset:1024 sc1 lds
    buffer_store_dwordx4 v[80:83], v0, s[44:47], s9 offen offset:0 sc1
    v_max_f32 v88, 0, v88
    v_max_f32 v89, 0, v89
    v_mul_f32 v88, v88, v120
    v_mul_f32 v89, v89, v121
    v_cvt_pk_bf16_f32 v88, v88, v89
    v_max_f32 v90, 0, v90
    v_max_f32 v91, 0, v91
    v_mul_f32 v90, v90, v122
    buffer_load_dwordx4 v12, s[48:51], s75 offen offset:2048 sc1 lds
    v_mul_f32 v91, v91, v123
    v_cvt_pk_bf16_f32 v89, v90, v91
    v_max_f32 v92, 0, v92
    v_max_f32 v93, 0, v93
    v_mul_f32 v92, v92, v124
    v_mul_f32 v93, v93, v125
    v_cvt_pk_bf16_f32 v90, v92, v93
    v_max_f32 v94, 0, v94
    v_max_f32 v95, 0, v95
    buffer_load_dwordx4 v13, s[48:51], s75 offen offset:3072 sc1 lds
    v_mul_f32 v94, v94, v126
    v_mul_f32 v95, v95, v127
    v_cvt_pk_bf16_f32 v91, v94, v95
    buffer_store_dwordx4 v[88:91], v0, s[44:47], s9 offen offset:1024 sc1
    s_waitcnt lgkmcnt(0)
    s_barrier
    ds_read_b128 v[240:243], v237
    ds_read_b128 v[244:247], v237 offset:1024
    v_cvt_pk_bf16_f32 v230, v40, v41
    v_cvt_pk_bf16_f32 v231, v42, v43
    v_cvt_pk_bf16_f32 v234, v44, v45
    ds_read_b64_tr_b16 a[176:177], v24 offset:16384
    ds_read_b64_tr_b16 a[178:179], v24 offset:18432
    ds_read_b64_tr_b16 a[180:181], v25 offset:16384
    ds_read_b64_tr_b16 a[182:183], v25 offset:18432
    ds_read_b64_tr_b16 a[184:185], v26 offset:16384
    ds_read_b64_tr_b16 a[186:187], v26 offset:18432
    ds_read_b64_tr_b16 a[188:189], v27 offset:16384
    ds_read_b64_tr_b16 a[190:191], v27 offset:18432
    s_add_u32 m0, s97, 81920
    s_lshl_b32 s23, s12, 3
    buffer_load_dwordx4 v10, s[52:55], s23 offen offset:0 sc1 lds
    v_cvt_pk_bf16_f32 v235, v46, v47
    s_waitcnt lgkmcnt(9)
    v_add_f32 v32, v32, v240
    v_add_f32 v33, v33, v241
    v_add_f32 v34, v34, v242
    v_add_f32 v35, v35, v243
    s_waitcnt lgkmcnt(8)
    v_add_f32 v36, v36, v244
    v_add_f32 v37, v37, v245
    v_add_f32 v38, v38, v246
    v_add_f32 v39, v39, v247
    buffer_load_dwordx4 v11, s[52:55], s23 offen offset:1024 sc1 lds
    v_cvt_pk_bf16_f32 v224, v32, v33
    v_cvt_pk_bf16_f32 v225, v34, v35
    v_cvt_pk_bf16_f32 v228, v36, v37
    v_cvt_pk_bf16_f32 v229, v38, v39
    s_add_u32 s8, s8, 24576
    s_add_u32 s9, s9, 24576
    v_mfma_f32_16x16x32_bf16 v[168:171], v[230:233], v[128:131], 0
    v_mfma_f32_16x16x32_bf16 v[172:175], v[232:235], v[128:131], 0
    v_mfma_f32_16x16x32_bf16 v[160:163], v[224:227], v[128:131], 0
    v_mfma_f32_16x16x32_bf16 v[164:167], v[226:229], v[128:131], 0
    v_mfma_f32_16x16x32_bf16 v[184:187], v[230:233], v[136:139], 0
    v_mfma_f32_16x16x32_bf16 v[188:191], v[232:235], v[136:139], 0
    v_mfma_f32_16x16x32_bf16 v[176:179], v[224:227], v[136:139], 0
    v_mfma_f32_16x16x32_bf16 v[180:183], v[226:229], v[136:139], 0
    buffer_load_dwordx4 v12, s[52:55], s23 offen offset:2048 sc1 lds
    v_add_f32 v168, 0x358637bd, v168
    v_add_f32 v172, 0x358637bd, v172
    v_rcp_f32 v168, v168
    v_rcp_f32 v172, v172
    v_mul_f32 v160, v160, v168
    v_mul_f32 v161, v161, v168
    v_mul_f32 v162, v162, v168
    buffer_load_dwordx4 v13, s[52:55], s23 offen offset:3072 sc1 lds
    v_mul_f32 v163, v163, v168
    v_mul_f32 v164, v164, v172
    v_mul_f32 v165, v165, v172
    v_mul_f32 v166, v166, v172
    v_mul_f32 v167, v167, v172
    v_cvt_pk_bf16_f32 v132, v160, v161
    v_cvt_pk_bf16_f32 v133, v162, v163
    v_cvt_pk_bf16_f32 v134, v164, v165
    v_cvt_pk_bf16_f32 v135, v166, v167
    v_mfma_f32_16x16x32_bf16 v[168:171], v[230:233], v[144:147], 0
    v_mfma_f32_16x16x32_bf16 v[172:175], v[232:235], v[144:147], 0
    v_mfma_f32_16x16x32_bf16 v[160:163], v[224:227], v[144:147], 0
    v_mfma_f32_16x16x32_bf16 v[164:167], v[226:229], v[144:147], 0
    s_add_u32 m0, s97, 98304
    s_lshl_b32 s23, s16, 3
    buffer_load_dwordx4 v10, s[52:55], s23 offen offset:0 sc1 lds
    buffer_store_dwordx4 v[132:135], v0, s[44:47], s8 offen offset:0 sc1
    v_add_f32 v184, 0x358637bd, v184
    v_add_f32 v188, 0x358637bd, v188
    v_rcp_f32 v184, v184
    v_rcp_f32 v188, v188
    v_mul_f32 v176, v176, v184
    v_mul_f32 v177, v177, v184
    buffer_load_dwordx4 v11, s[52:55], s23 offen offset:1024 sc1 lds
    v_mul_f32 v178, v178, v184
    v_mul_f32 v179, v179, v184
    v_mul_f32 v180, v180, v188
    v_mul_f32 v181, v181, v188
    v_mul_f32 v182, v182, v188
    v_mul_f32 v183, v183, v188
    v_cvt_pk_bf16_f32 v140, v176, v177
    v_cvt_pk_bf16_f32 v141, v178, v179
    v_cvt_pk_bf16_f32 v142, v180, v181
    buffer_load_dwordx4 v12, s[52:55], s23 offen offset:2048 sc1 lds
    v_cvt_pk_bf16_f32 v143, v182, v183
    v_mfma_f32_16x16x32_bf16 v[184:187], v[230:233], v[152:155], 0
    v_mfma_f32_16x16x32_bf16 v[188:191], v[232:235], v[152:155], 0
    v_mfma_f32_16x16x32_bf16 v[176:179], v[224:227], v[152:155], 0
    v_mfma_f32_16x16x32_bf16 v[180:183], v[226:229], v[152:155], 0
    buffer_load_dwordx4 v13, s[52:55], s23 offen offset:3072 sc1 lds
    buffer_store_dwordx4 v[140:143], v0, s[44:47], s8 offen offset:1024 sc1
    v_add_f32 v168, 0x358637bd, v168
    v_add_f32 v172, 0x358637bd, v172
    v_rcp_f32 v168, v168
    v_rcp_f32 v172, v172
    v_mul_f32 v160, v160, v168
    v_mul_f32 v161, v161, v168
    v_mul_f32 v162, v162, v168
    v_mul_f32 v163, v163, v168
    v_mul_f32 v164, v164, v172
    v_mul_f32 v165, v165, v172
    v_mul_f32 v166, v166, v172
    v_mul_f32 v167, v167, v172
    v_cvt_pk_bf16_f32 v148, v160, v161
    v_cvt_pk_bf16_f32 v149, v162, v163
    v_cvt_pk_bf16_f32 v150, v164, v165
    v_cvt_pk_bf16_f32 v151, v166, v167
    buffer_store_dwordx4 v[148:151], v0, s[44:47], s9 offen offset:0 sc1
    v_add_f32 v184, 0x358637bd, v184
    v_add_f32 v188, 0x358637bd, v188
    v_rcp_f32 v184, v184
    v_rcp_f32 v188, v188
    v_mul_f32 v176, v176, v184
    v_mul_f32 v177, v177, v184
    v_mul_f32 v178, v178, v184
    v_mul_f32 v179, v179, v184
    v_mul_f32 v180, v180, v188
    v_mul_f32 v181, v181, v188
    v_mul_f32 v182, v182, v188
    v_mul_f32 v183, v183, v188
    v_cvt_pk_bf16_f32 v156, v176, v177
    v_cvt_pk_bf16_f32 v157, v178, v179
    v_cvt_pk_bf16_f32 v158, v180, v181
    v_cvt_pk_bf16_f32 v159, v182, v183
    buffer_store_dwordx4 v[156:159], v0, s[44:47], s9 offen offset:1024 sc1
    buffer_load_dwordx4 v[224:227], v2, s[44:47], s12 offen sc1
    v_lshlrev_b32 v14, 3, v0
    v_and_b32 v14, 0x380, v14
    v_bfe_u32 v57, v0, 6, 1
    v_lshl_add_u32 v57, v57, 13, v6
    s_andn2_b32 s19, s4, 0x2000
    v_add_u32 v40, 0x20000, v24
    v_add_u32 v41, 0x20000, v25
    v_add_u32 v42, 0x20000, v26
    v_add_u32 v43, 0x20000, v27
    v_lshrrev_b32 v7, 2, v0
    s_waitcnt vmcnt(32)
    v_mfma_f32_16x16x32_bf16 v[64:67], a[128:131], v[192:195], 0
    v_and_b32 v7, 0x3c, v7
    v_lshl_add_u32 v7, s20, 6, v7
    v_mfma_f32_16x16x32_bf16 v[68:71], a[132:135], v[192:195], 0
    buffer_load_dwordx4 v[228:231], v3, s[44:47], s12 offen sc1
    v_mfma_f32_16x16x32_bf16 v[72:75], a[136:139], v[192:195], 0
    v_xor_b32 v15, 64, v7
    s_lshl_b32 s98, s17, 8
    v_mfma_f32_16x16x32_bf16 v[76:79], a[140:143], v[192:195], 0
    s_waitcnt vmcnt(32)
    s_mul_i32 s9, s100, -294912
    s_add_u32 s9, s9, 147456
    v_mfma_f32_16x16x32_bf16 v[92:95], a[140:143], v[196:199], 0
    v_xor_b32 v32, 0x2000, v24
    v_xor_b32 v33, 0x2000, v25
    v_mfma_f32_16x16x32_bf16 v[88:91], a[136:139], v[196:199], 0
    buffer_load_dwordx4 v[232:235], v4, s[44:47], s12 offen sc1
    v_mfma_f32_16x16x32_bf16 v[84:87], a[132:135], v[196:199], 0
    v_xor_b32 v34, 0x2000, v26
    v_xor_b32 v35, 0x2000, v27
    v_mfma_f32_16x16x32_bf16 v[80:83], a[128:131], v[196:199], 0
    s_waitcnt vmcnt(32)
    v_xor_b32 v36, 0x2000, v28
    v_xor_b32 v37, 0x2000, v29
    v_mfma_f32_16x16x32_bf16 v[96:99], a[128:131], v[200:203], 0
    v_xor_b32 v38, 0x2000, v30
    v_xor_b32 v39, 0x2000, v31
    v_mfma_f32_16x16x32_bf16 v[100:103], a[132:135], v[200:203], 0
    buffer_load_dwordx4 v[236:239], v5, s[44:47], s12 offen sc1
    v_mfma_f32_16x16x32_bf16 v[104:107], a[136:139], v[200:203], 0
    v_lshrrev_b32 v48, 0, v0
    v_add_u32 v48, s97, v48
    v_mfma_f32_16x16x32_bf16 v[108:111], a[140:143], v[200:203], 0
    s_waitcnt vmcnt(31)
    v_xor_b32 v49, 0x1000, v48
    v_xor_b32 v50, 0x2000, v48
    v_mfma_f32_16x16x32_bf16 v[124:127], a[140:143], v[204:207], 0
    v_xor_b32 v51, 0x3000, v48
    s_lshl2_add_u32 s24, s17, s20
    v_mfma_f32_16x16x32_bf16 v[120:123], a[136:139], v[204:207], 0
    s_waitcnt vmcnt(16)
    buffer_store_dwordx2 v[20:21], v1, s[44:47], s10 offen offset:2048 sc1
    buffer_load_dwordx4 v[240:243], v2, s[44:47], s16 offen sc1
    v_mfma_f32_16x16x32_bf16 v[116:119], a[132:135], v[204:207], 0
    s_lshl_b32 s24, s24, 14
    s_bfe_u32 s25, s2, 0x30003
    s_lshl_b32 s25, s25, 7
    v_mfma_f32_16x16x32_bf16 v[112:115], a[128:131], v[204:207], 0
    s_add_u32 s24, s24, s25
    s_add_u32 s25, s97, 147456
    v_bfe_u32 v54, v0, 4, 4
    v_mfma_f32_16x16x32_bf16 v[64:67], a[16:19], v[208:211], v[64:67]
    v_lshrrev_b32 v55, 5, v0
    v_and_b32 v55, 24, v55
    v_mfma_f32_16x16x32_bf16 v[68:71], a[20:23], v[208:211], v[68:71]
    buffer_load_dwordx4 v[244:247], v3, s[44:47], s16 offen sc1
    v_mfma_f32_16x16x32_bf16 v[72:75], a[24:27], v[208:211], v[72:75]
    v_and_b32 v56, 0x70, v0
    v_xor_b32 v55, v55, v56
    v_mfma_f32_16x16x32_bf16 v[76:79], a[28:31], v[208:211], v[76:79]
    v_lshl_add_u32 v55, v54, 7, v55
    v_add_u32 v58, s25, v55
    v_mfma_f32_16x16x32_bf16 v[92:95], a[28:31], v[212:215], v[92:95]
    v_xor_b32 v59, 32, v58
    v_xor_b32 v60, 64, v58
    v_mfma_f32_16x16x32_bf16 v[88:91], a[24:27], v[212:215], v[88:91]
    buffer_load_dwordx4 v[248:251], v4, s[44:47], s16 offen sc1
    v_mfma_f32_16x16x32_bf16 v[84:87], a[20:23], v[212:215], v[84:87]
    v_xor_b32 v61, 96, v58
    v_lshrrev_b32 v54, 7, v0
    v_mfma_f32_16x16x32_bf16 v[80:83], a[16:19], v[212:215], v[80:83]
    v_lshl_add_u32 v52, v54, 10, v56
    v_lshlrev_b32 v54, 4, v54
    v_mfma_f32_16x16x32_bf16 v[96:99], a[16:19], v[216:219], v[96:99]
    v_xad_u32 v53, v54, v0, s25
    s_add_u32 s25, s24, 8192
    v_mfma_f32_16x16x32_bf16 v[100:103], a[20:23], v[216:219], v[100:103]
    buffer_load_dwordx4 v[252:255], v5, s[44:47], s16 offen sc1
    v_mfma_f32_16x16x32_bf16 v[104:107], a[24:27], v[216:219], v[104:107]
    ds_read_b64_tr_b16 a[64:65], v28 offset:49152
    v_mfma_f32_16x16x32_bf16 v[108:111], a[28:31], v[216:219], v[108:111]
    ds_read_b64_tr_b16 a[66:67], v28 offset:51200
    v_mfma_f32_16x16x32_bf16 v[124:127], a[28:31], v[220:223], v[124:127]
    v_mfma_f32_16x16x32_bf16 v[120:123], a[24:27], v[220:223], v[120:123]
    s_waitcnt lgkmcnt(0)
    s_buffer_load_dword s84, s[44:47], s4 offset:1024 glc
    s_buffer_load_dword s85, s[44:47], s4 offset:1156 glc
    s_buffer_load_dword s86, s[44:47], s4 offset:1280 glc
    s_buffer_load_dword s87, s[44:47], s4 offset:1412 glc
    s_add_u32 m0, s97, 0
    s_nop 0
    buffer_load_dwordx4 v10, s[48:51], s78 offen offset:0 sc1 lds
    v_mfma_f32_16x16x32_bf16 v[116:119], a[20:23], v[220:223], v[116:119]
    v_mfma_f32_16x16x32_bf16 v[112:115], a[16:19], v[220:223], v[112:115]
    s_waitcnt vmcnt(9)
    v_mfma_f32_16x16x32_bf16 v[64:67], a[160:163], v[224:227], v[64:67]
    ds_read_b64_tr_b16 a[48:49], v24 offset:32768
    v_mfma_f32_16x16x32_bf16 v[68:71], a[164:167], v[224:227], v[68:71]
    buffer_load_dwordx4 v11, s[48:51], s78 offen offset:1024 sc1 lds
    v_mfma_f32_16x16x32_bf16 v[72:75], a[168:171], v[224:227], v[72:75]
    ds_read_b64_tr_b16 a[50:51], v24 offset:34816
    v_mfma_f32_16x16x32_bf16 v[76:79], a[172:175], v[224:227], v[76:79]
    s_waitcnt vmcnt(9)
    ds_read_b64_tr_b16 a[52:53], v25 offset:32768
    v_mfma_f32_16x16x32_bf16 v[92:95], a[172:175], v[228:231], v[92:95]
    ds_read_b64_tr_b16 a[54:55], v25 offset:34816
    v_mfma_f32_16x16x32_bf16 v[88:91], a[168:171], v[228:231], v[88:91]
    buffer_load_dwordx4 v12, s[48:51], s78 offen offset:2048 sc1 lds
    v_mfma_f32_16x16x32_bf16 v[84:87], a[164:167], v[228:231], v[84:87]
    ds_read_b64_tr_b16 a[56:57], v26 offset:32768
    v_mfma_f32_16x16x32_bf16 v[80:83], a[160:163], v[228:231], v[80:83]
    s_waitcnt vmcnt(9)
    ds_read_b64_tr_b16 a[58:59], v26 offset:34816
    v_mfma_f32_16x16x32_bf16 v[96:99], a[160:163], v[232:235], v[96:99]
    ds_read_b64_tr_b16 a[60:61], v27 offset:32768
    v_mfma_f32_16x16x32_bf16 v[100:103], a[164:167], v[232:235], v[100:103]
    buffer_load_dwordx4 v13, s[48:51], s78 offen offset:3072 sc1 lds
    v_mfma_f32_16x16x32_bf16 v[104:107], a[168:171], v[232:235], v[104:107]
    ds_read_b64_tr_b16 a[62:63], v27 offset:34816
    v_mfma_f32_16x16x32_bf16 v[108:111], a[172:175], v[232:235], v[108:111]
    s_waitcnt vmcnt(9)
    ds_read_b64_tr_b16 a[68:69], v29 offset:49152
    v_mfma_f32_16x16x32_bf16 v[124:127], a[172:175], v[236:239], v[124:127]
    ds_read_b64_tr_b16 a[70:71], v29 offset:51200
    v_mfma_f32_16x16x32_bf16 v[120:123], a[168:171], v[236:239], v[120:123]
    s_add_u32 m0, s97, 16384
    s_nop 0
    buffer_load_dwordx4 v10, s[48:51], s79 offen offset:0 sc1 lds
    v_mfma_f32_16x16x32_bf16 v[116:119], a[164:167], v[236:239], v[116:119]
    v_mfma_f32_16x16x32_bf16 v[112:115], a[160:163], v[236:239], v[112:115]
    s_waitcnt vmcnt(8)
    v_mfma_f32_16x16x32_bf16 v[64:67], a[32:35], v[240:243], v[64:67]
    v_mfma_f32_16x16x32_bf16 v[68:71], a[36:39], v[240:243], v[68:71]
    buffer_load_dwordx4 v11, s[48:51], s79 offen offset:1024 sc1 lds
    v_mfma_f32_16x16x32_bf16 v[72:75], a[40:43], v[240:243], v[72:75]
    v_mfma_f32_16x16x32_bf16 v[76:79], a[44:47], v[240:243], v[76:79]
L_padQ3:
    s_cbranch_execz L_retQ
    s_waitcnt vmcnt(8)
    v_mfma_f32_16x16x32_bf16 v[92:95], a[44:47], v[244:247], v[92:95]
    v_mfma_f32_16x16x32_bf16 v[88:91], a[40:43], v[244:247], v[88:91]
    buffer_load_dwordx4 v12, s[48:51], s79 offen offset:2048 sc1 lds
    v_mfma_f32_16x16x32_bf16 v[84:87], a[36:39], v[244:247], v[84:87]
    v_mfma_f32_16x16x32_bf16 v[80:83], a[32:35], v[244:247], v[80:83]
    s_waitcnt vmcnt(8)
    v_mfma_f32_16x16x32_bf16 v[96:99], a[32:35], v[248:251], v[96:99]
    v_mfma_f32_16x16x32_bf16 v[100:103], a[36:39], v[248:251], v[100:103]
    buffer_load_dwordx4 v13, s[48:51], s79 offen offset:3072 sc1 lds
    v_mfma_f32_16x16x32_bf16 v[104:107], a[40:43], v[248:251], v[104:107]
    v_mfma_f32_16x16x32_bf16 v[108:111], a[44:47], v[248:251], v[108:111]
    s_waitcnt vmcnt(8)
    v_mfma_f32_16x16x32_bf16 v[124:127], a[44:47], v[252:255], v[124:127]
    v_mfma_f32_16x16x32_bf16 v[120:123], a[40:43], v[252:255], v[120:123]
    s_waitcnt lgkmcnt(0)
    s_cmp_eq_u64 s[84:85], s[6:7]
    s_cbranch_scc0 L_slow_eQ
    s_cmp_eq_u64 s[86:87], s[6:7]
    s_cbranch_scc0 L_slow_eQ
L_back_eQ:
    s_add_u32 s99, s0, 16384
    buffer_load_dwordx4 v[192:195], v2, s[44:47], s99 offen sc1
    v_mfma_f32_16x16x32_bf16 v[116:119], a[36:39], v[252:255], v[116:119]
    v_mfma_f32_16x16x32_bf16 v[112:115], a[32:35], v[252:255], v[112:115]
    buffer_load_dwordx4 v[196:199], v3, s[44:47], s99 offen sc1
    ds_read_b64_tr_b16 a[192:193], v24 offset:49152
    ds_read_b64_tr_b16 a[194:195], v24 offset:51200
    ds_read_b64_tr_b16 a[196:197], v25 offset:49152
    ds_read_b64_tr_b16 a[198:199], v25 offset:51200
    buffer_load_dwordx4 v[200:203], v4, s[44:47], s99 offen sc1
    ds_read_b64_tr_b16 a[200:201], v26 offset:49152
    ds_read_b64_tr_b16 a[202:203], v26 offset:51200
    ds_read_b64_tr_b16 a[204:205], v27 offset:49152
    ds_read_b64_tr_b16 a[206:207], v27 offset:51200
    buffer_load_dwordx4 v[204:207], v5, s[44:47], s99 offen sc1
    ds_read_b64_tr_b16 a[72:73], v30 offset:49152
    ds_read_b64_tr_b16 a[74:75], v30 offset:51200
    ds_read_b64_tr_b16 a[76:77], v31 offset:49152
    ds_read_b64_tr_b16 a[78:79], v31 offset:51200
    buffer_store_dwordx2 v[20:21], v1, s[44:47], s10 offen offset:3072 sc1
    s_add_u32 m0, s97, 32768
    s_nop 0
    buffer_load_dwordx4 v10, s[48:51], s81 offen offset:0 sc1 lds
    s_waitcnt vmcnt(10)
    ds_read_b64_tr_b16 a[208:209], v24 offset:0
    ds_read_b64_tr_b16 a[210:211], v24 offset:2048
    ds_read_b64_tr_b16 a[212:213], v25 offset:0
    ds_read_b64_tr_b16 a[214:215], v25 offset:2048
    buffer_load_dwordx4 v11, s[48:51], s81 offen offset:1024 sc1 lds
    ds_read_b64_tr_b16 a[216:217], v26 offset:0
    ds_read_b64_tr_b16 a[218:219], v26 offset:2048
    ds_read_b64_tr_b16 a[220:221], v27 offset:0
    ds_read_b64_tr_b16 a[222:223], v27 offset:2048
    buffer_load_dwordx4 v12, s[48:51], s81 offen offset:2048 sc1 lds
    buffer_load_dwordx4 v13, s[48:51], s81 offen offset:3072 sc1 lds
    s_waitcnt vmcnt(9)
    ds_read_b64_tr_b16 a[80:81], v24 offset:16384
    ds_read_b64_tr_b16 a[82:83], v24 offset:18432
    ds_read_b64_tr_b16 a[84:85], v25 offset:16384
    ds_read_b64_tr_b16 a[86:87], v25 offset:18432
    s_add_u32 s99, s5, 16384
    buffer_load_dwordx4 v[208:211], v2, s[44:47], s99 offen sc1
    ds_read_b64_tr_b16 a[88:89], v26 offset:16384
    ds_read_b64_tr_b16 a[90:91], v26 offset:18432
    ds_read_b64_tr_b16 a[92:93], v27 offset:16384
    ds_read_b64_tr_b16 a[94:95], v27 offset:18432
    s_waitcnt vmcnt(9)
    v_mfma_f32_16x16x32_bf16 v[64:67], a[0:3], v[192:195], v[64:67]
    ds_read_b64_tr_b16 a[224:225], v40 offset:0
    v_mfma_f32_16x16x32_bf16 v[68:71], a[4:7], v[192:195], v[68:71]
    buffer_load_dwordx4 v[212:215], v3, s[44:47], s99 offen sc1
    v_mfma_f32_16x16x32_bf16 v[72:75], a[8:11], v[192:195], v[72:75]
    ds_read_b64_tr_b16 a[226:227], v40 offset:2048
    v_mfma_f32_16x16x32_bf16 v[76:79], a[12:15], v[192:195], v[76:79]
    s_waitcnt vmcnt(9)
    ds_read_b64_tr_b16 a[228:229], v41 offset:0
    v_mfma_f32_16x16x32_bf16 v[92:95], a[12:15], v[196:199], v[92:95]
    ds_read_b64_tr_b16 a[230:231], v41 offset:2048
    v_mfma_f32_16x16x32_bf16 v[88:91], a[8:11], v[196:199], v[88:91]
    buffer_load_dwordx4 v[216:219], v4, s[44:47], s99 offen sc1
    v_mfma_f32_16x16x32_bf16 v[84:87], a[4:7], v[196:199], v[84:87]
    ds_read_b64_tr_b16 a[232:233], v42 offset:0
    v_mfma_f32_16x16x32_bf16 v[80:83], a[0:3], v[196:199], v[80:83]
    s_waitcnt vmcnt(9)
    ds_read_b64_tr_b16 a[234:235], v42 offset:2048
    v_mfma_f32_16x16x32_bf16 v[96:99], a[0:3], v[200:203], v[96:99]
    ds_read_b64_tr_b16 a[236:237], v43 offset:0
    v_mfma_f32_16x16x32_bf16 v[100:103], a[4:7], v[200:203], v[100:103]
    buffer_load_dwordx4 v[220:223], v5, s[44:47], s99 offen sc1
    v_mfma_f32_16x16x32_bf16 v[104:107], a[8:11], v[200:203], v[104:107]
    ds_read_b64_tr_b16 a[238:239], v43 offset:2048
    v_mfma_f32_16x16x32_bf16 v[108:111], a[12:15], v[200:203], v[108:111]
    s_waitcnt vmcnt(9)
    v_mfma_f32_16x16x32_bf16 v[124:127], a[12:15], v[204:207], v[124:127]
    s_add_u32 m0, s97, 49152
    s_lshl_b32 s23, s5, 3
    v_mfma_f32_16x16x32_bf16 v[120:123], a[8:11], v[204:207], v[120:123]
    s_waitcnt lgkmcnt(14)
    buffer_load_dwordx4 v10, s[52:55], s23 offen offset:0 sc1 lds
    v_mfma_f32_16x16x32_bf16 v[116:119], a[4:7], v[204:207], v[116:119]
    v_mfma_f32_16x16x32_bf16 v[112:115], a[0:3], v[204:207], v[112:115]
    buffer_load_dwordx4 v11, s[52:55], s23 offen offset:1024 sc1 lds
    buffer_load_dwordx4 v12, s[52:55], s23 offen offset:2048 sc1 lds
    buffer_load_dwordx4 v13, s[52:55], s23 offen offset:3072 sc1 lds
    s_waitcnt vmcnt(8)
    ds_read_b64_tr_b16 a[96:97], v24 offset:32768
    ds_read_b64_tr_b16 a[98:99], v24 offset:34816
    ds_read_b64_tr_b16 a[100:101], v25 offset:32768
    ds_read_b64_tr_b16 a[102:103], v25 offset:34816
    s_waitcnt lgkmcnt(0)
    s_buffer_load_dword s84, s[44:47], s4 offset:2048 glc
    s_buffer_load_dword s85, s[44:47], s4 offset:2180 glc
    s_buffer_load_dword s86, s[44:47], s4 offset:2304 glc
    s_buffer_load_dword s87, s[44:47], s4 offset:2436 glc
    s_buffer_load_dword s88, s[44:47], s4 offset:2560 glc
    s_buffer_load_dword s89, s[44:47], s4 offset:2692 glc
    s_buffer_load_dword s90, s[44:47], s4 offset:2816 glc
    s_buffer_load_dword s91, s[44:47], s4 offset:2948 glc
    s_add_u32 s99, s12, 16384
    buffer_load_dwordx4 v[224:227], v2, s[44:47], s99 offen sc1
    s_waitcnt vmcnt(8)
    v_mfma_f32_16x16x32_bf16 v[64:67], a[176:179], v[208:211], v[64:67]
    ds_read_b64_tr_b16 a[104:105], v26 offset:32768
    v_mfma_f32_16x16x32_bf16 v[68:71], a[180:183], v[208:211], v[68:71]
    buffer_load_dwordx4 v[228:231], v3, s[44:47], s99 offen sc1
    v_mfma_f32_16x16x32_bf16 v[72:75], a[184:187], v[208:211], v[72:75]
    ds_read_b64_tr_b16 a[106:107], v26 offset:34816
    v_mfma_f32_16x16x32_bf16 v[76:79], a[188:191], v[208:211], v[76:79]
    s_waitcnt vmcnt(8)
    ds_read_b64_tr_b16 a[108:109], v27 offset:32768
    v_mfma_f32_16x16x32_bf16 v[92:95], a[188:191], v[212:215], v[92:95]
    ds_read_b64_tr_b16 a[110:111], v27 offset:34816
    v_mfma_f32_16x16x32_bf16 v[88:91], a[184:187], v[212:215], v[88:91]
    buffer_load_dwordx4 v[232:235], v4, s[44:47], s99 offen sc1
    v_mfma_f32_16x16x32_bf16 v[84:87], a[180:183], v[212:215], v[84:87]
    ds_read_b64_tr_b16 a[240:241], v28 offset:0
    v_mfma_f32_16x16x32_bf16 v[80:83], a[176:179], v[212:215], v[80:83]
    s_waitcnt vmcnt(8)
    ds_read_b64_tr_b16 a[242:243], v28 offset:2048
    v_mfma_f32_16x16x32_bf16 v[96:99], a[176:179], v[216:219], v[96:99]
    v_mfma_f32_16x16x32_bf16 v[100:103], a[180:183], v[216:219], v[100:103]
    buffer_load_dwordx4 v[236:239], v5, s[44:47], s99 offen sc1
    v_mfma_f32_16x16x32_bf16 v[104:107], a[184:187], v[216:219], v[104:107]
    v_mfma_f32_16x16x32_bf16 v[108:111], a[188:191], v[216:219], v[108:111]
    s_waitcnt vmcnt(8)
    v_mfma_f32_16x16x32_bf16 v[124:127], a[188:191], v[220:223], v[124:127]
    s_add_u32 s99, s16, 16384
    v_mfma_f32_16x16x32_bf16 v[120:123], a[184:187], v[220:223], v[120:123]
    buffer_load_dwordx4 v[240:243], v2, s[44:47], s99 offen sc1
    v_mfma_f32_16x16x32_bf16 v[116:119], a[180:183], v[220:223], v[116:119]
    v_mfma_f32_16x16x32_bf16 v[112:115], a[176:179], v[220:223], v[112:115]
    buffer_load_dwordx4 v[244:247], v3, s[44:47], s99 offen sc1
    buffer_load_dwordx4 v[248:251], v4, s[44:47], s99 offen sc1
    buffer_load_dwordx4 v[252:255], v5, s[44:47], s99 offen sc1
    s_waitcnt lgkmcnt(0)
    s_cmp_eq_u64 s[84:85], s[6:7]
    s_cbranch_scc0 L_slow_lQ
    s_cmp_eq_u64 s[86:87], s[6:7]
    s_cbranch_scc0 L_slow_lQ
    s_cmp_eq_u64 s[88:89], s[6:7]
    s_cbranch_scc0 L_slow_lQ
    s_cmp_eq_u64 s[90:91], s[6:7]
    s_cbranch_scc0 L_slow_lQ
L_back_lQ:
    s_add_u32 s99, s0, 32768
    buffer_load_dwordx4 v[192:195], v2, s[44:47], s99 offen sc1
    s_waitcnt vmcnt(8)
    v_mfma_f32_16x16x32_bf16 v[64:67], a[48:51], v[224:227], v[64:67]
    ds_read_b64_tr_b16 a[244:245], v29 offset:0
    v_mfma_f32_16x16x32_bf16 v[68:71], a[52:55], v[224:227], v[68:71]
    buffer_load_dwordx4 v[196:199], v3, s[44:47], s99 offen sc1
    v_mfma_f32_16x16x32_bf16 v[72:75], a[56:59], v[224:227], v[72:75]
    ds_read_b64_tr_b16 a[246:247], v29 offset:2048
    v_mfma_f32_16x16x32_bf16 v[76:79], a[60:63], v[224:227], v[76:79]
    s_waitcnt vmcnt(8)
    ds_read_b64_tr_b16 a[248:249], v30 offset:0
    v_mfma_f32_16x16x32_bf16 v[92:95], a[60:63], v[228:231], v[92:95]
    ds_read_b64_tr_b16 a[250:251], v30 offset:2048
    v_mfma_f32_16x16x32_bf16 v[88:91], a[56:59], v[228:231], v[88:91]
    buffer_load_dwordx4 v[200:203], v4, s[44:47], s99 offen sc1
    v_mfma_f32_16x16x32_bf16 v[84:87], a[52:55], v[228:231], v[84:87]
    ds_read_b64_tr_b16 a[252:253], v31 offset:0
    v_mfma_f32_16x16x32_bf16 v[80:83], a[48:51], v[228:231], v[80:83]
    s_waitcnt vmcnt(8)
    ds_read_b64_tr_b16 a[254:255], v31 offset:2048
    v_mfma_f32_16x16x32_bf16 v[96:99], a[48:51], v[232:235], v[96:99]
    ds_read_b64_tr_b16 a[112:113], v24 offset:49152
    v_mfma_f32_16x16x32_bf16 v[100:103], a[52:55], v[232:235], v[100:103]
    buffer_load_dwordx4 v[204:207], v5, s[44:47], s99 offen sc1
    v_mfma_f32_16x16x32_bf16 v[104:107], a[56:59], v[232:235], v[104:107]
    ds_read_b64_tr_b16 a[114:115], v24 offset:51200
    v_mfma_f32_16x16x32_bf16 v[108:111], a[60:63], v[232:235], v[108:111]
    s_waitcnt vmcnt(8)
    ds_read_b64_tr_b16 a[116:117], v25 offset:49152
    v_mfma_f32_16x16x32_bf16 v[124:127], a[60:63], v[236:239], v[124:127]
    ds_read_b64_tr_b16 a[118:119], v25 offset:51200
    v_mfma_f32_16x16x32_bf16 v[120:123], a[56:59], v[236:239], v[120:123]
    s_barrier
    s_add_u32 s99, s5, 32768
    buffer_load_dwordx4 v[216:219], v4, s[44:47], s99 offen sc1
    v_mfma_f32_16x16x32_bf16 v[116:119], a[52:55], v[236:239], v[116:119]
    ds_read_b64_tr_b16 a[120:121], v26 offset:49152
    v_mfma_f32_16x16x32_bf16 v[112:115], a[48:51], v[236:239], v[112:115]
    s_waitcnt vmcnt(8)
    ds_read_b64_tr_b16 a[122:123], v26 offset:51200
    v_mfma_f32_16x16x32_bf16 v[64:67], a[192:195], v[240:243], v[64:67]
    ds_read_b64_tr_b16 a[124:125], v27 offset:49152
    v_mfma_f32_16x16x32_bf16 v[68:71], a[196:199], v[240:243], v[68:71]
    buffer_load_dwordx4 v[220:223], v5, s[44:47], s99 offen sc1
    v_mfma_f32_16x16x32_bf16 v[72:75], a[200:203], v[240:243], v[72:75]
    ds_read_b64_tr_b16 a[126:127], v27 offset:51200
    v_mfma_f32_16x16x32_bf16 v[76:79], a[204:207], v[240:243], v[76:79]
    s_waitcnt vmcnt(8)
    ds_read_b64_tr_b16 a[128:129], v28 offset:16384
    v_mfma_f32_16x16x32_bf16 v[92:95], a[204:207], v[244:247], v[92:95]
    ds_read_b64_tr_b16 a[130:131], v28 offset:18432
    v_mfma_f32_16x16x32_bf16 v[88:91], a[200:203], v[244:247], v[88:91]
    buffer_load_dwordx4 v[212:215], v3, s[44:47], s99 offen sc1
    v_mfma_f32_16x16x32_bf16 v[84:87], a[196:199], v[244:247], v[84:87]
    ds_read_b64_tr_b16 a[132:133], v29 offset:16384
    v_mfma_f32_16x16x32_bf16 v[80:83], a[192:195], v[244:247], v[80:83]
    s_waitcnt vmcnt(8)
    ds_read_b64_tr_b16 a[134:135], v29 offset:18432
    v_mfma_f32_16x16x32_bf16 v[96:99], a[192:195], v[248:251], v[96:99]
    ds_read_b64_tr_b16 a[136:137], v30 offset:16384
    v_mfma_f32_16x16x32_bf16 v[100:103], a[196:199], v[248:251], v[100:103]
    buffer_load_dwordx4 v[208:211], v2, s[44:47], s99 offen sc1
    v_mfma_f32_16x16x32_bf16 v[104:107], a[200:203], v[248:251], v[104:107]
    ds_read_b64_tr_b16 a[138:139], v30 offset:18432
    v_mfma_f32_16x16x32_bf16 v[108:111], a[204:207], v[248:251], v[108:111]
    s_waitcnt vmcnt(8)
    ds_read_b64_tr_b16 a[140:141], v31 offset:16384
    v_mfma_f32_16x16x32_bf16 v[124:127], a[204:207], v[252:255], v[124:127]
    s_add_u32 s99, s12, 32768
    ds_read_b64_tr_b16 a[142:143], v31 offset:18432
    v_mfma_f32_16x16x32_bf16 v[120:123], a[200:203], v[252:255], v[120:123]
    buffer_load_dwordx4 v[224:227], v2, s[44:47], s99 offen sc1
    v_mfma_f32_16x16x32_bf16 v[116:119], a[196:199], v[252:255], v[116:119]
    ds_read_b64_tr_b16 a[16:17], v28 offset:32768
    v_mfma_f32_16x16x32_bf16 v[112:115], a[192:195], v[252:255], v[112:115]
    s_waitcnt vmcnt(8)
    ds_read_b64_tr_b16 a[18:19], v28 offset:34816
    v_mfma_f32_16x16x32_bf16 v[64:67], a[144:147], v[192:195], v[64:67]
    ds_read_b64_tr_b16 a[20:21], v29 offset:32768
    v_mfma_f32_16x16x32_bf16 v[68:71], a[148:151], v[192:195], v[68:71]
    buffer_load_dwordx4 v[228:231], v3, s[44:47], s99 offen sc1
    v_mfma_f32_16x16x32_bf16 v[72:75], a[152:155], v[192:195], v[72:75]
    ds_read_b64_tr_b16 a[22:23], v29 offset:34816
    v_mfma_f32_16x16x32_bf16 v[76:79], a[156:159], v[192:195], v[76:79]
    s_waitcnt vmcnt(8)
    ds_read_b64_tr_b16 a[24:25], v30 offset:32768
    v_mfma_f32_16x16x32_bf16 v[92:95], a[156:159], v[196:199], v[92:95]
    ds_read_b64_tr_b16 a[26:27], v30 offset:34816
    v_mfma_f32_16x16x32_bf16 v[88:91], a[152:155], v[196:199], v[88:91]
    buffer_load_dwordx4 v[232:235], v4, s[44:47], s99 offen sc1
    v_mfma_f32_16x16x32_bf16 v[84:87], a[148:151], v[196:199], v[84:87]
    ds_read_b64_tr_b16 a[28:29], v31 offset:32768
    v_mfma_f32_16x16x32_bf16 v[80:83], a[144:147], v[196:199], v[80:83]
    s_waitcnt vmcnt(8)
    ds_read_b64_tr_b16 a[30:31], v31 offset:34816
    v_mfma_f32_16x16x32_bf16 v[96:99], a[144:147], v[200:203], v[96:99]
    ds_read_b64_tr_b16 a[160:161], v36 offset:0
    v_mfma_f32_16x16x32_bf16 v[100:103], a[148:151], v[200:203], v[100:103]
    buffer_load_dwordx4 v[236:239], v5, s[44:47], s99 offen sc1
    v_mfma_f32_16x16x32_bf16 v[104:107], a[152:155], v[200:203], v[104:107]
    ds_read_b64_tr_b16 a[162:163], v36 offset:2048
    v_mfma_f32_16x16x32_bf16 v[108:111], a[156:159], v[200:203], v[108:111]
    s_waitcnt vmcnt(8)
    ds_read_b64_tr_b16 a[164:165], v37 offset:0
    v_mfma_f32_16x16x32_bf16 v[124:127], a[156:159], v[204:207], v[124:127]
    s_add_u32 s99, s16, 32768
    ds_read_b64_tr_b16 a[166:167], v37 offset:2048
    v_mfma_f32_16x16x32_bf16 v[120:123], a[152:155], v[204:207], v[120:123]
    buffer_load_dwordx4 v[240:243], v2, s[44:47], s99 offen sc1
    v_mfma_f32_16x16x32_bf16 v[116:119], a[148:151], v[204:207], v[116:119]
    ds_read_b64_tr_b16 a[168:169], v38 offset:0
    v_mfma_f32_16x16x32_bf16 v[112:115], a[144:147], v[204:207], v[112:115]
    s_waitcnt vmcnt(8)
    ds_read_b64_tr_b16 a[170:171], v38 offset:2048
    v_mfma_f32_16x16x32_bf16 v[96:99], a[64:67], v[216:219], v[96:99]
    ds_read_b64_tr_b16 a[172:173], v39 offset:0
    v_mfma_f32_16x16x32_bf16 v[100:103], a[68:71], v[216:219], v[100:103]
    buffer_load_dwordx4 v[244:247], v3, s[44:47], s99 offen sc1
    v_mfma_f32_16x16x32_bf16 v[104:107], a[72:75], v[216:219], v[104:107]
    ds_read_b64_tr_b16 a[174:175], v39 offset:2048
    v_mfma_f32_16x16x32_bf16 v[108:111], a[76:79], v[216:219], v[108:111]
    s_waitcnt vmcnt(8)
    ds_read_b64_tr_b16 a[32:33], v32 offset:49152
    v_mfma_f32_16x16x32_bf16 v[124:127], a[76:79], v[220:223], v[124:127]
    ds_read_b64_tr_b16 a[34:35], v32 offset:51200
    v_mfma_f32_16x16x32_bf16 v[120:123], a[72:75], v[220:223], v[120:123]
    buffer_load_dwordx4 v[248:251], v4, s[44:47], s99 offen sc1
    v_mfma_f32_16x16x32_bf16 v[116:119], a[68:71], v[220:223], v[116:119]
    ds_read_b64_tr_b16 a[36:37], v33 offset:49152
    v_mfma_f32_16x16x32_bf16 v[112:115], a[64:67], v[220:223], v[112:115]
    s_waitcnt vmcnt(8)
    ds_read_b64_tr_b16 a[38:39], v33 offset:51200
    v_mfma_f32_16x16x32_bf16 v[80:83], a[64:67], v[212:215], v[80:83]
    ds_read_b64_tr_b16 a[40:41], v34 offset:49152
    v_mfma_f32_16x16x32_bf16 v[84:87], a[68:71], v[212:215], v[84:87]
    buffer_load_dwordx4 v[252:255], v5, s[44:47], s99 offen sc1
    v_mfma_f32_16x16x32_bf16 v[88:91], a[72:75], v[212:215], v[88:91]
    ds_read_b64_tr_b16 a[42:43], v34 offset:51200
    v_mfma_f32_16x16x32_bf16 v[92:95], a[76:79], v[212:215], v[92:95]
    s_waitcnt vmcnt(8)
    ds_read_b64_tr_b16 a[44:45], v35 offset:49152
    v_mfma_f32_16x16x32_bf16 v[76:79], a[76:79], v[208:211], v[76:79]
    ds_read_b64_tr_b16 a[46:47], v35 offset:51200
    v_mfma_f32_16x16x32_bf16 v[72:75], a[72:75], v[208:211], v[72:75]
    buffer_load_dword v16, v7, s[44:47], s98 offen offset:1024 sc1
    buffer_load_dword v17, v15, s[44:47], s98 offen offset:1024 sc1
    buffer_load_dwordx2 v[8:9], v57, s[44:47], s19 offen offset:3584 sc1
    s_add_u32 s99, s22, 49152
    buffer_load_dwordx4 v[192:195], v2, s[44:47], s99 offen sc1
    v_mfma_f32_16x16x32_bf16 v[68:71], a[68:71], v[208:211], v[68:71]
    ds_read_b64_tr_b16 a[0:1], v36 offset:16384
    v_mfma_f32_16x16x32_bf16 v[64:67], a[64:67], v[208:211], v[64:67]
    s_waitcnt vmcnt(11)
    ds_read_b64_tr_b16 a[2:3], v36 offset:18432
    v_mfma_f32_16x16x32_bf16 v[64:67], a[208:211], v[224:227], v[64:67]
    ds_read_b64_tr_b16 a[4:5], v37 offset:16384
    v_mfma_f32_16x16x32_bf16 v[68:71], a[212:215], v[224:227], v[68:71]
    buffer_load_dwordx4 v[196:199], v3, s[44:47], s99 offen sc1
    v_mfma_f32_16x16x32_bf16 v[72:75], a[216:219], v[224:227], v[72:75]
    ds_read_b64_tr_b16 a[6:7], v37 offset:18432
    v_mfma_f32_16x16x32_bf16 v[76:79], a[220:223], v[224:227], v[76:79]
    s_waitcnt vmcnt(11)
    ds_read_b64_tr_b16 a[8:9], v38 offset:16384
    v_mfma_f32_16x16x32_bf16 v[92:95], a[220:223], v[228:231], v[92:95]
    ds_read_b64_tr_b16 a[10:11], v38 offset:18432
    v_mfma_f32_16x16x32_bf16 v[88:91], a[216:219], v[228:231], v[88:91]
    buffer_load_dwordx4 v[200:203], v4, s[44:47], s99 offen sc1
    v_mfma_f32_16x16x32_bf16 v[84:87], a[212:215], v[228:231], v[84:87]
    ds_read_b64_tr_b16 a[12:13], v39 offset:16384
    v_mfma_f32_16x16x32_bf16 v[80:83], a[208:211], v[228:231], v[80:83]
    s_waitcnt vmcnt(11)
    ds_read_b64_tr_b16 a[14:15], v39 offset:18432
    v_mfma_f32_16x16x32_bf16 v[96:99], a[208:211], v[232:235], v[96:99]
    ds_read_b64_tr_b16 a[176:177], v36 offset:32768
    v_mfma_f32_16x16x32_bf16 v[100:103], a[212:215], v[232:235], v[100:103]
    buffer_load_dwordx4 v[204:207], v5, s[44:47], s99 offen sc1
    v_mfma_f32_16x16x32_bf16 v[104:107], a[216:219], v[232:235], v[104:107]
    ds_read_b64_tr_b16 a[178:179], v36 offset:34816
    v_mfma_f32_16x16x32_bf16 v[108:111], a[220:223], v[232:235], v[108:111]
    s_waitcnt vmcnt(11)
    ds_read_b64_tr_b16 a[180:181], v37 offset:32768
    v_mfma_f32_16x16x32_bf16 v[124:127], a[220:223], v[236:239], v[124:127]
    s_add_u32 s99, s27, 49152
    ds_read_b64_tr_b16 a[182:183], v37 offset:34816
    v_mfma_f32_16x16x32_bf16 v[120:123], a[216:219], v[236:239], v[120:123]
    buffer_load_dwordx4 v[216:219], v4, s[44:47], s99 offen sc1
    v_mfma_f32_16x16x32_bf16 v[116:119], a[212:215], v[236:239], v[116:119]
    ds_read_b64_tr_b16 a[184:185], v38 offset:32768
    v_mfma_f32_16x16x32_bf16 v[112:115], a[208:211], v[236:239], v[112:115]
    s_waitcnt vmcnt(11)
    ds_read_b64_tr_b16 a[186:187], v38 offset:34816
    v_mfma_f32_16x16x32_bf16 v[64:67], a[80:83], v[240:243], v[64:67]
    ds_read_b64_tr_b16 a[188:189], v39 offset:32768
    v_mfma_f32_16x16x32_bf16 v[68:71], a[84:87], v[240:243], v[68:71]
    buffer_load_dwordx4 v[220:223], v5, s[44:47], s99 offen sc1
    v_mfma_f32_16x16x32_bf16 v[72:75], a[88:91], v[240:243], v[72:75]
    ds_read_b64_tr_b16 a[190:191], v39 offset:34816
    v_mfma_f32_16x16x32_bf16 v[76:79], a[92:95], v[240:243], v[76:79]
    s_waitcnt vmcnt(11)
    v_mfma_f32_16x16x32_bf16 v[92:95], a[92:95], v[244:247], v[92:95]
    v_mfma_f32_16x16x32_bf16 v[88:91], a[88:91], v[244:247], v[88:91]
    buffer_load_dwordx4 v[212:215], v3, s[44:47], s99 offen sc1
    v_mfma_f32_16x16x32_bf16 v[84:87], a[84:87], v[244:247], v[84:87]
    v_mfma_f32_16x16x32_bf16 v[80:83], a[80:83], v[244:247], v[80:83]
    s_waitcnt vmcnt(11)
    v_mfma_f32_16x16x32_bf16 v[96:99], a[80:83], v[248:251], v[96:99]
    v_mfma_f32_16x16x32_bf16 v[100:103], a[84:87], v[248:251], v[100:103]
    buffer_load_dwordx4 v[208:211], v2, s[44:47], s99 offen sc1
    v_mfma_f32_16x16x32_bf16 v[104:107], a[88:91], v[248:251], v[104:107]
    v_mfma_f32_16x16x32_bf16 v[108:111], a[92:95], v[248:251], v[108:111]
    s_waitcnt vmcnt(11)
    v_mfma_f32_16x16x32_bf16 v[124:127], a[92:95], v[252:255], v[124:127]
    v_mfma_f32_16x16x32_bf16 v[120:123], a[88:91], v[252:255], v[120:123]
    s_waitcnt vmcnt(8)
    v_cmp_eq_u64 vcc, s[6:7], v[8:9]
    s_nop 0
    s_cmp_eq_u64 vcc, -1
    s_cbranch_scc0 L_slow_oQ
L_back_oQ:
    v_add_u32 v4, s9, v2
    v_add_u32 v5, s9, v3
    s_add_u32 s99, s0, 57344
    buffer_load_dwordx4 v[224:227], v3, s[44:47], s99 offen sc1
    v_mfma_f32_16x16x32_bf16 v[116:119], a[84:87], v[252:255], v[116:119]
    v_mfma_f32_16x16x32_bf16 v[112:115], a[80:83], v[252:255], v[112:115]
    s_waitcnt vmcnt(8)
    v_mfma_f32_16x16x32_bf16 v[64:67], a[224:227], v[192:195], v[64:67]
    v_mfma_f32_16x16x32_bf16 v[68:71], a[228:231], v[192:195], v[68:71]
    buffer_load_dwordx4 v[228:231], v5, s[44:47], s99 offen sc1
    v_mfma_f32_16x16x32_bf16 v[72:75], a[232:235], v[192:195], v[72:75]
    v_mfma_f32_16x16x32_bf16 v[76:79], a[236:239], v[192:195], v[76:79]
    s_waitcnt vmcnt(8)
    v_mfma_f32_16x16x32_bf16 v[92:95], a[236:239], v[196:199], v[92:95]
    s_add_u32 s99, s5, 57344
    v_mfma_f32_16x16x32_bf16 v[88:91], a[232:235], v[196:199], v[88:91]
    buffer_load_dwordx4 v[232:235], v3, s[44:47], s99 offen sc1
    v_mfma_f32_16x16x32_bf16 v[84:87], a[228:231], v[196:199], v[84:87]
    v_mfma_f32_16x16x32_bf16 v[80:83], a[224:227], v[196:199], v[80:83]
    s_waitcnt vmcnt(8)
    v_mfma_f32_16x16x32_bf16 v[96:99], a[224:227], v[200:203], v[96:99]
    v_mfma_f32_16x16x32_bf16 v[100:103], a[228:231], v[200:203], v[100:103]
    buffer_load_dwordx4 v[236:239], v5, s[44:47], s99 offen sc1
    v_mfma_f32_16x16x32_bf16 v[104:107], a[232:235], v[200:203], v[104:107]
    v_mfma_f32_16x16x32_bf16 v[108:111], a[236:239], v[200:203], v[108:111]
    s_waitcnt vmcnt(8)
    v_mfma_f32_16x16x32_bf16 v[124:127], a[236:239], v[204:207], v[124:127]
    s_add_u32 s99, s12, 57344
    v_mfma_f32_16x16x32_bf16 v[120:123], a[232:235], v[204:207], v[120:123]
    buffer_load_dwordx4 v[240:243], v3, s[44:47], s99 offen sc1
    v_mfma_f32_16x16x32_bf16 v[116:119], a[228:231], v[204:207], v[116:119]
    v_mfma_f32_16x16x32_bf16 v[112:115], a[224:227], v[204:207], v[112:115]
    s_waitcnt vmcnt(8)
    v_mfma_f32_16x16x32_bf16 v[96:99], a[96:99], v[216:219], v[96:99]
    v_mfma_f32_16x16x32_bf16 v[100:103], a[100:103], v[216:219], v[100:103]
    buffer_load_dwordx4 v[244:247], v5, s[44:47], s99 offen sc1
    v_mfma_f32_16x16x32_bf16 v[104:107], a[104:107], v[216:219], v[104:107]
    v_mfma_f32_16x16x32_bf16 v[108:111], a[108:111], v[216:219], v[108:111]
    s_waitcnt vmcnt(8)
    v_mfma_f32_16x16x32_bf16 v[124:127], a[108:111], v[220:223], v[124:127]
    s_add_u32 s99, s16, 57344
    v_mfma_f32_16x16x32_bf16 v[120:123], a[104:107], v[220:223], v[120:123]
    buffer_load_dwordx4 v[248:251], v3, s[44:47], s99 offen sc1
    v_mfma_f32_16x16x32_bf16 v[116:119], a[100:103], v[220:223], v[116:119]
    v_mfma_f32_16x16x32_bf16 v[112:115], a[96:99], v[220:223], v[112:115]
    s_waitcnt vmcnt(8)
    v_mfma_f32_16x16x32_bf16 v[80:83], a[96:99], v[212:215], v[80:83]
    v_mfma_f32_16x16x32_bf16 v[84:87], a[100:103], v[212:215], v[84:87]
    buffer_load_dwordx4 v[252:255], v5, s[44:47], s99 offen sc1
    v_mfma_f32_16x16x32_bf16 v[88:91], a[104:107], v[212:215], v[88:91]
    v_mfma_f32_16x16x32_bf16 v[92:95], a[108:111], v[212:215], v[92:95]
    s_waitcnt vmcnt(8)
    v_mfma_f32_16x16x32_bf16 v[76:79], a[108:111], v[208:211], v[76:79]
    s_add_u32 s99, s0, 57344
    v_mfma_f32_16x16x32_bf16 v[72:75], a[104:107], v[208:211], v[72:75]
    buffer_load_dwordx4 v[192:195], v2, s[44:47], s99 offen sc1
    v_mfma_f32_16x16x32_bf16 v[68:71], a[100:103], v[208:211], v[68:71]
    v_mfma_f32_16x16x32_bf16 v[64:67], a[96:99], v[208:211], v[64:67]
    s_waitcnt vmcnt(8)
    v_mfma_f32_16x16x32_bf16 v[144:147], a[240:243], v[224:227], 0
    ds_write_b128 v48, v[96:99] offset:16384
    s_waitcnt lgkmcnt(14)
    v_mfma_f32_16x16x32_bf16 v[148:151], a[244:247], v[224:227], 0
    buffer_load_dwordx4 v[196:199], v4, s[44:47], s99 offen sc1
    v_mfma_f32_16x16x32_bf16 v[152:155], a[248:251], v[224:227], 0
    v_mfma_f32_16x16x32_bf16 v[156:159], a[252:255], v[224:227], 0
    s_waitcnt vmcnt(8)
    ds_write_b128 v48, v[100:103] offset:17408
    v_mfma_f32_16x16x32_bf16 v[144:147], a[160:163], v[228:231], v[144:147]
    s_add_u32 s99, s5, 57344
    v_sub_f32 v18, 1.0, v16
    v_sub_f32 v19, 1.0, v17
    v_mfma_f32_16x16x32_bf16 v[148:151], a[164:167], v[228:231], v[148:151]
    buffer_load_dwordx4 v[200:203], v2, s[44:47], s99 offen sc1
    v_mfma_f32_16x16x32_bf16 v[152:155], a[168:171], v[228:231], v[152:155]
    v_mul_f32 v80, v80, v19
    v_mfma_f32_16x16x32_bf16 v[156:159], a[172:175], v[228:231], v[156:159]
    s_waitcnt vmcnt(8)
    ds_write_b128 v48, v[104:107] offset:18432
    v_mfma_f32_16x16x32_bf16 v[144:147], a[112:115], v[232:235], v[144:147]
    v_mul_f32 v81, v81, v19
    v_mul_f32 v82, v82, v19
    v_mfma_f32_16x16x32_bf16 v[148:151], a[116:119], v[232:235], v[148:151]
    buffer_load_dwordx4 v[204:207], v4, s[44:47], s99 offen sc1
    v_mfma_f32_16x16x32_bf16 v[152:155], a[120:123], v[232:235], v[152:155]
    v_mul_f32 v83, v83, v19
    v_mfma_f32_16x16x32_bf16 v[156:159], a[124:127], v[232:235], v[156:159]
    s_waitcnt vmcnt(8)
    ds_write_b128 v48, v[108:111] offset:19456
    v_mfma_f32_16x16x32_bf16 v[144:147], a[32:35], v[236:239], v[144:147]
    s_add_u32 s99, s12, 57344
    v_mul_f32 v84, v84, v19
    v_mul_f32 v85, v85, v19
    v_mfma_f32_16x16x32_bf16 v[148:151], a[36:39], v[236:239], v[148:151]
    buffer_load_dwordx4 v[208:211], v2, s[44:47], s99 offen sc1
    v_mfma_f32_16x16x32_bf16 v[152:155], a[40:43], v[236:239], v[152:155]
    v_mul_f32 v86, v86, v19
    v_mfma_f32_16x16x32_bf16 v[156:159], a[44:47], v[236:239], v[156:159]
    s_waitcnt vmcnt(8)
    ds_write_b128 v48, v[112:115] offset:32768
    v_mfma_f32_16x16x32_bf16 v[144:147], a[128:131], v[240:243], v[144:147]
    v_mul_f32 v87, v87, v19
    v_mul_f32 v88, v88, v19
    v_mfma_f32_16x16x32_bf16 v[148:151], a[132:135], v[240:243], v[148:151]
    buffer_load_dwordx4 v[212:215], v4, s[44:47], s99 offen sc1
    v_mfma_f32_16x16x32_bf16 v[152:155], a[136:139], v[240:243], v[152:155]
    v_mul_f32 v89, v89, v19
    v_mfma_f32_16x16x32_bf16 v[156:159], a[140:143], v[240:243], v[156:159]
    s_waitcnt vmcnt(8)
    ds_write_b128 v48, v[116:119] offset:33792
    v_mfma_f32_16x16x32_bf16 v[144:147], a[0:3], v[244:247], v[144:147]
    s_add_u32 s99, s16, 57344
    v_mul_f32 v90, v90, v19
    v_mul_f32 v91, v91, v19
    s_waitcnt lgkmcnt(14)
    v_mfma_f32_16x16x32_bf16 v[148:151], a[4:7], v[244:247], v[148:151]
    buffer_load_dwordx4 v[216:219], v2, s[44:47], s99 offen sc1
    v_mfma_f32_16x16x32_bf16 v[152:155], a[8:11], v[244:247], v[152:155]
    v_mul_f32 v92, v92, v19
    v_mfma_f32_16x16x32_bf16 v[156:159], a[12:15], v[244:247], v[156:159]
    s_waitcnt vmcnt(8)
    ds_write_b128 v48, v[120:123] offset:34816
    v_mfma_f32_16x16x32_bf16 v[144:147], a[16:19], v[248:251], v[144:147]
    v_mul_f32 v93, v93, v19
    v_mul_f32 v94, v94, v19
    v_mfma_f32_16x16x32_bf16 v[148:151], a[20:23], v[248:251], v[148:151]
    buffer_load_dwordx4 v[220:223], v4, s[44:47], s99 offen sc1
    v_mfma_f32_16x16x32_bf16 v[152:155], a[24:27], v[248:251], v[152:155]
    v_mul_f32 v95, v95, v19
    v_mfma_f32_16x16x32_bf16 v[156:159], a[28:31], v[248:251], v[156:159]
    s_waitcnt vmcnt(8)
    ds_write_b128 v48, v[124:127] offset:35840
    s_waitcnt lgkmcnt(14)
    v_mfma_f32_16x16x32_bf16 v[144:147], a[176:179], v[252:255], v[144:147]
    s_waitcnt lgkmcnt(12)
    v_mfma_f32_16x16x32_bf16 v[148:151], a[180:183], v[252:255], v[148:151]
    s_waitcnt lgkmcnt(10)
    v_mfma_f32_16x16x32_bf16 v[152:155], a[184:187], v[252:255], v[152:155]
    s_waitcnt lgkmcnt(8)
    v_mfma_f32_16x16x32_bf16 v[156:159], a[188:191], v[252:255], v[156:159]
    s_waitcnt vmcnt(7)
    v_mfma_f32_16x16x32_bf16 v[128:131], a[240:243], v[192:195], 0
    v_mfma_f32_16x16x32_bf16 v[132:135], a[244:247], v[192:195], 0
    v_fmac_f32 v80, v144, v17
    v_fmac_f32 v81, v145, v17
    v_mfma_f32_16x16x32_bf16 v[136:139], a[248:251], v[192:195], 0
    v_fmac_f32 v82, v146, v17
    v_fmac_f32 v83, v147, v17
    v_mfma_f32_16x16x32_bf16 v[140:143], a[252:255], v[192:195], 0
    s_waitcnt vmcnt(6)
    ds_write_b128 v48, v[80:83] offset:0
    v_mfma_f32_16x16x32_bf16 v[128:131], a[160:163], v[196:199], v[128:131]
    v_fmac_f32 v84, v148, v17
    v_fmac_f32 v85, v149, v17
    v_mfma_f32_16x16x32_bf16 v[132:135], a[164:167], v[196:199], v[132:135]
    v_fmac_f32 v86, v150, v17
    v_fmac_f32 v87, v151, v17
    v_mfma_f32_16x16x32_bf16 v[136:139], a[168:171], v[196:199], v[136:139]
    ds_write_b128 v48, v[84:87] offset:1024
    v_fmac_f32 v88, v152, v17
    v_mfma_f32_16x16x32_bf16 v[140:143], a[172:175], v[196:199], v[140:143]
    s_waitcnt vmcnt(5)
    v_fmac_f32 v89, v153, v17
    v_fmac_f32 v90, v154, v17
    v_mfma_f32_16x16x32_bf16 v[128:131], a[112:115], v[200:203], v[128:131]
    v_fmac_f32 v91, v155, v17
    v_fmac_f32 v92, v156, v17
    v_mfma_f32_16x16x32_bf16 v[132:135], a[116:119], v[200:203], v[132:135]
    ds_write_b128 v48, v[88:91] offset:2048
    v_fmac_f32 v93, v157, v17
    v_mfma_f32_16x16x32_bf16 v[136:139], a[120:123], v[200:203], v[136:139]
    v_fmac_f32 v94, v158, v17
    v_fmac_f32 v95, v159, v17
    v_mfma_f32_16x16x32_bf16 v[140:143], a[124:127], v[200:203], v[140:143]
    s_waitcnt vmcnt(4)
    ds_write_b128 v48, v[92:95] offset:3072
    v_mfma_f32_16x16x32_bf16 v[128:131], a[32:35], v[204:207], v[128:131]
    v_mfma_f32_16x16x32_bf16 v[132:135], a[36:39], v[204:207], v[132:135]
    s_waitcnt lgkmcnt(0)
    s_barrier
    v_mfma_f32_16x16x32_bf16 v[136:139], a[40:43], v[204:207], v[136:139]
    ds_read_b128 v[96:99], v50 offset:16384
    v_mfma_f32_16x16x32_bf16 v[140:143], a[44:47], v[204:207], v[140:143]
    s_waitcnt vmcnt(3)
    ds_read_b128 v[112:115], v51 offset:32768
    v_mfma_f32_16x16x32_bf16 v[128:131], a[128:131], v[208:211], v[128:131]
    ds_read_b128 v[100:103], v50 offset:17408
    v_mfma_f32_16x16x32_bf16 v[132:135], a[132:135], v[208:211], v[132:135]
    ds_read_b128 v[116:119], v51 offset:33792
    v_mfma_f32_16x16x32_bf16 v[136:139], a[136:139], v[208:211], v[136:139]
    ds_read_b128 v[104:107], v50 offset:18432
    s_waitcnt lgkmcnt(4)
    v_add_f32 v64, v64, v96
    v_mfma_f32_16x16x32_bf16 v[140:143], a[140:143], v[208:211], v[140:143]
L_padQ4:
    s_cbranch_execz L_retQ
    s_waitcnt vmcnt(2)
    ds_read_b128 v[120:123], v51 offset:34816
    v_mfma_f32_16x16x32_bf16 v[128:131], a[0:3], v[212:215], v[128:131]
    ds_read_b128 v[108:111], v50 offset:19456
    v_add_f32 v65, v65, v97
    v_mfma_f32_16x16x32_bf16 v[132:135], a[4:7], v[212:215], v[132:135]
    ds_read_b128 v[124:127], v51 offset:35840
    v_add_f32 v66, v66, v98
    v_mfma_f32_16x16x32_bf16 v[136:139], a[8:11], v[212:215], v[136:139]
    ds_read_b128 v[80:83], v49 offset:0
    v_add_f32 v67, v67, v99
    v_mfma_f32_16x16x32_bf16 v[140:143], a[12:15], v[212:215], v[140:143]
    s_waitcnt vmcnt(1)
    ds_read_b128 v[84:87], v49 offset:1024
    v_mfma_f32_16x16x32_bf16 v[128:131], a[16:19], v[216:219], v[128:131]
    ds_read_b128 v[88:91], v49 offset:2048
    s_waitcnt lgkmcnt(9)
    v_add_f32 v64, v64, v112
    v_mfma_f32_16x16x32_bf16 v[132:135], a[20:23], v[216:219], v[132:135]
    ds_read_b128 v[92:95], v49 offset:3072
    v_add_f32 v65, v65, v113
    v_mfma_f32_16x16x32_bf16 v[136:139], a[24:27], v[216:219], v[136:139]
    v_add_f32 v66, v66, v114
    v_add_f32 v67, v67, v115
    v_mfma_f32_16x16x32_bf16 v[140:143], a[28:31], v[216:219], v[140:143]
    s_waitcnt vmcnt(0)
    s_waitcnt lgkmcnt(9)
    v_add_f32 v68, v68, v100
    v_mfma_f32_16x16x32_bf16 v[128:131], a[176:179], v[220:223], v[128:131]
    v_add_f32 v69, v69, v101
    v_add_f32 v70, v70, v102
    v_mfma_f32_16x16x32_bf16 v[132:135], a[180:183], v[220:223], v[132:135]
    v_add_f32 v71, v71, v103
    s_waitcnt lgkmcnt(8)
    v_add_f32 v68, v68, v116
    v_mfma_f32_16x16x32_bf16 v[136:139], a[184:187], v[220:223], v[136:139]
    v_add_f32 v69, v69, v117
    v_add_f32 v70, v70, v118
    v_mfma_f32_16x16x32_bf16 v[140:143], a[188:191], v[220:223], v[140:143]
    v_add_f32 v71, v71, v119
    s_waitcnt lgkmcnt(7)
    v_add_f32 v72, v72, v104
    s_waitcnt lgkmcnt(0)
    v_add_f32 v73, v73, v105
    v_pk_add_f32 v[74:75], v[74:75], v[106:107]
    v_pk_add_f32 v[72:73], v[72:73], v[120:121]
    v_pk_add_f32 v[74:75], v[74:75], v[122:123]
    v_pk_add_f32 v[76:77], v[76:77], v[108:109]
    v_pk_add_f32 v[78:79], v[78:79], v[110:111]
    v_pk_add_f32 v[76:77], v[76:77], v[124:125]
    v_pk_add_f32 v[78:79], v[78:79], v[126:127]
    v_pk_fma_f32 v[64:65], v[64:65], v[18:19], v[80:81] op_sel_hi:[1,0,1]
    v_pk_fma_f32 v[66:67], v[66:67], v[18:19], v[82:83] op_sel_hi:[1,0,1]
    v_pk_fma_f32 v[68:69], v[68:69], v[18:19], v[84:85] op_sel_hi:[1,0,1]
    v_pk_fma_f32 v[70:71], v[70:71], v[18:19], v[86:87] op_sel_hi:[1,0,1]
    v_pk_fma_f32 v[72:73], v[72:73], v[18:19], v[88:89] op_sel_hi:[1,0,1]
    v_pk_fma_f32 v[74:75], v[74:75], v[18:19], v[90:91] op_sel_hi:[1,0,1]
    v_pk_fma_f32 v[76:77], v[76:77], v[18:19], v[92:93] op_sel_hi:[1,0,1]
    v_pk_fma_f32 v[78:79], v[78:79], v[18:19], v[94:95] op_sel_hi:[1,0,1]
    v_pk_fma_f32 v[64:65], v[128:129], v[16:17], v[64:65] op_sel_hi:[1,0,1]
    v_pk_fma_f32 v[66:67], v[130:131], v[16:17], v[66:67] op_sel_hi:[1,0,1]
    v_cvt_pk_bf16_f32 v64, v64, v65
    v_cvt_pk_bf16_f32 v65, v66, v67
    ds_write_b64 v58, v[64:65]
    v_pk_fma_f32 v[68:69], v[132:133], v[16:17], v[68:69] op_sel_hi:[1,0,1]
    v_pk_fma_f32 v[70:71], v[134:135], v[16:17], v[70:71] op_sel_hi:[1,0,1]
    v_cvt_pk_bf16_f32 v68, v68, v69
    v_cvt_pk_bf16_f32 v69, v70, v71
    ds_write_b64 v59, v[68:69]
    v_pk_fma_f32 v[72:73], v[136:137], v[16:17], v[72:73] op_sel_hi:[1,0,1]
    v_pk_fma_f32 v[74:75], v[138:139], v[16:17], v[74:75] op_sel_hi:[1,0,1]
    v_cvt_pk_bf16_f32 v72, v72, v73
    v_cvt_pk_bf16_f32 v73, v74, v75
    ds_write_b64 v60, v[72:73]
    v_pk_fma_f32 v[76:77], v[140:141], v[16:17], v[76:77] op_sel_hi:[1,0,1]
    v_pk_fma_f32 v[78:79], v[142:143], v[16:17], v[78:79] op_sel_hi:[1,0,1]
    v_cvt_pk_bf16_f32 v76, v76, v77
    v_cvt_pk_bf16_f32 v77, v78, v79
    ds_write_b64 v61, v[76:77]
    ds_read_b128 v[80:83], v53 offset:0
    ds_read_b128 v[84:87], v53 offset:1024
    s_waitcnt lgkmcnt(1)
    buffer_store_dwordx4 v[80:83], v52, s[56:59], s24 offen sc1 nt
    s_waitcnt lgkmcnt(0)
    buffer_store_dwordx4 v[84:87], v52, s[56:59], s25 offen sc1 nt
    s_endpgm
L_slow_tagQ:
    s_mov_b32 s3, 0
L_spin_tagQ:
    s_nop 4
    buffer_load_dwordx2 v[20:21], off, s[60:63], 0 sc1
    s_waitcnt vmcnt(0)
    v_readfirstlane_b32 s6, v20
    s_nop 4
    v_readfirstlane_b32 s7, v21
    s_nop 4
    s_cmp_lg_u32 s7, 0
    s_cbranch_scc1 L_back_tagQ
    s_add_u32 s3, s3, 1
    s_cmp_lt_u32 s3, 0x40000
    s_cbranch_scc1 L_spin_tagQ
    s_branch L_back_tagQ
L_slow_kv:
    s_mov_b32 s3, 0
L_spin_kv:
    s_nop 4
    buffer_load_dwordx2 v[16:17], v18, s[44:47], s11 offen sc1
    s_waitcnt vmcnt(0)
    v_cmp_eq_u64 vcc, s[6:7], v[16:17]
    s_nop 4
    s_cmp_eq_u32 vcc_lo, s15
    s_cbranch_scc1 L_back_kv
    s_add_u32 s3, s3, 1
    s_cmp_lt_u32 s3, 0x40000
    s_cbranch_scc1 L_spin_kv
    s_branch L_back_kv
L_slow_vQ:
    s_mov_b32 s3, 0
L_spin_vQ:
    s_nop 4
    buffer_load_dwordx2 v[8:9], v6, s[44:47], s4 offen offset:512 sc1
    s_waitcnt vmcnt(0)
    v_cmp_eq_u64 vcc, s[6:7], v[8:9]
    s_nop 4
    s_cmp_eq_u64 vcc, -1
    s_cbranch_scc1 L_back_vQ
    s_add_u32 s3, s3, 1
    s_cmp_lt_u32 s3, 0x40000
    s_cbranch_scc1 L_spin_vQ
    s_branch L_back_vQ
L_slow_eQ:
    s_waitcnt vmcnt(0)
    buffer_store_dwordx2 v[20:21], v1, s[44:47], s10 offen offset:3072 sc1
    s_mov_b32 s3, 0
L_spin_eQ:
    s_nop 4
    buffer_load_dwordx2 v[8:9], v6, s[44:47], s4 offen offset:1024 sc1
    s_waitcnt vmcnt(0)
    v_cmp_eq_u64 vcc, s[6:7], v[8:9]
    s_nop 4
    s_cmp_eq_u64 vcc, -1
    s_cbranch_scc1 L_back_eQ
    s_add_u32 s3, s3, 1
    s_cmp_lt_u32 s3, 0x40000
    s_cbranch_scc1 L_spin_eQ
    s_branch L_back_eQ
L_slow_lQ:
    s_mov_b32 s3, 0
L_spin_lQ:
    s_nop 4
    buffer_load_dwordx2 v[8:9], v14, s[44:47], s4 offen offset:2048 sc1
    s_waitcnt vmcnt(0)
    v_cmp_eq_u64 vcc, s[6:7], v[8:9]
    s_nop 4
    s_cmp_eq_u64 vcc, -1
    s_cbranch_scc1 L_back_lQ
    s_add_u32 s3, s3, 1
    s_cmp_lt_u32 s3, 0x40000
    s_cbranch_scc1 L_spin_lQ
    s_branch L_back_lQ
L_slow_oQ:
    s_mov_b32 s3, 0
L_spin_oQ:
    s_nop 4
    buffer_load_dwordx2 v[8:9], v57, s[44:47], s19 offen offset:3584 sc1
    s_waitcnt vmcnt(0)
    v_cmp_eq_u64 vcc, s[6:7], v[8:9]
    s_nop 4
    s_cmp_eq_u64 vcc, -1
    s_cbranch_scc1 L_back_oQ
    s_add_u32 s3, s3, 1
    s_cmp_lt_u32 s3, 0x40000
    s_cbranch_scc1 L_spin_oQ
    s_branch L_back_oQ
L_end:
    s_endpgm
.section .rodata,"a"
.p2align 6
.amdhsa_kernel gated_mix__linear_attn_block__glu_gated_reglu__prompt_kernel
  .amdhsa_next_free_vgpr 512
  .amdhsa_next_free_sgpr 102
  .amdhsa_accum_offset 256
  .amdhsa_group_segment_fixed_size 0
  .amdhsa_kernarg_size 88
  .amdhsa_user_sgpr_count 2
  .amdhsa_user_sgpr_kernarg_segment_ptr 1
  .amdhsa_system_sgpr_workgroup_id_x 1
.end_amdhsa_kernel
```
